```python
import torch

def _softmax(x, axis=-1):
    return torch.softmax(x, dim=axis)
def _gelu(x):
    return torch.nn.functional.gelu(x, approximate="tanh")
def _silu(x):
    return torch.nn.functional.silu(x)
def _sigmoid(x):
    return torch.sigmoid(x)
def _layernorm(x, axis=-1, eps=1e-5):
    m = x.mean(dim=axis, keepdim=True)
    v = x.var(dim=axis, keepdim=True, unbiased=False)
    return (x - m) / torch.sqrt(v + eps)
def _scatter_add(tgt, idx, src, axis=0):
    return tgt.clone().index_add_(axis, idx, src)
def _segment_sum(src, seg, n):
    out = torch.zeros((n,) + src.shape[1:], dtype=src.dtype)
    return out.index_add_(0, seg, src)
def _pad(x, pw):
    flat = tuple(v for pair in reversed(pw) for v in pair)
    return torch.nn.functional.pad(x, flat)

kernel_name = 'parallel_sum__ssm_conv_s5__swiglu_ffn__prompt'

def setup_inputs():

    _w = (lambda a: (lambda t: t.to(torch.bfloat16) if t.is_floating_point() else t)(torch.as_tensor(a)))
    def _A_setup():
        B, S, D = 1, 2048, 576
        P = D
        Lambda_re = -0.5 * (lambda _x: torch.exp(torch.as_tensor(_x)))((lambda *s: torch.randn(*s, dtype=torch.bfloat16) * 0.8)(P))
        Lambda_im = (lambda *s: torch.randn(*s, dtype=torch.bfloat16) * 0.8)(P) * 1.0
        B_re = (lambda *s: torch.randn(*s, dtype=torch.bfloat16) * 0.8)(P, D) * (D ** -0.5)
        B_im = (lambda *s: torch.randn(*s, dtype=torch.bfloat16) * 0.8)(P, D) * (D ** -0.5)
        C_re = (lambda *s: torch.randn(*s, dtype=torch.bfloat16) * 0.8)(D, P) * (P ** -0.5)
        C_im = (lambda *s: torch.randn(*s, dtype=torch.bfloat16) * 0.8)(D, P) * (P ** -0.5)
        log_dt = (lambda *s: torch.randn(*s, dtype=torch.bfloat16) * 0.8)(P) * 0.3 - 2.0
        Dskip = (lambda *s: torch.randn(*s, dtype=torch.bfloat16) * 0.8)(D)
        return {
            "x": _w((lambda *s: torch.randn(*s, dtype=torch.bfloat16) * 0.05)(B, S, D)),
            "Lambda_re": _w(Lambda_re),
            "Lambda_im": _w(Lambda_im),
            "B_re": _w(B_re),
            "B_im": _w(B_im),
            "C_re": _w(C_re),
            "C_im": _w(C_im),
            "log_dt": _w(log_dt),
            "Dskip": _w(Dskip),
        }
    _A_in = _A_setup()

    def _B_setup():
        B, S, D, F = 1, 2048, 576, 4608
        return {
            "x": _w((lambda *s: torch.randn(*s, dtype=torch.bfloat16) * 0.05)(B, S, D)),
            "w_gate": _w((lambda *s: torch.randn(*s, dtype=torch.bfloat16) * 0.05)(D, F)),
            "w_up": _w((lambda *s: torch.randn(*s, dtype=torch.bfloat16) * 0.05)(D, F)),
            "w_down": _w((lambda *s: torch.randn(*s, dtype=torch.bfloat16) * 0.05)(F, D)),
        }
    _B_in = _B_setup()

    return {
        "A_x": _A_in["x"],
        "A_Lambda_re": _A_in["Lambda_re"],
        "A_Lambda_im": _A_in["Lambda_im"],
        "A_B_re": _A_in["B_re"],
        "A_B_im": _A_in["B_im"],
        "A_C_re": _A_in["C_re"],
        "A_C_im": _A_in["C_im"],
        "A_log_dt": _A_in["log_dt"],
        "A_Dskip": _A_in["Dskip"],
        "B_x": _B_in["x"],
        "B_w_gate": _B_in["w_gate"],
        "B_w_up": _B_in["w_up"],
        "B_w_down": _B_in["w_down"],
    }

def reference(A_x, A_Lambda_re, A_Lambda_im, A_B_re, A_B_im, A_C_re, A_C_im, A_log_dt, A_Dskip, B_x, B_w_gate, B_w_up, B_w_down):
    def _A_ref(x, Lambda_re, Lambda_im, B_re, B_im, C_re, C_im, log_dt, Dskip):
        Bsz, L, H = x.shape
        Lam = Lambda_re + 1j * Lambda_im
        Bmat = B_re + 1j * B_im
        Cmat = C_re + 1j * C_im
        dt = torch.exp(log_dt)
        Lam_bar = torch.exp(dt * Lam)
        B_bar = ((Lam_bar - 1.0) / Lam)[:, None] * Bmat
        Bu = torch.einsum("bld,pd->blp", x + 0j, B_bar)
        h = torch.zeros_like(Bu[:, 0, :])
        hs = []
        for t in range(L):
            h = Lam_bar[None, :] * h + Bu[:, t, :]
            hs.append(h)
        hseq = torch.stack(hs, 1)
        y = 2.0 * torch.einsum("blp,dp->bld", hseq, Cmat).real + x * Dskip[None, None, :]
        return y

    def _B_ref(x, w_gate, w_up, w_down):
        g = _silu(x @ w_gate)
        u = x @ w_up
        return (g * u) @ w_down

    x = A_x
    xn = _layernorm(x, axis=-1)
    return x + _A_ref(xn, A_Lambda_re, A_Lambda_im, A_B_re, A_B_im, A_C_re, A_C_im, A_log_dt, A_Dskip) + _B_ref(xn, B_w_gate, B_w_up, B_w_down)
```

```asm
; @launch kernel=k0_kernel grid=(580,1,1) block=(256,1,1) lds=12288
; @launch kernel=k1_kernel grid=(256,1,1) block=(512,1,1) lds=108544
; @launch kernel=k2_kernel grid=(400,1,1) block=(256,1,1) lds=73728
.amdgcn_target "amdgcn-amd-amdhsa--gfx950"
.text
.globl k0_kernel
.p2align 8
.type k0_kernel,@function
k0_kernel:
    s_cmp_ge_u32 s2, 580
    s_cbranch_scc1 K0_END
    s_load_dwordx2 s[4:5], s[0:1], 0
    s_load_dwordx4 s[8:11], s[0:1], 24
    s_load_dwordx4 s[12:15], s[0:1], 40
    s_load_dwordx2 s[6:7], s[0:1], 120
    s_waitcnt lgkmcnt(0)
    s_cmp_ge_u32 s2, 256
    s_cbranch_scc1 K0_B
    s_mov_b32 s16, s4
    s_mov_b32 s17, s5
    s_mov_b32 s18, 2359296
    s_mov_b32 s19, 0x00020000
    s_add_u32 s20, s6, 0
    s_addc_u32 s21, s7, 0
    s_mov_b32 s22, 2359296
    s_mov_b32 s23, 0x00020000
    s_add_u32 s28, s6, 66060288
    s_addc_u32 s29, s7, 0
    s_mov_b32 s30, 32768
    s_mov_b32 s31, 0x00020000
    s_lshl_b32 s24, s2, 7
    v_lshlrev_b32 v1, 2, v0
    v_mov_b32 v2, 0
    v_cmp_gt_u32 vcc, 32, v0
    s_and_saveexec_b64 s[26:27], vcc
    buffer_store_dword v2, v1, s[28:31], s24 offen sc1
    s_mov_b64 exec, s[26:27]
    v_lshrrev_b32 v1, 5, v0
    v_and_b32 v2, 31, v0
    s_lshr_b32 s34, s2, 1
    s_and_b32 s35, s2, 1
    s_lshl_b32 s35, s35, 3
    v_mov_b32 v47, v1
    v_add_u32 v1, s35, v1
    s_lshr_b32 s36, s34, 5
    s_lshl_b32 s36, s36, 9
    s_and_b32 s37, s34, 31
    s_add_u32 s36, s36, s37
    v_lshl_add_u32 v1, v1, 5, s36
    v_mul_u32_u24 v3, 0x480, v1
    v_lshl_add_u32 v3, v2, 2, v3
    buffer_load_dword v10, v3, s[16:19], 0 offen offset:0
    buffer_load_dword v11, v3, s[16:19], 0 offen offset:128
    buffer_load_dword v12, v3, s[16:19], 0 offen offset:256
    buffer_load_dword v13, v3, s[16:19], 0 offen offset:384
    buffer_load_dword v14, v3, s[16:19], 0 offen offset:512
    buffer_load_dword v15, v3, s[16:19], 0 offen offset:640
    buffer_load_dword v16, v3, s[16:19], 0 offen offset:768
    buffer_load_dword v17, v3, s[16:19], 0 offen offset:896
    buffer_load_dword v18, v3, s[16:19], 0 offen offset:1024
    v_lshrrev_b32 v44, 9, v1
    v_and_b32 v45, 31, v1
    v_lshl_add_u32 v44, v44, 5, v45
    v_bfe_u32 v45, v1, 5, 4
    v_mul_u32_u24 v44, 0x4800, v44
    v_lshl_add_u32 v44, v45, 4, v44
    v_lshrrev_b32 v45, 2, v2
    v_lshl_add_u32 v44, v45, 8, v44
    v_and_b32 v45, 3, v2
    v_lshl_add_u32 v44, v45, 2, v44
    v_lshrrev_b32 v46, 2, v2
    v_lshlrev_b32 v46, 7, v46
    v_lshl_add_u32 v46, v47, 4, v46
    v_and_b32 v45, 3, v2
    v_lshl_add_u32 v46, v45, 2, v46
    s_mov_b32 s25, 0xffff0000
    s_waitcnt vmcnt(0)
    v_lshlrev_b32 v20, 16, v10
    v_and_b32 v21, s25, v10
    v_lshlrev_b32 v22, 16, v11
    v_and_b32 v23, s25, v11
    v_lshlrev_b32 v24, 16, v12
    v_and_b32 v25, s25, v12
    v_lshlrev_b32 v26, 16, v13
    v_and_b32 v27, s25, v13
    v_lshlrev_b32 v28, 16, v14
    v_and_b32 v29, s25, v14
    v_lshlrev_b32 v30, 16, v15
    v_and_b32 v31, s25, v15
    v_lshlrev_b32 v32, 16, v16
    v_and_b32 v33, s25, v16
    v_lshlrev_b32 v34, 16, v17
    v_and_b32 v35, s25, v17
    v_lshlrev_b32 v36, 16, v18
    v_and_b32 v37, s25, v18
    v_add_f32 v4, v20, v21
    v_add_f32 v5, v22, v23
    v_add_f32 v4, v4, v24
    v_add_f32 v4, v4, v25
    v_add_f32 v5, v5, v26
    v_add_f32 v5, v5, v27
    v_add_f32 v4, v4, v28
    v_add_f32 v4, v4, v29
    v_add_f32 v5, v5, v30
    v_add_f32 v5, v5, v31
    v_add_f32 v4, v4, v32
    v_add_f32 v4, v4, v33
    v_add_f32 v5, v5, v34
    v_add_f32 v5, v5, v35
    v_add_f32 v4, v4, v36
    v_add_f32 v4, v4, v37
    v_add_f32 v4, v4, v5
    ds_swizzle_b32 v9, v4 offset:1055
    s_waitcnt lgkmcnt(0)
    v_add_f32 v4, v4, v9
    ds_swizzle_b32 v9, v4 offset:2079
    s_waitcnt lgkmcnt(0)
    v_add_f32 v4, v4, v9
    ds_swizzle_b32 v9, v4 offset:4127
    s_waitcnt lgkmcnt(0)
    v_add_f32 v4, v4, v9
    ds_swizzle_b32 v9, v4 offset:8223
    s_waitcnt lgkmcnt(0)
    v_add_f32 v4, v4, v9
    ds_swizzle_b32 v9, v4 offset:16415
    s_waitcnt lgkmcnt(0)
    v_add_f32 v4, v4, v9
    v_mul_f32 v5, 0x3ae38e39, v4
    v_mov_b32 v6, 0
    v_mov_b32 v7, 0
    v_sub_f32 v8, v20, v5
    v_fma_f32 v6, v8, v8, v6
    v_sub_f32 v8, v21, v5
    v_fma_f32 v7, v8, v8, v7
    v_sub_f32 v8, v22, v5
    v_fma_f32 v6, v8, v8, v6
    v_sub_f32 v8, v23, v5
    v_fma_f32 v7, v8, v8, v7
    v_sub_f32 v8, v24, v5
    v_fma_f32 v6, v8, v8, v6
    v_sub_f32 v8, v25, v5
    v_fma_f32 v7, v8, v8, v7
    v_sub_f32 v8, v26, v5
    v_fma_f32 v6, v8, v8, v6
    v_sub_f32 v8, v27, v5
    v_fma_f32 v7, v8, v8, v7
    v_sub_f32 v8, v28, v5
    v_fma_f32 v6, v8, v8, v6
    v_sub_f32 v8, v29, v5
    v_fma_f32 v7, v8, v8, v7
    v_sub_f32 v8, v30, v5
    v_fma_f32 v6, v8, v8, v6
    v_sub_f32 v8, v31, v5
    v_fma_f32 v7, v8, v8, v7
    v_sub_f32 v8, v32, v5
    v_fma_f32 v6, v8, v8, v6
    v_sub_f32 v8, v33, v5
    v_fma_f32 v7, v8, v8, v7
    v_sub_f32 v8, v34, v5
    v_fma_f32 v6, v8, v8, v6
    v_sub_f32 v8, v35, v5
    v_fma_f32 v7, v8, v8, v7
    v_sub_f32 v8, v36, v5
    v_fma_f32 v6, v8, v8, v6
    v_sub_f32 v8, v37, v5
    v_fma_f32 v7, v8, v8, v7
    v_add_f32 v6, v6, v7
    ds_swizzle_b32 v9, v6 offset:1055
    s_waitcnt lgkmcnt(0)
    v_add_f32 v6, v6, v9
    ds_swizzle_b32 v9, v6 offset:2079
    s_waitcnt lgkmcnt(0)
    v_add_f32 v6, v6, v9
    ds_swizzle_b32 v9, v6 offset:4127
    s_waitcnt lgkmcnt(0)
    v_add_f32 v6, v6, v9
    ds_swizzle_b32 v9, v6 offset:8223
    s_waitcnt lgkmcnt(0)
    v_add_f32 v6, v6, v9
    ds_swizzle_b32 v9, v6 offset:16415
    s_waitcnt lgkmcnt(0)
    v_add_f32 v6, v6, v9
    v_mul_f32 v6, 0x3ae38e39, v6
    v_cvt_pk_bf16_f32 v7, v5, v6
    v_lshlrev_b32 v5, 16, v7
    v_and_b32 v6, s25, v7
    v_add_f32 v6, 0x3727c5ac, v6
    v_cvt_pk_bf16_f32 v7, v6, v6
    v_lshlrev_b32 v6, 16, v7
    v_sqrt_f32 v6, v6
    s_nop 0
    v_cvt_pk_bf16_f32 v7, v6, v6
    v_lshlrev_b32 v6, 16, v7
    v_rcp_f32 v8, v6
    s_nop 0
    v_sub_f32 v20, v20, v5
    v_sub_f32 v21, v21, v5
    v_cvt_pk_bf16_f32 v7, v20, v21
    v_lshlrev_b32 v20, 16, v7
    v_and_b32 v21, s25, v7
    v_mul_f32 v40, v20, v8
    v_mul_f32 v41, v21, v8
    v_fma_f32 v42, -v40, v6, v20
    v_fma_f32 v43, -v41, v6, v21
    v_fma_f32 v40, v42, v8, v40
    v_fma_f32 v41, v43, v8, v41
    v_cvt_pk_bf16_f32 v10, v40, v41
    ds_write_b32 v46, v10 offset:0
    v_sub_f32 v22, v22, v5
    v_sub_f32 v23, v23, v5
    v_cvt_pk_bf16_f32 v7, v22, v23
    v_lshlrev_b32 v22, 16, v7
    v_and_b32 v23, s25, v7
    v_mul_f32 v40, v22, v8
    v_mul_f32 v41, v23, v8
    v_fma_f32 v42, -v40, v6, v22
    v_fma_f32 v43, -v41, v6, v23
    v_fma_f32 v40, v42, v8, v40
    v_fma_f32 v41, v43, v8, v41
    v_cvt_pk_bf16_f32 v11, v40, v41
    ds_write_b32 v46, v11 offset:1024
    v_sub_f32 v24, v24, v5
    v_sub_f32 v25, v25, v5
    v_cvt_pk_bf16_f32 v7, v24, v25
    v_lshlrev_b32 v24, 16, v7
    v_and_b32 v25, s25, v7
    v_mul_f32 v40, v24, v8
    v_mul_f32 v41, v25, v8
    v_fma_f32 v42, -v40, v6, v24
    v_fma_f32 v43, -v41, v6, v25
    v_fma_f32 v40, v42, v8, v40
    v_fma_f32 v41, v43, v8, v41
    v_cvt_pk_bf16_f32 v12, v40, v41
    ds_write_b32 v46, v12 offset:2048
    v_sub_f32 v26, v26, v5
    v_sub_f32 v27, v27, v5
    v_cvt_pk_bf16_f32 v7, v26, v27
    v_lshlrev_b32 v26, 16, v7
    v_and_b32 v27, s25, v7
    v_mul_f32 v40, v26, v8
    v_mul_f32 v41, v27, v8
    v_fma_f32 v42, -v40, v6, v26
    v_fma_f32 v43, -v41, v6, v27
    v_fma_f32 v40, v42, v8, v40
    v_fma_f32 v41, v43, v8, v41
    v_cvt_pk_bf16_f32 v13, v40, v41
    ds_write_b32 v46, v13 offset:3072
    v_sub_f32 v28, v28, v5
    v_sub_f32 v29, v29, v5
    v_cvt_pk_bf16_f32 v7, v28, v29
    v_lshlrev_b32 v28, 16, v7
    v_and_b32 v29, s25, v7
    v_mul_f32 v40, v28, v8
    v_mul_f32 v41, v29, v8
    v_fma_f32 v42, -v40, v6, v28
    v_fma_f32 v43, -v41, v6, v29
    v_fma_f32 v40, v42, v8, v40
    v_fma_f32 v41, v43, v8, v41
    v_cvt_pk_bf16_f32 v14, v40, v41
    ds_write_b32 v46, v14 offset:4096
    v_sub_f32 v30, v30, v5
    v_sub_f32 v31, v31, v5
    v_cvt_pk_bf16_f32 v7, v30, v31
    v_lshlrev_b32 v30, 16, v7
    v_and_b32 v31, s25, v7
    v_mul_f32 v40, v30, v8
    v_mul_f32 v41, v31, v8
    v_fma_f32 v42, -v40, v6, v30
    v_fma_f32 v43, -v41, v6, v31
    v_fma_f32 v40, v42, v8, v40
    v_fma_f32 v41, v43, v8, v41
    v_cvt_pk_bf16_f32 v15, v40, v41
    ds_write_b32 v46, v15 offset:5120
    v_sub_f32 v32, v32, v5
    v_sub_f32 v33, v33, v5
    v_cvt_pk_bf16_f32 v7, v32, v33
    v_lshlrev_b32 v32, 16, v7
    v_and_b32 v33, s25, v7
    v_mul_f32 v40, v32, v8
    v_mul_f32 v41, v33, v8
    v_fma_f32 v42, -v40, v6, v32
    v_fma_f32 v43, -v41, v6, v33
    v_fma_f32 v40, v42, v8, v40
    v_fma_f32 v41, v43, v8, v41
    v_cvt_pk_bf16_f32 v16, v40, v41
    ds_write_b32 v46, v16 offset:6144
    v_sub_f32 v34, v34, v5
    v_sub_f32 v35, v35, v5
    v_cvt_pk_bf16_f32 v7, v34, v35
    v_lshlrev_b32 v34, 16, v7
    v_and_b32 v35, s25, v7
    v_mul_f32 v40, v34, v8
    v_mul_f32 v41, v35, v8
    v_fma_f32 v42, -v40, v6, v34
    v_fma_f32 v43, -v41, v6, v35
    v_fma_f32 v40, v42, v8, v40
    v_fma_f32 v41, v43, v8, v41
    v_cvt_pk_bf16_f32 v17, v40, v41
    ds_write_b32 v46, v17 offset:7168
    v_sub_f32 v36, v36, v5
    v_sub_f32 v37, v37, v5
    v_cvt_pk_bf16_f32 v7, v36, v37
    v_lshlrev_b32 v36, 16, v7
    v_and_b32 v37, s25, v7
    v_mul_f32 v40, v36, v8
    v_mul_f32 v41, v37, v8
    v_fma_f32 v42, -v40, v6, v36
    v_fma_f32 v43, -v41, v6, v37
    v_fma_f32 v40, v42, v8, v40
    v_fma_f32 v41, v43, v8, v41
    v_cvt_pk_bf16_f32 v18, v40, v41
    ds_write_b32 v46, v18 offset:8192
    s_waitcnt lgkmcnt(0)
    s_barrier
    s_mul_i32 s36, s34, 18432
    s_lshl_b32 s37, s35, 4
    s_add_u32 s36, s36, s37
    v_lshlrev_b32 v4, 4, v0
    v_lshrrev_b32 v5, 3, v0
    v_lshlrev_b32 v5, 8, v5
    v_and_b32 v6, 7, v0
    v_lshl_add_u32 v5, v6, 4, v5
    ds_read_b128 v[48:51], v4 offset:0
    ds_read_b128 v[52:55], v4 offset:4096
    ds_read_b128 v[56:59], v4 offset:8192
    s_waitcnt lgkmcnt(0)
    s_add_u32 s37, s36, 0
    buffer_store_dwordx4 v[48:51], v5, s[20:23], s37 offen sc1
    s_add_u32 s37, s36, 8192
    buffer_store_dwordx4 v[52:55], v5, s[20:23], s37 offen sc1
    v_cmp_gt_u32 vcc, 64, v0
    s_and_b64 exec, exec, vcc
    s_cbranch_execz K0_END
    s_add_u32 s37, s36, 16384
    buffer_store_dwordx4 v[56:59], v5, s[20:23], s37 offen sc1
    s_endpgm
K0_B:
    s_cmp_ge_u32 s2, 418
    s_cbranch_scc1 K0_C
    s_mov_b32 s16, s8
    s_mov_b32 s17, s9
    s_mov_b32 s18, 663552
    s_mov_b32 s19, 0x00020000
    s_mov_b32 s20, s10
    s_mov_b32 s21, s11
    s_mov_b32 s22, 663552
    s_mov_b32 s23, 0x00020000
    s_add_u32 s24, s6, 4194304
    s_addc_u32 s25, s7, 0
    s_mov_b32 s26, 5308416
    s_mov_b32 s27, 0x00020000
    s_sub_u32 s28, s2, 256
    s_mul_i32 s29, s28, 57
    s_lshr_b32 s29, s29, 9
    s_mul_i32 s30, s29, 9
    s_sub_u32 s30, s28, s30
    v_lshrrev_b32 v1, 6, v0
    v_and_b32 v2, 63, v0
    s_lshl_b32 s29, s29, 2
    v_add_u32 v1, s29, v1
    s_lshl_b32 s30, s30, 6
    v_add_u32 v2, s30, v2
    v_mul_u32_u24 v3, 0x480, v2
    v_lshl_add_u32 v3, v1, 4, v3
    buffer_load_dwordx4 v[8:11], v3, s[16:19], 0 offen
    buffer_load_dwordx4 v[12:15], v3, s[20:23], 0 offen
    v_mul_u32_u24 v4, 0x12000, v1
    v_lshl_add_u32 v4, v2, 2, v4
    s_mov_b32 s31, 0x05040100
    s_mov_b32 s32, 0x07060302
    s_mov_b32 s33, 9216
    s_waitcnt vmcnt(0)
    v_perm_b32 v16, v12, v8, s31
    v_perm_b32 v17, v12, v8, s32
    v_perm_b32 v18, v13, v9, s31
    v_perm_b32 v19, v13, v9, s32
    v_perm_b32 v20, v14, v10, s31
    v_perm_b32 v21, v14, v10, s32
    v_perm_b32 v22, v15, v11, s31
    v_perm_b32 v23, v15, v11, s32
    v_lshrrev_b32 v5, 6, v0
    v_lshlrev_b32 v5, 11, v5
    v_and_b32 v6, 63, v0
    v_lshl_add_u32 v7, v6, 2, v5
    ds_write_b32 v7, v16 offset:0
    ds_write_b32 v7, v17 offset:256
    ds_write_b32 v7, v18 offset:512
    ds_write_b32 v7, v19 offset:768
    ds_write_b32 v7, v20 offset:1024
    ds_write_b32 v7, v21 offset:1280
    ds_write_b32 v7, v22 offset:1536
    ds_write_b32 v7, v23 offset:1792
    v_lshl_add_u32 v7, v6, 4, v5
    s_waitcnt lgkmcnt(0)
    ds_read_b128 v[24:27], v7
    ds_read_b128 v[28:31], v7 offset:1024
    v_mul_u32_u24 v4, 0x12000, v1
    v_lshrrev_b32 v5, 4, v6
    v_mul_u32_u24 v5, 0x2400, v5
    v_add_u32 v4, v4, v5
    v_and_b32 v5, 15, v6
    v_lshl_add_u32 v4, v5, 4, v4
    s_lshl_b32 s34, s30, 2
    s_add_u32 s35, s34, 36864
    s_waitcnt lgkmcnt(0)
    buffer_store_dwordx4 v[24:27], v4, s[24:27], s34 offen sc1
    buffer_store_dwordx4 v[28:31], v4, s[24:27], s35 offen sc1
    s_endpgm
K0_C:
    s_mov_b32 s16, s12
    s_mov_b32 s17, s13
    s_mov_b32 s18, 663552
    s_mov_b32 s19, 0x00020000
    s_mov_b32 s20, s14
    s_mov_b32 s21, s15
    s_mov_b32 s22, 663552
    s_mov_b32 s23, 0x00020000
    s_add_u32 s24, s6, 2359296
    s_addc_u32 s25, s7, 0
    s_mov_b32 s26, 1327104
    s_mov_b32 s27, 0x00020000
    v_lshrrev_b32 v1, 6, v0
    s_nop 0
    v_readfirstlane_b32 s29, v1
    s_sub_u32 s28, s2, 418
    s_lshl_b32 s28, s28, 2
    s_add_u32 s28, s28, s29
    s_mul_i32 s29, s28, 3641
    s_lshr_b32 s29, s29, 16
    s_mul_i32 s30, s29, 18
    s_sub_u32 s30, s28, s30
    v_and_b32 v1, 15, v0
    v_bfe_u32 v2, v0, 4, 2
    s_lshl_b32 s31, s30, 2
    v_add_u32 v2, s31, v2
    s_lshl_b32 s31, s29, 4
    v_add_u32 v3, s31, v1
    v_mul_u32_u24 v3, 0x480, v3
    v_lshl_add_u32 v3, v2, 4, v3
    buffer_load_dwordx4 v[8:11], v3, s[16:19], 0 offen
    buffer_load_dwordx4 v[12:15], v3, s[20:23], 0 offen
    s_mul_i32 s31, s29, 36864
    v_lshlrev_b32 v4, 9, v2
    v_lshl_add_u32 v4, v1, 4, v4
    v_add_u32 v4, s31, v4
    s_mov_b32 s31, 0x05040100
    s_mov_b32 s32, 0x07060302
    s_waitcnt vmcnt(0)
    v_perm_b32 v16, v12, v8, s31
    v_perm_b32 v17, v12, v8, s32
    v_perm_b32 v18, v13, v9, s31
    v_perm_b32 v19, v13, v9, s32
    v_perm_b32 v20, v14, v10, s31
    v_perm_b32 v21, v14, v10, s32
    v_perm_b32 v22, v15, v11, s31
    v_perm_b32 v23, v15, v11, s32
    buffer_store_dwordx4 v[16:19], v4, s[24:27], 0 offen sc1
    buffer_store_dwordx4 v[20:23], v4, s[24:27], 0 offen offset:256 sc1
K0_END:
    s_endpgm
.globl k1_kernel
.p2align 8
.type k1_kernel,@function
k1_kernel:
    s_cmp_ge_u32 s2, 256
    s_cbranch_scc1 K1_END
    s_load_dwordx4 s[4:7], s[0:1], 80
    s_load_dwordx2 s[30:31], s[0:1], 120
    s_load_dwordx2 s[28:29], s[0:1], 96
    v_lshrrev_b32 v10, 6, v0
    s_nop 0
    v_readfirstlane_b32 s32, v10
    s_and_b32 s33, s2, 7
    s_lshr_b32 s34, s2, 3
    s_and_b32 s35, s34, 3
    s_lshl_b32 s36, s33, 2
    s_add_u32 s36, s36, s35
    s_lshr_b32 s37, s34, 2
    s_mul_i32 s38, s33, 3
    s_min_u32 s39, s35, 2
    s_add_u32 s38, s38, s39
    s_waitcnt lgkmcnt(0)
    s_add_u32 s8, s30, 0
    s_addc_u32 s9, s31, 0
    s_mov_b32 s10, 2359296
    s_mov_b32 s11, 0x00020000
    s_add_u32 s16, s30, 10485760
    s_addc_u32 s17, s31, 0
    s_mov_b32 s18, 18874368
    s_mov_b32 s19, 0x00020000
    s_add_u32 s20, s30, 29360128
    s_addc_u32 s21, s31, 0
    s_mov_b32 s22, 9437184
    s_mov_b32 s23, 0x00020000
    s_cmp_lt_u32 s35, 3
    s_cselect_b32 s22, 9437184, 0
    s_add_u32 s24, s30, 4194304
    s_addc_u32 s25, s31, 0
    s_cmp_lt_u32 s35, 3
    s_cselect_b32 s26, 5308416, 0
    s_cmp_lt_u32 s32, 4
    s_cselect_b32 s26, s26, 0
    s_cselect_b32 s12, s4, s6
    s_cselect_b32 s13, s5, s7
    s_mov_b32 s14, 5308416
    s_mov_b32 s15, 0x00020000
    v_and_b32 v10, 63, v0
    v_lshrrev_b32 v11, 4, v10
    v_and_b32 v12, 15, v10
    s_lshl_b32 s39, s37, 4
    s_lshl_b32 s40, s32, 1
    s_add_u32 s39, s39, s40
    v_lshlrev_b32 v14, 4, v10
    s_mul_i32 s40, s39, 18432
    s_mul_i32 s41, s36, 288
    s_mul_i32 s44, s38, 96
    v_lshrrev_b32 v16, 1, v11
    v_and_b32 v17, 1, v11
    v_lshlrev_b32 v16, 4, v16
    v_lshl_add_u32 v16, v17, 2, v16
    v_bfe_u32 v17, v10, 2, 2
    v_add_u32 v16, v16, v17
    v_mul_u32_u24 v16, 96, v16
    v_and_b32 v17, 3, v10
    v_lshl_add_u32 v1, v17, 3, v16
    v_add_u32 v2, 49152, v1
    s_and_b32 s45, s32, 3
    s_mul_i32 s46, s45, 96
    v_add_u32 v16, s46, v10
    v_mul_u32_u24 v17, 171, v16
    v_lshrrev_b32 v17, 10, v17
    v_mul_u32_u24 v18, 6, v17
    v_sub_u32 v18, v16, v18
    v_and_b32 v19, 0x33, v17
    v_bfe_u32 v20, v17, 2, 1
    v_lshl_add_u32 v19, v20, 3, v19
    v_bfe_u32 v20, v17, 3, 1
    v_lshl_add_u32 v19, v20, 2, v19
    v_mul_u32_u24 v19, 0x2400, v19
    v_lshl_add_u32 v3, v18, 4, v19
    v_add_u32 v16, s46, v10
    v_add_u32 v16, 64, v16
    v_mul_u32_u24 v17, 171, v16
    v_lshrrev_b32 v17, 10, v17
    v_mul_u32_u24 v18, 6, v17
    v_sub_u32 v18, v16, v18
    v_and_b32 v19, 0x33, v17
    v_bfe_u32 v20, v17, 2, 1
    v_lshl_add_u32 v19, v20, 3, v19
    v_bfe_u32 v20, v17, 3, 1
    v_lshl_add_u32 v19, v20, 2, v19
    v_mul_u32_u24 v19, 0x2400, v19
    v_lshl_add_u32 v4, v18, 4, v19
    s_lshr_b32 s47, s32, 2
    s_mul_i32 s47, s47, 6144
    s_mul_i32 s48, s45, 1536
    s_add_u32 s47, s47, s48
    s_mul_i32 s42, s39, 147456
    s_mul_i32 s43, s36, 4608
    s_add_u32 s42, s42, s43
    v_lshrrev_b32 v16, 1, v11
    v_lshlrev_b32 v16, 8, v16
    v_lshl_add_u32 v16, v12, 4, v16
    v_and_b32 v17, 1, v11
    v_lshl_add_u32 v16, v17, 3, v16
    v_add_u32 v5, s42, v16
    s_mul_i32 s42, s39, 72
    s_mul_i32 s43, s38, 3
    s_add_u32 s42, s42, s43
    s_lshl_b32 s42, s42, 10
    v_add_u32 v0, s42, v14
    s_mov_b32 s50, 0xffff0000
    s_mov_b32 s51, 73728
    s_mov_b32 s4, s28
    s_mov_b32 s5, s29
    s_mov_b32 s6, 5308416
    s_mov_b32 s7, 0x00020000
    s_lshr_b32 s27, s33, 1
    s_mul_i32 s27, s27, 1327104
    s_mul_i32 s56, s34, 41472
    s_add_u32 s27, s27, s56
    s_mul_i32 s56, s32, 5184
    s_add_u32 s27, s27, s56
    s_lshl_b32 s57, s32, 10
    v_lshlrev_b32 v31, 4, v10
    s_mul_i32 s53, s35, 2
    s_lshr_b32 s54, s37, 0
    s_add_u32 s53, s53, s54
    s_cmp_ge_u32 s53, 9
    s_cselect_b32 s54, 9, 0
    s_sub_u32 s53, s53, s54
    s_add_u32 s54, s53, 0
    s_cmp_ge_u32 s54, 9
    s_cselect_b32 s55, 9, 0
    s_sub_u32 s54, s54, s55
    s_mul_i32 s60, s54, 589824
    s_lshl_b32 s70, s54, 11
    s_add_u32 s70, s70, s40
    s_add_u32 s54, s53, 1
    s_cmp_ge_u32 s54, 9
    s_cselect_b32 s55, 9, 0
    s_sub_u32 s54, s54, s55
    s_mul_i32 s61, s54, 589824
    s_lshl_b32 s71, s54, 11
    s_add_u32 s71, s71, s40
    s_add_u32 s54, s53, 2
    s_cmp_ge_u32 s54, 9
    s_cselect_b32 s55, 9, 0
    s_sub_u32 s54, s54, s55
    s_mul_i32 s62, s54, 589824
    s_lshl_b32 s72, s54, 11
    s_add_u32 s72, s72, s40
    s_add_u32 s54, s53, 3
    s_cmp_ge_u32 s54, 9
    s_cselect_b32 s55, 9, 0
    s_sub_u32 s54, s54, s55
    s_mul_i32 s63, s54, 589824
    s_lshl_b32 s73, s54, 11
    s_add_u32 s73, s73, s40
    s_add_u32 s54, s53, 4
    s_cmp_ge_u32 s54, 9
    s_cselect_b32 s55, 9, 0
    s_sub_u32 s54, s54, s55
    s_mul_i32 s64, s54, 589824
    s_lshl_b32 s74, s54, 11
    s_add_u32 s74, s74, s40
    s_add_u32 s54, s53, 5
    s_cmp_ge_u32 s54, 9
    s_cselect_b32 s55, 9, 0
    s_sub_u32 s54, s54, s55
    s_mul_i32 s65, s54, 589824
    s_lshl_b32 s75, s54, 11
    s_add_u32 s75, s75, s40
    s_add_u32 s54, s53, 6
    s_cmp_ge_u32 s54, 9
    s_cselect_b32 s55, 9, 0
    s_sub_u32 s54, s54, s55
    s_mul_i32 s66, s54, 589824
    s_lshl_b32 s76, s54, 11
    s_add_u32 s76, s76, s40
    s_add_u32 s54, s53, 7
    s_cmp_ge_u32 s54, 9
    s_cselect_b32 s55, 9, 0
    s_sub_u32 s54, s54, s55
    s_mul_i32 s67, s54, 589824
    s_lshl_b32 s77, s54, 11
    s_add_u32 s77, s77, s40
    s_add_u32 s54, s53, 8
    s_cmp_ge_u32 s54, 9
    s_cselect_b32 s55, 9, 0
    s_sub_u32 s54, s54, s55
    s_mul_i32 s68, s54, 589824
    s_lshl_b32 s78, s54, 11
    s_add_u32 s78, s78, s40
    s_add_u32 s49, s41, s60
    s_add_u32 m0, s47, 0
    s_nop 0
    buffer_load_dwordx4 v3, s[12:15], s49 offen lds
    s_add_u32 s49, s41, s60
    s_mov_b32 exec_hi, 0
    s_add_u32 m0, s47, 1024
    s_nop 0
    buffer_load_dwordx4 v4, s[12:15], s49 offen lds
    s_mov_b32 exec_hi, -1
    s_add_u32 s49, s70, 0
    buffer_load_dwordx4 v[112:115], v14, s[8:11], s49 offen
    s_add_u32 s49, s70, 18432
    buffer_load_dwordx4 v[184:187], v14, s[8:11], s49 offen
    s_add_u32 s49, s70, 1024
    buffer_load_dwordx4 v[116:119], v14, s[8:11], s49 offen
    s_add_u32 s49, s70, 19456
    buffer_load_dwordx4 v[188:191], v14, s[8:11], s49 offen
    s_add_u32 s49, s41, s61
    s_add_u32 m0, s47, 12288
    s_nop 0
    buffer_load_dwordx4 v3, s[12:15], s49 offen lds
    s_add_u32 s49, s41, s61
    s_mov_b32 exec_hi, 0
    s_add_u32 m0, s47, 13312
    s_nop 0
    buffer_load_dwordx4 v4, s[12:15], s49 offen lds
    s_mov_b32 exec_hi, -1
    s_add_u32 s49, s71, 0
    buffer_load_dwordx4 v[120:123], v14, s[8:11], s49 offen
    s_add_u32 s49, s71, 18432
    buffer_load_dwordx4 v[192:195], v14, s[8:11], s49 offen
    s_add_u32 s49, s71, 1024
    buffer_load_dwordx4 v[124:127], v14, s[8:11], s49 offen
    s_add_u32 s49, s71, 19456
    buffer_load_dwordx4 v[196:199], v14, s[8:11], s49 offen
    s_waitcnt vmcnt(4)
    s_barrier
    ds_read_b64_tr_b16 v[40:41], v1 offset:0
    ds_read_b64_tr_b16 v[42:43], v1 offset:768
    ds_read_b64_tr_b16 v[44:45], v1 offset:32
    ds_read_b64_tr_b16 v[46:47], v1 offset:800
    ds_read_b64_tr_b16 v[48:49], v1 offset:64
    ds_read_b64_tr_b16 v[50:51], v1 offset:832
    ds_read_b64_tr_b16 v[52:53], v1 offset:6144
    ds_read_b64_tr_b16 v[54:55], v1 offset:6912
    ds_read_b64_tr_b16 v[56:57], v1 offset:6176
    ds_read_b64_tr_b16 v[58:59], v1 offset:6944
    ds_read_b64_tr_b16 v[60:61], v1 offset:6208
    ds_read_b64_tr_b16 v[62:63], v1 offset:6976
    s_waitcnt lgkmcnt(10)
    v_mfma_f32_16x16x32_bf16 v[64:67], v[40:43], v[112:115], 0
    s_add_u32 s49, s41, s62
    s_add_u32 m0, s47, 24576
    s_nop 0
    buffer_load_dwordx4 v3, s[12:15], s49 offen lds
    v_mfma_f32_16x16x32_bf16 v[76:79], v[40:43], v[184:187], 0
    ds_read_b64_tr_b16 v[40:41], v1 offset:3072
    ds_read_b64_tr_b16 v[42:43], v1 offset:3840
    s_waitcnt lgkmcnt(10)
    v_mfma_f32_16x16x32_bf16 v[68:71], v[44:47], v[112:115], 0
    v_mfma_f32_16x16x32_bf16 v[80:83], v[44:47], v[184:187], 0
    s_add_u32 s49, s41, s62
    s_mov_b32 exec_hi, 0
    s_add_u32 m0, s47, 25600
    s_nop 0
    buffer_load_dwordx4 v4, s[12:15], s49 offen lds
    s_mov_b32 exec_hi, -1
    ds_read_b64_tr_b16 v[44:45], v1 offset:3104
    ds_read_b64_tr_b16 v[46:47], v1 offset:3872
    s_waitcnt lgkmcnt(10)
    v_mfma_f32_16x16x32_bf16 v[72:75], v[48:51], v[112:115], 0
    v_mfma_f32_16x16x32_bf16 v[84:87], v[48:51], v[184:187], 0
    ds_read_b64_tr_b16 v[48:49], v1 offset:3136
    ds_read_b64_tr_b16 v[50:51], v1 offset:3904
    s_waitcnt lgkmcnt(10)
    v_mfma_f32_16x16x32_bf16 v[88:91], v[52:55], v[112:115], 0
    v_mfma_f32_16x16x32_bf16 v[100:103], v[52:55], v[184:187], 0
    s_add_u32 s49, s72, 0
    buffer_load_dwordx4 v[128:131], v14, s[8:11], s49 offen
    ds_read_b64_tr_b16 v[52:53], v1 offset:9216
    ds_read_b64_tr_b16 v[54:55], v1 offset:9984
    s_waitcnt lgkmcnt(10)
    v_mfma_f32_16x16x32_bf16 v[92:95], v[56:59], v[112:115], 0
    v_mfma_f32_16x16x32_bf16 v[104:107], v[56:59], v[184:187], 0
    ds_read_b64_tr_b16 v[56:57], v1 offset:9248
    ds_read_b64_tr_b16 v[58:59], v1 offset:10016
    s_waitcnt lgkmcnt(10)
    v_mfma_f32_16x16x32_bf16 v[96:99], v[60:63], v[112:115], 0
    v_mfma_f32_16x16x32_bf16 v[108:111], v[60:63], v[184:187], 0
    s_add_u32 s49, s72, 18432
    buffer_load_dwordx4 v[200:203], v14, s[8:11], s49 offen
    ds_read_b64_tr_b16 v[60:61], v1 offset:9280
    ds_read_b64_tr_b16 v[62:63], v1 offset:10048
    s_waitcnt lgkmcnt(10)
    v_mfma_f32_16x16x32_bf16 v[64:67], v[40:43], v[116:119], v[64:67]
    v_mfma_f32_16x16x32_bf16 v[76:79], v[40:43], v[188:191], v[76:79]
    ds_read_b64_tr_b16 v[40:41], v1 offset:12288
    ds_read_b64_tr_b16 v[42:43], v1 offset:13056
    s_waitcnt lgkmcnt(10)
    v_mfma_f32_16x16x32_bf16 v[68:71], v[44:47], v[116:119], v[68:71]
    s_add_u32 s49, s72, 1024
    buffer_load_dwordx4 v[132:135], v14, s[8:11], s49 offen
    v_mfma_f32_16x16x32_bf16 v[80:83], v[44:47], v[188:191], v[80:83]
    ds_read_b64_tr_b16 v[44:45], v1 offset:12320
    ds_read_b64_tr_b16 v[46:47], v1 offset:13088
    s_waitcnt lgkmcnt(10)
    v_mfma_f32_16x16x32_bf16 v[72:75], v[48:51], v[116:119], v[72:75]
    v_mfma_f32_16x16x32_bf16 v[84:87], v[48:51], v[188:191], v[84:87]
    ds_read_b64_tr_b16 v[48:49], v1 offset:12352
    ds_read_b64_tr_b16 v[50:51], v1 offset:13120
    s_waitcnt lgkmcnt(10)
    v_mfma_f32_16x16x32_bf16 v[88:91], v[52:55], v[116:119], v[88:91]
    s_add_u32 s49, s72, 19456
    buffer_load_dwordx4 v[204:207], v14, s[8:11], s49 offen
    v_mfma_f32_16x16x32_bf16 v[100:103], v[52:55], v[188:191], v[100:103]
    ds_read_b64_tr_b16 v[52:53], v1 offset:18432
    ds_read_b64_tr_b16 v[54:55], v1 offset:19200
    s_waitcnt lgkmcnt(10)
    v_mfma_f32_16x16x32_bf16 v[92:95], v[56:59], v[116:119], v[92:95]
    v_mfma_f32_16x16x32_bf16 v[104:107], v[56:59], v[188:191], v[104:107]
    ds_read_b64_tr_b16 v[56:57], v1 offset:18464
    ds_read_b64_tr_b16 v[58:59], v1 offset:19232
    s_waitcnt lgkmcnt(10)
    v_mfma_f32_16x16x32_bf16 v[96:99], v[60:63], v[116:119], v[96:99]
    v_mfma_f32_16x16x32_bf16 v[108:111], v[60:63], v[188:191], v[108:111]
    ds_read_b64_tr_b16 v[60:61], v1 offset:18496
    ds_read_b64_tr_b16 v[62:63], v1 offset:19264
    s_waitcnt vmcnt(4)
    s_barrier
    s_waitcnt lgkmcnt(10)
    v_mfma_f32_16x16x32_bf16 v[64:67], v[40:43], v[120:123], v[64:67]
    s_add_u32 s49, s41, s63
    s_add_u32 m0, s47, 36864
    s_nop 0
    buffer_load_dwordx4 v3, s[12:15], s49 offen lds
    v_mfma_f32_16x16x32_bf16 v[76:79], v[40:43], v[192:195], v[76:79]
    ds_read_b64_tr_b16 v[40:41], v1 offset:15360
    ds_read_b64_tr_b16 v[42:43], v1 offset:16128
    s_waitcnt lgkmcnt(10)
    v_mfma_f32_16x16x32_bf16 v[68:71], v[44:47], v[120:123], v[68:71]
    v_mfma_f32_16x16x32_bf16 v[80:83], v[44:47], v[192:195], v[80:83]
    s_add_u32 s49, s41, s63
    s_mov_b32 exec_hi, 0
    s_add_u32 m0, s47, 37888
    s_nop 0
    buffer_load_dwordx4 v4, s[12:15], s49 offen lds
    s_mov_b32 exec_hi, -1
    ds_read_b64_tr_b16 v[44:45], v1 offset:15392
    ds_read_b64_tr_b16 v[46:47], v1 offset:16160
    s_waitcnt lgkmcnt(10)
    v_mfma_f32_16x16x32_bf16 v[72:75], v[48:51], v[120:123], v[72:75]
    v_mfma_f32_16x16x32_bf16 v[84:87], v[48:51], v[192:195], v[84:87]
    ds_read_b64_tr_b16 v[48:49], v1 offset:15424
    ds_read_b64_tr_b16 v[50:51], v1 offset:16192
    s_waitcnt lgkmcnt(10)
    v_mfma_f32_16x16x32_bf16 v[88:91], v[52:55], v[120:123], v[88:91]
    v_mfma_f32_16x16x32_bf16 v[100:103], v[52:55], v[192:195], v[100:103]
    s_add_u32 s49, s73, 0
    buffer_load_dwordx4 v[136:139], v14, s[8:11], s49 offen
    ds_read_b64_tr_b16 v[52:53], v1 offset:21504
    ds_read_b64_tr_b16 v[54:55], v1 offset:22272
    s_waitcnt lgkmcnt(10)
    v_mfma_f32_16x16x32_bf16 v[92:95], v[56:59], v[120:123], v[92:95]
    v_mfma_f32_16x16x32_bf16 v[104:107], v[56:59], v[192:195], v[104:107]
    ds_read_b64_tr_b16 v[56:57], v1 offset:21536
    ds_read_b64_tr_b16 v[58:59], v1 offset:22304
    s_waitcnt lgkmcnt(10)
    v_mfma_f32_16x16x32_bf16 v[96:99], v[60:63], v[120:123], v[96:99]
    v_mfma_f32_16x16x32_bf16 v[108:111], v[60:63], v[192:195], v[108:111]
    s_add_u32 s49, s73, 18432
    buffer_load_dwordx4 v[208:211], v14, s[8:11], s49 offen
    ds_read_b64_tr_b16 v[60:61], v1 offset:21568
    ds_read_b64_tr_b16 v[62:63], v1 offset:22336
    s_waitcnt lgkmcnt(10)
    v_mfma_f32_16x16x32_bf16 v[64:67], v[40:43], v[124:127], v[64:67]
    v_mfma_f32_16x16x32_bf16 v[76:79], v[40:43], v[196:199], v[76:79]
    ds_read_b64_tr_b16 v[40:41], v1 offset:24576
    ds_read_b64_tr_b16 v[42:43], v1 offset:25344
    s_waitcnt lgkmcnt(10)
    v_mfma_f32_16x16x32_bf16 v[68:71], v[44:47], v[124:127], v[68:71]
    s_add_u32 s49, s73, 1024
    buffer_load_dwordx4 v[140:143], v14, s[8:11], s49 offen
    v_mfma_f32_16x16x32_bf16 v[80:83], v[44:47], v[196:199], v[80:83]
    ds_read_b64_tr_b16 v[44:45], v1 offset:24608
    ds_read_b64_tr_b16 v[46:47], v1 offset:25376
    s_waitcnt lgkmcnt(10)
    v_mfma_f32_16x16x32_bf16 v[72:75], v[48:51], v[124:127], v[72:75]
    v_mfma_f32_16x16x32_bf16 v[84:87], v[48:51], v[196:199], v[84:87]
    ds_read_b64_tr_b16 v[48:49], v1 offset:24640
    ds_read_b64_tr_b16 v[50:51], v1 offset:25408
    s_waitcnt lgkmcnt(10)
    v_mfma_f32_16x16x32_bf16 v[88:91], v[52:55], v[124:127], v[88:91]
    s_add_u32 s49, s73, 19456
    buffer_load_dwordx4 v[212:215], v14, s[8:11], s49 offen
    v_mfma_f32_16x16x32_bf16 v[100:103], v[52:55], v[196:199], v[100:103]
    ds_read_b64_tr_b16 v[52:53], v1 offset:30720
    ds_read_b64_tr_b16 v[54:55], v1 offset:31488
    s_waitcnt lgkmcnt(10)
    v_mfma_f32_16x16x32_bf16 v[92:95], v[56:59], v[124:127], v[92:95]
    v_mfma_f32_16x16x32_bf16 v[104:107], v[56:59], v[196:199], v[104:107]
    ds_read_b64_tr_b16 v[56:57], v1 offset:30752
    ds_read_b64_tr_b16 v[58:59], v1 offset:31520
    s_waitcnt lgkmcnt(10)
    v_mfma_f32_16x16x32_bf16 v[96:99], v[60:63], v[124:127], v[96:99]
    v_mfma_f32_16x16x32_bf16 v[108:111], v[60:63], v[196:199], v[108:111]
    ds_read_b64_tr_b16 v[60:61], v1 offset:30784
    ds_read_b64_tr_b16 v[62:63], v1 offset:31552
    s_waitcnt vmcnt(4)
    s_barrier
    s_waitcnt lgkmcnt(10)
    v_mfma_f32_16x16x32_bf16 v[64:67], v[40:43], v[128:131], v[64:67]
    s_add_u32 s49, s41, s64
    s_add_u32 m0, s47, 49152
    s_nop 0
    buffer_load_dwordx4 v3, s[12:15], s49 offen lds
    v_mfma_f32_16x16x32_bf16 v[76:79], v[40:43], v[200:203], v[76:79]
    ds_read_b64_tr_b16 v[40:41], v1 offset:27648
    ds_read_b64_tr_b16 v[42:43], v1 offset:28416
    s_waitcnt lgkmcnt(10)
    v_mfma_f32_16x16x32_bf16 v[68:71], v[44:47], v[128:131], v[68:71]
    v_mfma_f32_16x16x32_bf16 v[80:83], v[44:47], v[200:203], v[80:83]
    s_add_u32 s49, s41, s64
    s_mov_b32 exec_hi, 0
    s_add_u32 m0, s47, 50176
    s_nop 0
    buffer_load_dwordx4 v4, s[12:15], s49 offen lds
    s_mov_b32 exec_hi, -1
    ds_read_b64_tr_b16 v[44:45], v1 offset:27680
    ds_read_b64_tr_b16 v[46:47], v1 offset:28448
    s_waitcnt lgkmcnt(10)
    v_mfma_f32_16x16x32_bf16 v[72:75], v[48:51], v[128:131], v[72:75]
    v_mfma_f32_16x16x32_bf16 v[84:87], v[48:51], v[200:203], v[84:87]
    ds_read_b64_tr_b16 v[48:49], v1 offset:27712
    ds_read_b64_tr_b16 v[50:51], v1 offset:28480
    s_waitcnt lgkmcnt(10)
    v_mfma_f32_16x16x32_bf16 v[88:91], v[52:55], v[128:131], v[88:91]
    v_mfma_f32_16x16x32_bf16 v[100:103], v[52:55], v[200:203], v[100:103]
    s_add_u32 s49, s74, 0
    buffer_load_dwordx4 v[144:147], v14, s[8:11], s49 offen
    ds_read_b64_tr_b16 v[52:53], v1 offset:33792
    ds_read_b64_tr_b16 v[54:55], v1 offset:34560
    s_waitcnt lgkmcnt(10)
    v_mfma_f32_16x16x32_bf16 v[92:95], v[56:59], v[128:131], v[92:95]
    v_mfma_f32_16x16x32_bf16 v[104:107], v[56:59], v[200:203], v[104:107]
    ds_read_b64_tr_b16 v[56:57], v1 offset:33824
    ds_read_b64_tr_b16 v[58:59], v1 offset:34592
    s_waitcnt lgkmcnt(10)
    v_mfma_f32_16x16x32_bf16 v[96:99], v[60:63], v[128:131], v[96:99]
    v_mfma_f32_16x16x32_bf16 v[108:111], v[60:63], v[200:203], v[108:111]
    s_add_u32 s49, s74, 18432
    buffer_load_dwordx4 v[216:219], v14, s[8:11], s49 offen
    ds_read_b64_tr_b16 v[60:61], v1 offset:33856
    ds_read_b64_tr_b16 v[62:63], v1 offset:34624
    s_waitcnt lgkmcnt(10)
    v_mfma_f32_16x16x32_bf16 v[64:67], v[40:43], v[132:135], v[64:67]
    v_mfma_f32_16x16x32_bf16 v[76:79], v[40:43], v[204:207], v[76:79]
    ds_read_b64_tr_b16 v[40:41], v1 offset:36864
    ds_read_b64_tr_b16 v[42:43], v1 offset:37632
    s_waitcnt lgkmcnt(10)
    v_mfma_f32_16x16x32_bf16 v[68:71], v[44:47], v[132:135], v[68:71]
    s_add_u32 s49, s74, 1024
    buffer_load_dwordx4 v[148:151], v14, s[8:11], s49 offen
    v_mfma_f32_16x16x32_bf16 v[80:83], v[44:47], v[204:207], v[80:83]
    ds_read_b64_tr_b16 v[44:45], v1 offset:36896
    ds_read_b64_tr_b16 v[46:47], v1 offset:37664
    s_waitcnt lgkmcnt(10)
    v_mfma_f32_16x16x32_bf16 v[72:75], v[48:51], v[132:135], v[72:75]
    v_mfma_f32_16x16x32_bf16 v[84:87], v[48:51], v[204:207], v[84:87]
    ds_read_b64_tr_b16 v[48:49], v1 offset:36928
    ds_read_b64_tr_b16 v[50:51], v1 offset:37696
    s_waitcnt lgkmcnt(10)
    v_mfma_f32_16x16x32_bf16 v[88:91], v[52:55], v[132:135], v[88:91]
    s_add_u32 s49, s74, 19456
    buffer_load_dwordx4 v[220:223], v14, s[8:11], s49 offen
    v_mfma_f32_16x16x32_bf16 v[100:103], v[52:55], v[204:207], v[100:103]
    ds_read_b64_tr_b16 v[52:53], v1 offset:43008
    ds_read_b64_tr_b16 v[54:55], v1 offset:43776
    s_waitcnt lgkmcnt(10)
    v_mfma_f32_16x16x32_bf16 v[92:95], v[56:59], v[132:135], v[92:95]
    v_mfma_f32_16x16x32_bf16 v[104:107], v[56:59], v[204:207], v[104:107]
    ds_read_b64_tr_b16 v[56:57], v1 offset:43040
    ds_read_b64_tr_b16 v[58:59], v1 offset:43808
    s_waitcnt lgkmcnt(10)
    v_mfma_f32_16x16x32_bf16 v[96:99], v[60:63], v[132:135], v[96:99]
    v_mfma_f32_16x16x32_bf16 v[108:111], v[60:63], v[204:207], v[108:111]
    ds_read_b64_tr_b16 v[60:61], v1 offset:43072
    ds_read_b64_tr_b16 v[62:63], v1 offset:43840
    s_waitcnt vmcnt(4)
    s_barrier
    s_waitcnt lgkmcnt(10)
    v_mfma_f32_16x16x32_bf16 v[64:67], v[40:43], v[136:139], v[64:67]
    s_add_u32 s49, s41, s65
    s_add_u32 m0, s47, 61440
    s_nop 0
    buffer_load_dwordx4 v3, s[12:15], s49 offen lds
    v_mfma_f32_16x16x32_bf16 v[76:79], v[40:43], v[208:211], v[76:79]
    ds_read_b64_tr_b16 v[40:41], v1 offset:39936
    ds_read_b64_tr_b16 v[42:43], v1 offset:40704
    s_waitcnt lgkmcnt(10)
    v_mfma_f32_16x16x32_bf16 v[68:71], v[44:47], v[136:139], v[68:71]
    v_mfma_f32_16x16x32_bf16 v[80:83], v[44:47], v[208:211], v[80:83]
    s_add_u32 s49, s41, s65
    s_mov_b32 exec_hi, 0
    s_add_u32 m0, s47, 62464
    s_nop 0
    buffer_load_dwordx4 v4, s[12:15], s49 offen lds
    s_mov_b32 exec_hi, -1
    ds_read_b64_tr_b16 v[44:45], v1 offset:39968
    ds_read_b64_tr_b16 v[46:47], v1 offset:40736
    s_waitcnt lgkmcnt(10)
    v_mfma_f32_16x16x32_bf16 v[72:75], v[48:51], v[136:139], v[72:75]
    v_mfma_f32_16x16x32_bf16 v[84:87], v[48:51], v[208:211], v[84:87]
    ds_read_b64_tr_b16 v[48:49], v1 offset:40000
    ds_read_b64_tr_b16 v[50:51], v1 offset:40768
    s_waitcnt lgkmcnt(10)
    v_mfma_f32_16x16x32_bf16 v[88:91], v[52:55], v[136:139], v[88:91]
    v_mfma_f32_16x16x32_bf16 v[100:103], v[52:55], v[208:211], v[100:103]
    s_add_u32 s49, s75, 0
    buffer_load_dwordx4 v[152:155], v14, s[8:11], s49 offen
    ds_read_b64_tr_b16 v[52:53], v1 offset:46080
    ds_read_b64_tr_b16 v[54:55], v1 offset:46848
    s_waitcnt lgkmcnt(10)
    v_mfma_f32_16x16x32_bf16 v[92:95], v[56:59], v[136:139], v[92:95]
    v_mfma_f32_16x16x32_bf16 v[104:107], v[56:59], v[208:211], v[104:107]
    ds_read_b64_tr_b16 v[56:57], v1 offset:46112
    ds_read_b64_tr_b16 v[58:59], v1 offset:46880
    s_waitcnt lgkmcnt(10)
    v_mfma_f32_16x16x32_bf16 v[96:99], v[60:63], v[136:139], v[96:99]
    v_mfma_f32_16x16x32_bf16 v[108:111], v[60:63], v[208:211], v[108:111]
    s_add_u32 s49, s75, 18432
    buffer_load_dwordx4 v[224:227], v14, s[8:11], s49 offen
    ds_read_b64_tr_b16 v[60:61], v1 offset:46144
    ds_read_b64_tr_b16 v[62:63], v1 offset:46912
    s_waitcnt lgkmcnt(10)
    v_mfma_f32_16x16x32_bf16 v[64:67], v[40:43], v[140:143], v[64:67]
    v_mfma_f32_16x16x32_bf16 v[76:79], v[40:43], v[212:215], v[76:79]
    ds_read_b64_tr_b16 v[40:41], v2 offset:0
    ds_read_b64_tr_b16 v[42:43], v2 offset:768
    s_waitcnt lgkmcnt(10)
    v_mfma_f32_16x16x32_bf16 v[68:71], v[44:47], v[140:143], v[68:71]
    s_add_u32 s49, s75, 1024
    buffer_load_dwordx4 v[156:159], v14, s[8:11], s49 offen
    v_mfma_f32_16x16x32_bf16 v[80:83], v[44:47], v[212:215], v[80:83]
    ds_read_b64_tr_b16 v[44:45], v2 offset:32
    ds_read_b64_tr_b16 v[46:47], v2 offset:800
    s_waitcnt lgkmcnt(10)
    v_mfma_f32_16x16x32_bf16 v[72:75], v[48:51], v[140:143], v[72:75]
    v_mfma_f32_16x16x32_bf16 v[84:87], v[48:51], v[212:215], v[84:87]
    ds_read_b64_tr_b16 v[48:49], v2 offset:64
    ds_read_b64_tr_b16 v[50:51], v2 offset:832
    s_waitcnt lgkmcnt(10)
    v_mfma_f32_16x16x32_bf16 v[88:91], v[52:55], v[140:143], v[88:91]
    s_add_u32 s49, s75, 19456
    buffer_load_dwordx4 v[228:231], v14, s[8:11], s49 offen
    v_mfma_f32_16x16x32_bf16 v[100:103], v[52:55], v[212:215], v[100:103]
    ds_read_b64_tr_b16 v[52:53], v2 offset:6144
    ds_read_b64_tr_b16 v[54:55], v2 offset:6912
    s_waitcnt lgkmcnt(10)
    v_mfma_f32_16x16x32_bf16 v[92:95], v[56:59], v[140:143], v[92:95]
    v_mfma_f32_16x16x32_bf16 v[104:107], v[56:59], v[212:215], v[104:107]
    ds_read_b64_tr_b16 v[56:57], v2 offset:6176
    ds_read_b64_tr_b16 v[58:59], v2 offset:6944
    s_waitcnt lgkmcnt(10)
    v_mfma_f32_16x16x32_bf16 v[96:99], v[60:63], v[140:143], v[96:99]
    v_mfma_f32_16x16x32_bf16 v[108:111], v[60:63], v[212:215], v[108:111]
    ds_read_b64_tr_b16 v[60:61], v2 offset:6208
    ds_read_b64_tr_b16 v[62:63], v2 offset:6976
    s_waitcnt vmcnt(4)
    s_barrier
    s_waitcnt lgkmcnt(10)
    v_mfma_f32_16x16x32_bf16 v[64:67], v[40:43], v[144:147], v[64:67]
    s_add_u32 s49, s41, s66
    s_add_u32 m0, s47, 73728
    s_nop 0
    buffer_load_dwordx4 v3, s[12:15], s49 offen lds
    v_mfma_f32_16x16x32_bf16 v[76:79], v[40:43], v[216:219], v[76:79]
    ds_read_b64_tr_b16 v[40:41], v2 offset:3072
    ds_read_b64_tr_b16 v[42:43], v2 offset:3840
    s_waitcnt lgkmcnt(10)
    v_mfma_f32_16x16x32_bf16 v[68:71], v[44:47], v[144:147], v[68:71]
    v_mfma_f32_16x16x32_bf16 v[80:83], v[44:47], v[216:219], v[80:83]
    s_add_u32 s49, s41, s66
    s_mov_b32 exec_hi, 0
    s_add_u32 m0, s47, 74752
    s_nop 0
    buffer_load_dwordx4 v4, s[12:15], s49 offen lds
    s_mov_b32 exec_hi, -1
    ds_read_b64_tr_b16 v[44:45], v2 offset:3104
    ds_read_b64_tr_b16 v[46:47], v2 offset:3872
    s_waitcnt lgkmcnt(10)
    v_mfma_f32_16x16x32_bf16 v[72:75], v[48:51], v[144:147], v[72:75]
    v_mfma_f32_16x16x32_bf16 v[84:87], v[48:51], v[216:219], v[84:87]
    ds_read_b64_tr_b16 v[48:49], v2 offset:3136
    ds_read_b64_tr_b16 v[50:51], v2 offset:3904
    s_waitcnt lgkmcnt(10)
    v_mfma_f32_16x16x32_bf16 v[88:91], v[52:55], v[144:147], v[88:91]
    v_mfma_f32_16x16x32_bf16 v[100:103], v[52:55], v[216:219], v[100:103]
    s_add_u32 s49, s76, 0
    buffer_load_dwordx4 v[160:163], v14, s[8:11], s49 offen
    ds_read_b64_tr_b16 v[52:53], v2 offset:9216
    ds_read_b64_tr_b16 v[54:55], v2 offset:9984
    s_waitcnt lgkmcnt(10)
    v_mfma_f32_16x16x32_bf16 v[92:95], v[56:59], v[144:147], v[92:95]
    v_mfma_f32_16x16x32_bf16 v[104:107], v[56:59], v[216:219], v[104:107]
    ds_read_b64_tr_b16 v[56:57], v2 offset:9248
    ds_read_b64_tr_b16 v[58:59], v2 offset:10016
    s_waitcnt lgkmcnt(10)
    v_mfma_f32_16x16x32_bf16 v[96:99], v[60:63], v[144:147], v[96:99]
    v_mfma_f32_16x16x32_bf16 v[108:111], v[60:63], v[216:219], v[108:111]
    s_add_u32 s49, s76, 18432
    buffer_load_dwordx4 v[232:235], v14, s[8:11], s49 offen
    ds_read_b64_tr_b16 v[60:61], v2 offset:9280
    ds_read_b64_tr_b16 v[62:63], v2 offset:10048
    s_waitcnt lgkmcnt(10)
    v_mfma_f32_16x16x32_bf16 v[64:67], v[40:43], v[148:151], v[64:67]
    v_mfma_f32_16x16x32_bf16 v[76:79], v[40:43], v[220:223], v[76:79]
    ds_read_b64_tr_b16 v[40:41], v2 offset:12288
    ds_read_b64_tr_b16 v[42:43], v2 offset:13056
    s_waitcnt lgkmcnt(10)
    v_mfma_f32_16x16x32_bf16 v[68:71], v[44:47], v[148:151], v[68:71]
    s_add_u32 s49, s76, 1024
    buffer_load_dwordx4 v[164:167], v14, s[8:11], s49 offen
    v_mfma_f32_16x16x32_bf16 v[80:83], v[44:47], v[220:223], v[80:83]
    ds_read_b64_tr_b16 v[44:45], v2 offset:12320
    ds_read_b64_tr_b16 v[46:47], v2 offset:13088
    s_waitcnt lgkmcnt(10)
    v_mfma_f32_16x16x32_bf16 v[72:75], v[48:51], v[148:151], v[72:75]
    v_mfma_f32_16x16x32_bf16 v[84:87], v[48:51], v[220:223], v[84:87]
    ds_read_b64_tr_b16 v[48:49], v2 offset:12352
    ds_read_b64_tr_b16 v[50:51], v2 offset:13120
    s_waitcnt lgkmcnt(10)
    v_mfma_f32_16x16x32_bf16 v[88:91], v[52:55], v[148:151], v[88:91]
    s_add_u32 s49, s76, 19456
    buffer_load_dwordx4 v[236:239], v14, s[8:11], s49 offen
    v_mfma_f32_16x16x32_bf16 v[100:103], v[52:55], v[220:223], v[100:103]
    ds_read_b64_tr_b16 v[52:53], v2 offset:18432
    ds_read_b64_tr_b16 v[54:55], v2 offset:19200
    s_waitcnt lgkmcnt(10)
    v_mfma_f32_16x16x32_bf16 v[92:95], v[56:59], v[148:151], v[92:95]
    v_mfma_f32_16x16x32_bf16 v[104:107], v[56:59], v[220:223], v[104:107]
    ds_read_b64_tr_b16 v[56:57], v2 offset:18464
    ds_read_b64_tr_b16 v[58:59], v2 offset:19232
    s_waitcnt lgkmcnt(10)
    v_mfma_f32_16x16x32_bf16 v[96:99], v[60:63], v[148:151], v[96:99]
    v_mfma_f32_16x16x32_bf16 v[108:111], v[60:63], v[220:223], v[108:111]
    ds_read_b64_tr_b16 v[60:61], v2 offset:18496
    ds_read_b64_tr_b16 v[62:63], v2 offset:19264
    s_waitcnt vmcnt(4)
    s_barrier
    s_waitcnt lgkmcnt(10)
    v_mfma_f32_16x16x32_bf16 v[64:67], v[40:43], v[152:155], v[64:67]
    s_add_u32 s49, s41, s67
    s_add_u32 m0, s47, 86016
    s_nop 0
    buffer_load_dwordx4 v3, s[12:15], s49 offen lds
    v_mfma_f32_16x16x32_bf16 v[76:79], v[40:43], v[224:227], v[76:79]
    ds_read_b64_tr_b16 v[40:41], v2 offset:15360
    ds_read_b64_tr_b16 v[42:43], v2 offset:16128
    s_waitcnt lgkmcnt(10)
    v_mfma_f32_16x16x32_bf16 v[68:71], v[44:47], v[152:155], v[68:71]
    v_mfma_f32_16x16x32_bf16 v[80:83], v[44:47], v[224:227], v[80:83]
    s_add_u32 s49, s41, s67
    s_mov_b32 exec_hi, 0
    s_add_u32 m0, s47, 87040
    s_nop 0
    buffer_load_dwordx4 v4, s[12:15], s49 offen lds
    s_mov_b32 exec_hi, -1
    ds_read_b64_tr_b16 v[44:45], v2 offset:15392
    ds_read_b64_tr_b16 v[46:47], v2 offset:16160
    s_waitcnt lgkmcnt(10)
    v_mfma_f32_16x16x32_bf16 v[72:75], v[48:51], v[152:155], v[72:75]
    v_mfma_f32_16x16x32_bf16 v[84:87], v[48:51], v[224:227], v[84:87]
    ds_read_b64_tr_b16 v[48:49], v2 offset:15424
    ds_read_b64_tr_b16 v[50:51], v2 offset:16192
    s_waitcnt lgkmcnt(10)
    v_mfma_f32_16x16x32_bf16 v[88:91], v[52:55], v[152:155], v[88:91]
    v_mfma_f32_16x16x32_bf16 v[100:103], v[52:55], v[224:227], v[100:103]
    s_add_u32 s49, s77, 0
    buffer_load_dwordx4 v[168:171], v14, s[8:11], s49 offen
    ds_read_b64_tr_b16 v[52:53], v2 offset:21504
    ds_read_b64_tr_b16 v[54:55], v2 offset:22272
    s_waitcnt lgkmcnt(10)
    v_mfma_f32_16x16x32_bf16 v[92:95], v[56:59], v[152:155], v[92:95]
    v_mfma_f32_16x16x32_bf16 v[104:107], v[56:59], v[224:227], v[104:107]
    ds_read_b64_tr_b16 v[56:57], v2 offset:21536
    ds_read_b64_tr_b16 v[58:59], v2 offset:22304
    s_waitcnt lgkmcnt(10)
    v_mfma_f32_16x16x32_bf16 v[96:99], v[60:63], v[152:155], v[96:99]
    v_mfma_f32_16x16x32_bf16 v[108:111], v[60:63], v[224:227], v[108:111]
    s_add_u32 s49, s77, 18432
    buffer_load_dwordx4 v[240:243], v14, s[8:11], s49 offen
    ds_read_b64_tr_b16 v[60:61], v2 offset:21568
    ds_read_b64_tr_b16 v[62:63], v2 offset:22336
    s_waitcnt lgkmcnt(10)
    v_mfma_f32_16x16x32_bf16 v[64:67], v[40:43], v[156:159], v[64:67]
    v_mfma_f32_16x16x32_bf16 v[76:79], v[40:43], v[228:231], v[76:79]
    ds_read_b64_tr_b16 v[40:41], v2 offset:24576
    ds_read_b64_tr_b16 v[42:43], v2 offset:25344
    s_waitcnt lgkmcnt(10)
    v_mfma_f32_16x16x32_bf16 v[68:71], v[44:47], v[156:159], v[68:71]
    s_add_u32 s49, s77, 1024
    buffer_load_dwordx4 v[172:175], v14, s[8:11], s49 offen
    v_mfma_f32_16x16x32_bf16 v[80:83], v[44:47], v[228:231], v[80:83]
    ds_read_b64_tr_b16 v[44:45], v2 offset:24608
    ds_read_b64_tr_b16 v[46:47], v2 offset:25376
    s_waitcnt lgkmcnt(10)
    v_mfma_f32_16x16x32_bf16 v[72:75], v[48:51], v[156:159], v[72:75]
    v_mfma_f32_16x16x32_bf16 v[84:87], v[48:51], v[228:231], v[84:87]
    ds_read_b64_tr_b16 v[48:49], v2 offset:24640
    ds_read_b64_tr_b16 v[50:51], v2 offset:25408
    s_waitcnt lgkmcnt(10)
    v_mfma_f32_16x16x32_bf16 v[88:91], v[52:55], v[156:159], v[88:91]
    s_add_u32 s49, s77, 19456
    buffer_load_dwordx4 v[244:247], v14, s[8:11], s49 offen
    v_mfma_f32_16x16x32_bf16 v[100:103], v[52:55], v[228:231], v[100:103]
    ds_read_b64_tr_b16 v[52:53], v2 offset:30720
    ds_read_b64_tr_b16 v[54:55], v2 offset:31488
    s_waitcnt lgkmcnt(10)
    v_mfma_f32_16x16x32_bf16 v[92:95], v[56:59], v[156:159], v[92:95]
    v_mfma_f32_16x16x32_bf16 v[104:107], v[56:59], v[228:231], v[104:107]
    ds_read_b64_tr_b16 v[56:57], v2 offset:30752
    ds_read_b64_tr_b16 v[58:59], v2 offset:31520
    s_waitcnt lgkmcnt(10)
    v_mfma_f32_16x16x32_bf16 v[96:99], v[60:63], v[156:159], v[96:99]
    v_mfma_f32_16x16x32_bf16 v[108:111], v[60:63], v[228:231], v[108:111]
    ds_read_b64_tr_b16 v[60:61], v2 offset:30784
    ds_read_b64_tr_b16 v[62:63], v2 offset:31552
    s_waitcnt vmcnt(4)
    s_barrier
    s_waitcnt lgkmcnt(10)
    v_mfma_f32_16x16x32_bf16 v[64:67], v[40:43], v[160:163], v[64:67]
    s_add_u32 s49, s41, s68
    s_add_u32 m0, s47, 0
    s_nop 0
    buffer_load_dwordx4 v3, s[12:15], s49 offen lds
    v_mfma_f32_16x16x32_bf16 v[76:79], v[40:43], v[232:235], v[76:79]
    ds_read_b64_tr_b16 v[40:41], v2 offset:27648
    ds_read_b64_tr_b16 v[42:43], v2 offset:28416
    s_waitcnt lgkmcnt(10)
    v_mfma_f32_16x16x32_bf16 v[68:71], v[44:47], v[160:163], v[68:71]
    s_add_u32 s49, s41, s68
    s_mov_b32 exec_hi, 0
    s_add_u32 m0, s47, 1024
    s_nop 0
    buffer_load_dwordx4 v4, s[12:15], s49 offen lds
    s_mov_b32 exec_hi, -1
    v_mfma_f32_16x16x32_bf16 v[80:83], v[44:47], v[232:235], v[80:83]
    ds_read_b64_tr_b16 v[44:45], v2 offset:27680
    ds_read_b64_tr_b16 v[46:47], v2 offset:28448
    s_waitcnt lgkmcnt(10)
    v_mfma_f32_16x16x32_bf16 v[72:75], v[48:51], v[160:163], v[72:75]
    v_mfma_f32_16x16x32_bf16 v[84:87], v[48:51], v[232:235], v[84:87]
    s_add_u32 s49, s78, 0
    buffer_load_dwordx4 v[176:179], v14, s[8:11], s49 offen
    ds_read_b64_tr_b16 v[48:49], v2 offset:27712
    ds_read_b64_tr_b16 v[50:51], v2 offset:28480
    s_waitcnt lgkmcnt(10)
    v_mfma_f32_16x16x32_bf16 v[88:91], v[52:55], v[160:163], v[88:91]
    v_mfma_f32_16x16x32_bf16 v[100:103], v[52:55], v[232:235], v[100:103]
    ds_read_b64_tr_b16 v[52:53], v2 offset:33792
    ds_read_b64_tr_b16 v[54:55], v2 offset:34560
    s_waitcnt lgkmcnt(10)
    v_mfma_f32_16x16x32_bf16 v[92:95], v[56:59], v[160:163], v[92:95]
    s_add_u32 s49, s78, 18432
    buffer_load_dwordx4 v[248:251], v14, s[8:11], s49 offen
    v_mfma_f32_16x16x32_bf16 v[104:107], v[56:59], v[232:235], v[104:107]
    ds_read_b64_tr_b16 v[56:57], v2 offset:33824
    ds_read_b64_tr_b16 v[58:59], v2 offset:34592
    s_waitcnt lgkmcnt(10)
    v_mfma_f32_16x16x32_bf16 v[96:99], v[60:63], v[160:163], v[96:99]
    v_mfma_f32_16x16x32_bf16 v[108:111], v[60:63], v[232:235], v[108:111]
    s_add_u32 s49, s78, 1024
    buffer_load_dwordx4 v[180:183], v14, s[8:11], s49 offen
    ds_read_b64_tr_b16 v[60:61], v2 offset:33856
    ds_read_b64_tr_b16 v[62:63], v2 offset:34624
    s_waitcnt lgkmcnt(10)
    v_mfma_f32_16x16x32_bf16 v[64:67], v[40:43], v[164:167], v[64:67]
    v_mfma_f32_16x16x32_bf16 v[76:79], v[40:43], v[236:239], v[76:79]
    s_add_u32 s49, s78, 19456
    buffer_load_dwordx4 v[252:255], v14, s[8:11], s49 offen
    ds_read_b64_tr_b16 v[40:41], v2 offset:36864
    ds_read_b64_tr_b16 v[42:43], v2 offset:37632
    s_waitcnt lgkmcnt(10)
    v_mfma_f32_16x16x32_bf16 v[68:71], v[44:47], v[164:167], v[68:71]
    v_mfma_f32_16x16x32_bf16 v[80:83], v[44:47], v[236:239], v[80:83]
    ds_read_b64_tr_b16 v[44:45], v2 offset:36896
    ds_read_b64_tr_b16 v[46:47], v2 offset:37664
    s_waitcnt lgkmcnt(10)
    v_mfma_f32_16x16x32_bf16 v[72:75], v[48:51], v[164:167], v[72:75]
    s_add_u32 s49, s41, s60
    s_add_u32 s49, s49, 96
    s_add_u32 m0, s47, 12288
    s_nop 0
    buffer_load_dwordx4 v3, s[12:15], s49 offen lds
    v_mfma_f32_16x16x32_bf16 v[84:87], v[48:51], v[236:239], v[84:87]
    ds_read_b64_tr_b16 v[48:49], v2 offset:36928
    ds_read_b64_tr_b16 v[50:51], v2 offset:37696
    s_waitcnt lgkmcnt(10)
    v_mfma_f32_16x16x32_bf16 v[88:91], v[52:55], v[164:167], v[88:91]
    v_mfma_f32_16x16x32_bf16 v[100:103], v[52:55], v[236:239], v[100:103]
    s_add_u32 s49, s41, s60
    s_add_u32 s49, s49, 96
    s_mov_b32 exec_hi, 0
    s_add_u32 m0, s47, 13312
    s_nop 0
    buffer_load_dwordx4 v4, s[12:15], s49 offen lds
    s_mov_b32 exec_hi, -1
    ds_read_b64_tr_b16 v[52:53], v2 offset:43008
    ds_read_b64_tr_b16 v[54:55], v2 offset:43776
    s_waitcnt lgkmcnt(10)
    v_mfma_f32_16x16x32_bf16 v[92:95], v[56:59], v[164:167], v[92:95]
    v_mfma_f32_16x16x32_bf16 v[104:107], v[56:59], v[236:239], v[104:107]
    ds_read_b64_tr_b16 v[56:57], v2 offset:43040
    ds_read_b64_tr_b16 v[58:59], v2 offset:43808
    s_waitcnt lgkmcnt(10)
    v_mfma_f32_16x16x32_bf16 v[96:99], v[60:63], v[164:167], v[96:99]
    v_mfma_f32_16x16x32_bf16 v[108:111], v[60:63], v[236:239], v[108:111]
    ds_read_b64_tr_b16 v[60:61], v2 offset:43072
    ds_read_b64_tr_b16 v[62:63], v2 offset:43840
    s_waitcnt vmcnt(6)
    s_barrier
    s_waitcnt lgkmcnt(10)
    v_mfma_f32_16x16x32_bf16 v[64:67], v[40:43], v[168:171], v[64:67]
    s_add_u32 s49, s41, s61
    s_add_u32 s49, s49, 96
    s_add_u32 m0, s47, 24576
    s_nop 0
    buffer_load_dwordx4 v3, s[12:15], s49 offen lds
    v_mfma_f32_16x16x32_bf16 v[76:79], v[40:43], v[240:243], v[76:79]
    ds_read_b64_tr_b16 v[40:41], v2 offset:39936
    ds_read_b64_tr_b16 v[42:43], v2 offset:40704
    s_waitcnt lgkmcnt(10)
    v_mfma_f32_16x16x32_bf16 v[68:71], v[44:47], v[168:171], v[68:71]
    v_mfma_f32_16x16x32_bf16 v[80:83], v[44:47], v[240:243], v[80:83]
    ds_read_b64_tr_b16 v[44:45], v2 offset:39968
    ds_read_b64_tr_b16 v[46:47], v2 offset:40736
    s_waitcnt lgkmcnt(10)
    v_mfma_f32_16x16x32_bf16 v[72:75], v[48:51], v[168:171], v[72:75]
    v_mfma_f32_16x16x32_bf16 v[84:87], v[48:51], v[240:243], v[84:87]
    s_add_u32 s49, s41, s61
    s_add_u32 s49, s49, 96
    s_mov_b32 exec_hi, 0
    s_add_u32 m0, s47, 25600
    s_nop 0
    buffer_load_dwordx4 v4, s[12:15], s49 offen lds
    s_mov_b32 exec_hi, -1
    ds_read_b64_tr_b16 v[48:49], v2 offset:40000
    ds_read_b64_tr_b16 v[50:51], v2 offset:40768
    s_waitcnt lgkmcnt(10)
    v_mfma_f32_16x16x32_bf16 v[88:91], v[52:55], v[168:171], v[88:91]
    v_mfma_f32_16x16x32_bf16 v[100:103], v[52:55], v[240:243], v[100:103]
    ds_read_b64_tr_b16 v[52:53], v2 offset:46080
    ds_read_b64_tr_b16 v[54:55], v2 offset:46848
    s_waitcnt lgkmcnt(10)
    v_mfma_f32_16x16x32_bf16 v[92:95], v[56:59], v[168:171], v[92:95]
    v_mfma_f32_16x16x32_bf16 v[104:107], v[56:59], v[240:243], v[104:107]
    ds_read_b64_tr_b16 v[56:57], v2 offset:46112
    ds_read_b64_tr_b16 v[58:59], v2 offset:46880
    s_waitcnt lgkmcnt(10)
    v_mfma_f32_16x16x32_bf16 v[96:99], v[60:63], v[168:171], v[96:99]
    v_mfma_f32_16x16x32_bf16 v[108:111], v[60:63], v[240:243], v[108:111]
    s_add_u32 s49, s41, s62
    s_add_u32 s49, s49, 96
    s_add_u32 m0, s47, 36864
    s_nop 0
    buffer_load_dwordx4 v3, s[12:15], s49 offen lds
    ds_read_b64_tr_b16 v[60:61], v2 offset:46144
    ds_read_b64_tr_b16 v[62:63], v2 offset:46912
    s_waitcnt lgkmcnt(10)
    v_mfma_f32_16x16x32_bf16 v[64:67], v[40:43], v[172:175], v[64:67]
    v_mfma_f32_16x16x32_bf16 v[76:79], v[40:43], v[244:247], v[76:79]
    ds_read_b64_tr_b16 v[40:41], v1 offset:0
    ds_read_b64_tr_b16 v[42:43], v1 offset:768
    s_waitcnt lgkmcnt(10)
    v_mfma_f32_16x16x32_bf16 v[68:71], v[44:47], v[172:175], v[68:71]
    v_mfma_f32_16x16x32_bf16 v[80:83], v[44:47], v[244:247], v[80:83]
    ds_read_b64_tr_b16 v[44:45], v1 offset:32
    ds_read_b64_tr_b16 v[46:47], v1 offset:800
    s_waitcnt lgkmcnt(10)
    v_mfma_f32_16x16x32_bf16 v[72:75], v[48:51], v[172:175], v[72:75]
    s_add_u32 s49, s41, s62
    s_add_u32 s49, s49, 96
    s_mov_b32 exec_hi, 0
    s_add_u32 m0, s47, 37888
    s_nop 0
    buffer_load_dwordx4 v4, s[12:15], s49 offen lds
    s_mov_b32 exec_hi, -1
    v_mfma_f32_16x16x32_bf16 v[84:87], v[48:51], v[244:247], v[84:87]
    ds_read_b64_tr_b16 v[48:49], v1 offset:64
    ds_read_b64_tr_b16 v[50:51], v1 offset:832
    s_waitcnt lgkmcnt(10)
    v_mfma_f32_16x16x32_bf16 v[88:91], v[52:55], v[172:175], v[88:91]
    v_mfma_f32_16x16x32_bf16 v[100:103], v[52:55], v[244:247], v[100:103]
    ds_read_b64_tr_b16 v[52:53], v1 offset:6144
    ds_read_b64_tr_b16 v[54:55], v1 offset:6912
    s_waitcnt lgkmcnt(10)
    v_mfma_f32_16x16x32_bf16 v[92:95], v[56:59], v[172:175], v[92:95]
    v_mfma_f32_16x16x32_bf16 v[104:107], v[56:59], v[244:247], v[104:107]
    ds_read_b64_tr_b16 v[56:57], v1 offset:6176
    ds_read_b64_tr_b16 v[58:59], v1 offset:6944
    s_waitcnt lgkmcnt(10)
    v_mfma_f32_16x16x32_bf16 v[96:99], v[60:63], v[172:175], v[96:99]
    v_mfma_f32_16x16x32_bf16 v[108:111], v[60:63], v[244:247], v[108:111]
    ds_read_b64_tr_b16 v[60:61], v1 offset:6208
    ds_read_b64_tr_b16 v[62:63], v1 offset:6976
    s_waitcnt vmcnt(4)
    s_barrier
    s_waitcnt lgkmcnt(10)
    v_mfma_f32_16x16x32_bf16 v[64:67], v[40:43], v[176:179], v[64:67]
    s_add_u32 s49, s41, s63
    s_add_u32 s49, s49, 96
    s_add_u32 m0, s47, 49152
    s_nop 0
    buffer_load_dwordx4 v3, s[12:15], s49 offen lds
    v_mfma_f32_16x16x32_bf16 v[76:79], v[40:43], v[248:251], v[76:79]
    ds_read_b64_tr_b16 v[40:41], v1 offset:3072
    ds_read_b64_tr_b16 v[42:43], v1 offset:3840
    s_waitcnt lgkmcnt(10)
    v_mfma_f32_16x16x32_bf16 v[68:71], v[44:47], v[176:179], v[68:71]
    v_mfma_f32_16x16x32_bf16 v[80:83], v[44:47], v[248:251], v[80:83]
    ds_read_b64_tr_b16 v[44:45], v1 offset:3104
    ds_read_b64_tr_b16 v[46:47], v1 offset:3872
    s_waitcnt lgkmcnt(10)
    v_mfma_f32_16x16x32_bf16 v[72:75], v[48:51], v[176:179], v[72:75]
    v_mfma_f32_16x16x32_bf16 v[84:87], v[48:51], v[248:251], v[84:87]
    s_add_u32 s49, s41, s63
    s_add_u32 s49, s49, 96
    s_mov_b32 exec_hi, 0
    s_add_u32 m0, s47, 50176
    s_nop 0
    buffer_load_dwordx4 v4, s[12:15], s49 offen lds
    s_mov_b32 exec_hi, -1
    ds_read_b64_tr_b16 v[48:49], v1 offset:3136
    ds_read_b64_tr_b16 v[50:51], v1 offset:3904
    s_waitcnt lgkmcnt(10)
    v_mfma_f32_16x16x32_bf16 v[88:91], v[52:55], v[176:179], v[88:91]
    v_mfma_f32_16x16x32_bf16 v[100:103], v[52:55], v[248:251], v[100:103]
    ds_read_b64_tr_b16 v[52:53], v1 offset:9216
    ds_read_b64_tr_b16 v[54:55], v1 offset:9984
    s_waitcnt lgkmcnt(10)
    v_mfma_f32_16x16x32_bf16 v[92:95], v[56:59], v[176:179], v[92:95]
    v_mfma_f32_16x16x32_bf16 v[104:107], v[56:59], v[248:251], v[104:107]
    ds_read_b64_tr_b16 v[56:57], v1 offset:9248
    ds_read_b64_tr_b16 v[58:59], v1 offset:10016
    s_waitcnt lgkmcnt(10)
    v_mfma_f32_16x16x32_bf16 v[96:99], v[60:63], v[176:179], v[96:99]
    v_mfma_f32_16x16x32_bf16 v[108:111], v[60:63], v[248:251], v[108:111]
    s_add_u32 s49, s41, s64
    s_add_u32 s49, s49, 96
    s_add_u32 m0, s47, 61440
    s_nop 0
    buffer_load_dwordx4 v3, s[12:15], s49 offen lds
    ds_read_b64_tr_b16 v[60:61], v1 offset:9280
    ds_read_b64_tr_b16 v[62:63], v1 offset:10048
    s_waitcnt lgkmcnt(10)
    v_mfma_f32_16x16x32_bf16 v[64:67], v[40:43], v[180:183], v[64:67]
    v_mfma_f32_16x16x32_bf16 v[76:79], v[40:43], v[252:255], v[76:79]
    ds_read_b64_tr_b16 v[40:41], v1 offset:12288
    ds_read_b64_tr_b16 v[42:43], v1 offset:13056
    s_waitcnt lgkmcnt(10)
    v_mfma_f32_16x16x32_bf16 v[68:71], v[44:47], v[180:183], v[68:71]
    v_mfma_f32_16x16x32_bf16 v[80:83], v[44:47], v[252:255], v[80:83]
    ds_read_b64_tr_b16 v[44:45], v1 offset:12320
    ds_read_b64_tr_b16 v[46:47], v1 offset:13088
    s_waitcnt lgkmcnt(10)
    v_mfma_f32_16x16x32_bf16 v[72:75], v[48:51], v[180:183], v[72:75]
    s_add_u32 s49, s41, s64
    s_add_u32 s49, s49, 96
    s_mov_b32 exec_hi, 0
    s_add_u32 m0, s47, 62464
    s_nop 0
    buffer_load_dwordx4 v4, s[12:15], s49 offen lds
    s_mov_b32 exec_hi, -1
    v_mfma_f32_16x16x32_bf16 v[84:87], v[48:51], v[252:255], v[84:87]
    ds_read_b64_tr_b16 v[48:49], v1 offset:12352
    ds_read_b64_tr_b16 v[50:51], v1 offset:13120
    s_waitcnt lgkmcnt(10)
    v_mfma_f32_16x16x32_bf16 v[88:91], v[52:55], v[180:183], v[88:91]
    v_mfma_f32_16x16x32_bf16 v[100:103], v[52:55], v[252:255], v[100:103]
    ds_read_b64_tr_b16 v[52:53], v1 offset:18432
    ds_read_b64_tr_b16 v[54:55], v1 offset:19200
    s_waitcnt lgkmcnt(10)
    v_mfma_f32_16x16x32_bf16 v[92:95], v[56:59], v[180:183], v[92:95]
    v_mfma_f32_16x16x32_bf16 v[104:107], v[56:59], v[252:255], v[104:107]
    ds_read_b64_tr_b16 v[56:57], v1 offset:18464
    ds_read_b64_tr_b16 v[58:59], v1 offset:19232
    s_waitcnt lgkmcnt(10)
    v_mfma_f32_16x16x32_bf16 v[96:99], v[60:63], v[180:183], v[96:99]
    v_mfma_f32_16x16x32_bf16 v[108:111], v[60:63], v[252:255], v[108:111]
    ds_read_b64_tr_b16 v[60:61], v1 offset:18496
    ds_read_b64_tr_b16 v[62:63], v1 offset:19264
    s_nop 7
    s_nop 1
    v_cvt_pk_bf16_f32 v6, v64, v65
    v_cvt_pk_bf16_f32 v18, v88, v89
    v_cvt_pk_bf16_f32 v7, v66, v67
    v_cvt_pk_bf16_f32 v19, v90, v91
    v_cvt_pk_bf16_f32 v8, v68, v69
    v_cvt_pk_bf16_f32 v20, v92, v93
    v_cvt_pk_bf16_f32 v9, v70, v71
    v_cvt_pk_bf16_f32 v21, v94, v95
    v_cvt_pk_bf16_f32 v10, v72, v73
    v_cvt_pk_bf16_f32 v22, v96, v97
    v_cvt_pk_bf16_f32 v11, v74, v75
    v_cvt_pk_bf16_f32 v23, v98, v99
    v_cvt_pk_bf16_f32 v12, v76, v77
    v_cvt_pk_bf16_f32 v24, v100, v101
    v_cvt_pk_bf16_f32 v13, v78, v79
    v_cvt_pk_bf16_f32 v25, v102, v103
    v_cvt_pk_bf16_f32 v14, v80, v81
    v_cvt_pk_bf16_f32 v26, v104, v105
    v_cvt_pk_bf16_f32 v15, v82, v83
    v_cvt_pk_bf16_f32 v27, v106, v107
    v_cvt_pk_bf16_f32 v16, v84, v85
    v_cvt_pk_bf16_f32 v28, v108, v109
    v_cvt_pk_bf16_f32 v17, v86, v87
    v_cvt_pk_bf16_f32 v29, v110, v111
    s_waitcnt vmcnt(6)
    s_barrier
    s_waitcnt lgkmcnt(10)
    v_mfma_f32_16x16x32_bf16 v[64:67], v[40:43], v[112:115], 0
    s_add_u32 s49, s41, s65
    s_add_u32 s49, s49, 96
    s_add_u32 m0, s47, 73728
    s_nop 0
    buffer_load_dwordx4 v3, s[12:15], s49 offen lds
    v_mfma_f32_16x16x32_bf16 v[76:79], v[40:43], v[184:187], 0
    ds_read_b64_tr_b16 v[40:41], v1 offset:15360
    ds_read_b64_tr_b16 v[42:43], v1 offset:16128
    s_waitcnt lgkmcnt(10)
    v_mfma_f32_16x16x32_bf16 v[68:71], v[44:47], v[112:115], 0
    v_mfma_f32_16x16x32_bf16 v[80:83], v[44:47], v[184:187], 0
    ds_read_b64_tr_b16 v[44:45], v1 offset:15392
    ds_read_b64_tr_b16 v[46:47], v1 offset:16160
    s_waitcnt lgkmcnt(10)
    v_mfma_f32_16x16x32_bf16 v[72:75], v[48:51], v[112:115], 0
    v_mfma_f32_16x16x32_bf16 v[84:87], v[48:51], v[184:187], 0
    s_add_u32 s49, s41, s65
    s_add_u32 s49, s49, 96
    s_mov_b32 exec_hi, 0
    s_add_u32 m0, s47, 74752
    s_nop 0
    buffer_load_dwordx4 v4, s[12:15], s49 offen lds
    s_mov_b32 exec_hi, -1
    ds_read_b64_tr_b16 v[48:49], v1 offset:15424
    ds_read_b64_tr_b16 v[50:51], v1 offset:16192
    s_waitcnt lgkmcnt(10)
    v_mfma_f32_16x16x32_bf16 v[88:91], v[52:55], v[112:115], 0
    v_mfma_f32_16x16x32_bf16 v[100:103], v[52:55], v[184:187], 0
    ds_read_b64_tr_b16 v[52:53], v1 offset:21504
    ds_read_b64_tr_b16 v[54:55], v1 offset:22272
    s_waitcnt lgkmcnt(10)
    v_mfma_f32_16x16x32_bf16 v[92:95], v[56:59], v[112:115], 0
    v_mfma_f32_16x16x32_bf16 v[104:107], v[56:59], v[184:187], 0
    ds_read_b64_tr_b16 v[56:57], v1 offset:21536
    ds_read_b64_tr_b16 v[58:59], v1 offset:22304
    s_waitcnt lgkmcnt(10)
    v_mfma_f32_16x16x32_bf16 v[96:99], v[60:63], v[112:115], 0
    v_mfma_f32_16x16x32_bf16 v[108:111], v[60:63], v[184:187], 0
    s_add_u32 s49, s41, s66
    s_add_u32 s49, s49, 96
    s_add_u32 m0, s47, 86016
    s_nop 0
    buffer_load_dwordx4 v3, s[12:15], s49 offen lds
    ds_read_b64_tr_b16 v[60:61], v1 offset:21568
    ds_read_b64_tr_b16 v[62:63], v1 offset:22336
    s_waitcnt lgkmcnt(10)
    v_mfma_f32_16x16x32_bf16 v[64:67], v[40:43], v[116:119], v[64:67]
    v_lshlrev_b32 v32, 16, v6
    v_and_b32 v33, s50, v6
    v_mfma_f32_16x16x32_bf16 v[76:79], v[40:43], v[188:191], v[76:79]
    v_mul_f32 v34, 0xbfb8aa3b, v32
    ds_read_b64_tr_b16 v[40:41], v1 offset:24576
    ds_read_b64_tr_b16 v[42:43], v1 offset:25344
    s_waitcnt lgkmcnt(10)
    v_mfma_f32_16x16x32_bf16 v[68:71], v[44:47], v[116:119], v[68:71]
    v_mul_f32 v35, 0xbfb8aa3b, v33
    v_exp_f32 v34, v34
    v_mfma_f32_16x16x32_bf16 v[80:83], v[44:47], v[188:191], v[80:83]
    v_exp_f32 v35, v35
    ds_read_b64_tr_b16 v[44:45], v1 offset:24608
    ds_read_b64_tr_b16 v[46:47], v1 offset:25376
    s_waitcnt lgkmcnt(10)
    v_mfma_f32_16x16x32_bf16 v[72:75], v[48:51], v[116:119], v[72:75]
    s_add_u32 s49, s41, s66
    s_add_u32 s49, s49, 96
    s_mov_b32 exec_hi, 0
    s_add_u32 m0, s47, 87040
    s_nop 0
    buffer_load_dwordx4 v4, s[12:15], s49 offen lds
    s_mov_b32 exec_hi, -1
    v_lshlrev_b32 v36, 16, v18
    v_add_f32 v34, 1.0, v34
    v_mfma_f32_16x16x32_bf16 v[84:87], v[48:51], v[188:191], v[84:87]
    v_add_f32 v35, 1.0, v35
    ds_read_b64_tr_b16 v[48:49], v1 offset:24640
    ds_read_b64_tr_b16 v[50:51], v1 offset:25408
    s_waitcnt lgkmcnt(10)
    v_mfma_f32_16x16x32_bf16 v[88:91], v[52:55], v[116:119], v[88:91]
    v_rcp_f32 v34, v34
    v_rcp_f32 v35, v35
    v_mfma_f32_16x16x32_bf16 v[100:103], v[52:55], v[188:191], v[100:103]
    v_and_b32 v37, s50, v18
    ds_read_b64_tr_b16 v[52:53], v1 offset:30720
    ds_read_b64_tr_b16 v[54:55], v1 offset:31488
    s_waitcnt lgkmcnt(10)
    v_mfma_f32_16x16x32_bf16 v[92:95], v[56:59], v[116:119], v[92:95]
    v_mul_f32 v34, v32, v34
    v_mul_f32 v35, v33, v35
    v_mfma_f32_16x16x32_bf16 v[104:107], v[56:59], v[188:191], v[104:107]
    v_cvt_pk_bf16_f32 v30, v34, v35
    ds_read_b64_tr_b16 v[56:57], v1 offset:30752
    ds_read_b64_tr_b16 v[58:59], v1 offset:31520
    s_waitcnt lgkmcnt(10)
    v_mfma_f32_16x16x32_bf16 v[96:99], v[60:63], v[116:119], v[96:99]
    v_lshlrev_b32 v34, 16, v30
    v_and_b32 v35, s50, v30
    v_mfma_f32_16x16x32_bf16 v[108:111], v[60:63], v[188:191], v[108:111]
    v_mul_f32 v34, v34, v36
    ds_read_b64_tr_b16 v[60:61], v1 offset:30784
    ds_read_b64_tr_b16 v[62:63], v1 offset:31552
    s_waitcnt vmcnt(8)
    s_barrier
    s_waitcnt lgkmcnt(10)
    v_mfma_f32_16x16x32_bf16 v[64:67], v[40:43], v[120:123], v[64:67]
    s_add_u32 s49, s41, s67
    s_add_u32 s49, s49, 96
    s_add_u32 m0, s47, 0
    s_nop 0
    buffer_load_dwordx4 v3, s[12:15], s49 offen lds
    v_mul_f32 v35, v35, v37
    v_cvt_pk_bf16_f32 v38, v34, v35
    v_mfma_f32_16x16x32_bf16 v[76:79], v[40:43], v[192:195], v[76:79]
    v_lshlrev_b32 v32, 16, v7
    ds_read_b64_tr_b16 v[40:41], v1 offset:27648
    ds_read_b64_tr_b16 v[42:43], v1 offset:28416
    s_waitcnt lgkmcnt(10)
    v_mfma_f32_16x16x32_bf16 v[68:71], v[44:47], v[120:123], v[68:71]
    v_and_b32 v33, s50, v7
    v_mul_f32 v34, 0xbfb8aa3b, v32
    v_mfma_f32_16x16x32_bf16 v[80:83], v[44:47], v[192:195], v[80:83]
    v_mul_f32 v35, 0xbfb8aa3b, v33
    ds_read_b64_tr_b16 v[44:45], v1 offset:27680
    ds_read_b64_tr_b16 v[46:47], v1 offset:28448
    s_waitcnt lgkmcnt(10)
    v_mfma_f32_16x16x32_bf16 v[72:75], v[48:51], v[120:123], v[72:75]
    v_exp_f32 v34, v34
    v_exp_f32 v35, v35
    v_mfma_f32_16x16x32_bf16 v[84:87], v[48:51], v[192:195], v[84:87]
    s_add_u32 s49, s41, s67
    s_add_u32 s49, s49, 96
    s_mov_b32 exec_hi, 0
    s_add_u32 m0, s47, 1024
    s_nop 0
    buffer_load_dwordx4 v4, s[12:15], s49 offen lds
    s_mov_b32 exec_hi, -1
    v_lshlrev_b32 v36, 16, v19
    ds_read_b64_tr_b16 v[48:49], v1 offset:27712
    ds_read_b64_tr_b16 v[50:51], v1 offset:28480
    s_waitcnt lgkmcnt(10)
    v_mfma_f32_16x16x32_bf16 v[88:91], v[52:55], v[120:123], v[88:91]
    v_add_f32 v34, 1.0, v34
    v_add_f32 v35, 1.0, v35
    v_mfma_f32_16x16x32_bf16 v[100:103], v[52:55], v[192:195], v[100:103]
    v_rcp_f32 v34, v34
    ds_read_b64_tr_b16 v[52:53], v1 offset:33792
    ds_read_b64_tr_b16 v[54:55], v1 offset:34560
    s_waitcnt lgkmcnt(10)
    v_mfma_f32_16x16x32_bf16 v[92:95], v[56:59], v[120:123], v[92:95]
    v_rcp_f32 v35, v35
    v_and_b32 v37, s50, v19
    v_mfma_f32_16x16x32_bf16 v[104:107], v[56:59], v[192:195], v[104:107]
    v_mul_f32 v34, v32, v34
    ds_read_b64_tr_b16 v[56:57], v1 offset:33824
    ds_read_b64_tr_b16 v[58:59], v1 offset:34592
    s_waitcnt lgkmcnt(10)
    v_mfma_f32_16x16x32_bf16 v[96:99], v[60:63], v[120:123], v[96:99]
    v_mul_f32 v35, v33, v35
    v_cvt_pk_bf16_f32 v30, v34, v35
    v_mfma_f32_16x16x32_bf16 v[108:111], v[60:63], v[192:195], v[108:111]
    s_add_u32 s49, s41, s68
    s_add_u32 s49, s49, 96
    s_add_u32 m0, s47, 12288
    s_nop 0
    buffer_load_dwordx4 v3, s[12:15], s49 offen lds
    v_lshlrev_b32 v34, 16, v30
    ds_read_b64_tr_b16 v[60:61], v1 offset:33856
    ds_read_b64_tr_b16 v[62:63], v1 offset:34624
    s_waitcnt lgkmcnt(10)
    v_mfma_f32_16x16x32_bf16 v[64:67], v[40:43], v[124:127], v[64:67]
    v_and_b32 v35, s50, v30
    v_mul_f32 v34, v34, v36
    v_mfma_f32_16x16x32_bf16 v[76:79], v[40:43], v[196:199], v[76:79]
    v_mul_f32 v35, v35, v37
    ds_read_b64_tr_b16 v[40:41], v1 offset:36864
    ds_read_b64_tr_b16 v[42:43], v1 offset:37632
    s_waitcnt lgkmcnt(10)
    v_mfma_f32_16x16x32_bf16 v[68:71], v[44:47], v[124:127], v[68:71]
    v_cvt_pk_bf16_f32 v39, v34, v35
    s_mov_b32 s52, 0
    buffer_store_dwordx2 v[38:39], v5, s[16:19], s52 offen offset:0 sc1
    v_mfma_f32_16x16x32_bf16 v[80:83], v[44:47], v[196:199], v[80:83]
    v_lshlrev_b32 v32, 16, v8
    ds_read_b64_tr_b16 v[44:45], v1 offset:36896
    ds_read_b64_tr_b16 v[46:47], v1 offset:37664
    s_waitcnt lgkmcnt(10)
    v_mfma_f32_16x16x32_bf16 v[72:75], v[48:51], v[124:127], v[72:75]
    s_add_u32 s49, s41, s68
    s_add_u32 s49, s49, 96
    s_mov_b32 exec_hi, 0
    s_add_u32 m0, s47, 13312
    s_nop 0
    buffer_load_dwordx4 v4, s[12:15], s49 offen lds
    s_mov_b32 exec_hi, -1
    v_and_b32 v33, s50, v8
    v_mul_f32 v34, 0xbfb8aa3b, v32
    v_mfma_f32_16x16x32_bf16 v[84:87], v[48:51], v[196:199], v[84:87]
    v_mul_f32 v35, 0xbfb8aa3b, v33
    ds_read_b64_tr_b16 v[48:49], v1 offset:36928
    ds_read_b64_tr_b16 v[50:51], v1 offset:37696
    s_waitcnt lgkmcnt(10)
    v_mfma_f32_16x16x32_bf16 v[88:91], v[52:55], v[124:127], v[88:91]
    v_exp_f32 v34, v34
    v_exp_f32 v35, v35
    v_mfma_f32_16x16x32_bf16 v[100:103], v[52:55], v[196:199], v[100:103]
    v_lshlrev_b32 v36, 16, v20
    ds_read_b64_tr_b16 v[52:53], v1 offset:43008
    ds_read_b64_tr_b16 v[54:55], v1 offset:43776
    s_waitcnt lgkmcnt(10)
    v_mfma_f32_16x16x32_bf16 v[92:95], v[56:59], v[124:127], v[92:95]
    v_add_f32 v34, 1.0, v34
    v_add_f32 v35, 1.0, v35
    v_mfma_f32_16x16x32_bf16 v[104:107], v[56:59], v[196:199], v[104:107]
    v_rcp_f32 v34, v34
    ds_read_b64_tr_b16 v[56:57], v1 offset:43040
    ds_read_b64_tr_b16 v[58:59], v1 offset:43808
    s_waitcnt lgkmcnt(10)
    v_mfma_f32_16x16x32_bf16 v[96:99], v[60:63], v[124:127], v[96:99]
    v_rcp_f32 v35, v35
    v_and_b32 v37, s50, v20
    v_mfma_f32_16x16x32_bf16 v[108:111], v[60:63], v[196:199], v[108:111]
    v_mul_f32 v34, v32, v34
    ds_read_b64_tr_b16 v[60:61], v1 offset:43072
    ds_read_b64_tr_b16 v[62:63], v1 offset:43840
    s_waitcnt vmcnt(11)
    s_barrier
    s_waitcnt lgkmcnt(10)
    v_mfma_f32_16x16x32_bf16 v[64:67], v[40:43], v[128:131], v[64:67]
    s_add_u32 s49, s41, s60
    s_add_u32 s49, s49, 192
    s_add_u32 m0, s47, 24576
    s_nop 0
    buffer_load_dwordx4 v3, s[12:15], s49 offen lds
    v_mul_f32 v35, v33, v35
    v_cvt_pk_bf16_f32 v30, v34, v35
    v_mfma_f32_16x16x32_bf16 v[76:79], v[40:43], v[200:203], v[76:79]
    v_lshlrev_b32 v34, 16, v30
    ds_read_b64_tr_b16 v[40:41], v1 offset:39936
    ds_read_b64_tr_b16 v[42:43], v1 offset:40704
    s_waitcnt lgkmcnt(10)
    v_mfma_f32_16x16x32_bf16 v[68:71], v[44:47], v[128:131], v[68:71]
    v_and_b32 v35, s50, v30
    v_mul_f32 v34, v34, v36
    v_mfma_f32_16x16x32_bf16 v[80:83], v[44:47], v[200:203], v[80:83]
    v_mul_f32 v35, v35, v37
    ds_read_b64_tr_b16 v[44:45], v1 offset:39968
    ds_read_b64_tr_b16 v[46:47], v1 offset:40736
    s_waitcnt lgkmcnt(10)
    v_mfma_f32_16x16x32_bf16 v[72:75], v[48:51], v[128:131], v[72:75]
    v_cvt_pk_bf16_f32 v38, v34, v35
    v_lshlrev_b32 v32, 16, v9
    v_mfma_f32_16x16x32_bf16 v[84:87], v[48:51], v[200:203], v[84:87]
    v_and_b32 v33, s50, v9
    ds_read_b64_tr_b16 v[48:49], v1 offset:40000
    ds_read_b64_tr_b16 v[50:51], v1 offset:40768
    s_waitcnt lgkmcnt(10)
    v_mfma_f32_16x16x32_bf16 v[88:91], v[52:55], v[128:131], v[88:91]
    v_mul_f32 v34, 0xbfb8aa3b, v32
    v_mul_f32 v35, 0xbfb8aa3b, v33
    v_mfma_f32_16x16x32_bf16 v[100:103], v[52:55], v[200:203], v[100:103]
    v_exp_f32 v34, v34
    ds_read_b64_tr_b16 v[52:53], v1 offset:46080
    ds_read_b64_tr_b16 v[54:55], v1 offset:46848
    s_waitcnt lgkmcnt(10)
    v_mfma_f32_16x16x32_bf16 v[92:95], v[56:59], v[128:131], v[92:95]
    v_exp_f32 v35, v35
    v_lshlrev_b32 v36, 16, v21
    v_mfma_f32_16x16x32_bf16 v[104:107], v[56:59], v[200:203], v[104:107]
    v_add_f32 v34, 1.0, v34
    ds_read_b64_tr_b16 v[56:57], v1 offset:46112
    ds_read_b64_tr_b16 v[58:59], v1 offset:46880
    s_waitcnt lgkmcnt(10)
    v_mfma_f32_16x16x32_bf16 v[96:99], v[60:63], v[128:131], v[96:99]
    v_add_f32 v35, 1.0, v35
    v_rcp_f32 v34, v34
    v_mfma_f32_16x16x32_bf16 v[108:111], v[60:63], v[200:203], v[108:111]
    s_add_u32 s49, s41, s60
    s_add_u32 s49, s49, 192
    s_mov_b32 exec_hi, 0
    s_add_u32 m0, s47, 25600
    s_nop 0
    buffer_load_dwordx4 v4, s[12:15], s49 offen lds
    s_mov_b32 exec_hi, -1
    v_rcp_f32 v35, v35
    ds_read_b64_tr_b16 v[60:61], v1 offset:46144
    ds_read_b64_tr_b16 v[62:63], v1 offset:46912
    s_waitcnt lgkmcnt(10)
    v_mfma_f32_16x16x32_bf16 v[64:67], v[40:43], v[132:135], v[64:67]
    v_and_b32 v37, s50, v21
    v_mul_f32 v34, v32, v34
    v_mfma_f32_16x16x32_bf16 v[76:79], v[40:43], v[204:207], v[76:79]
    v_mul_f32 v35, v33, v35
    ds_read_b64_tr_b16 v[40:41], v2 offset:0
    ds_read_b64_tr_b16 v[42:43], v2 offset:768
    s_waitcnt lgkmcnt(10)
    v_mfma_f32_16x16x32_bf16 v[68:71], v[44:47], v[132:135], v[68:71]
    v_cvt_pk_bf16_f32 v30, v34, v35
    v_lshlrev_b32 v34, 16, v30
    v_mfma_f32_16x16x32_bf16 v[80:83], v[44:47], v[204:207], v[80:83]
    v_and_b32 v35, s50, v30
    ds_read_b64_tr_b16 v[44:45], v2 offset:32
    ds_read_b64_tr_b16 v[46:47], v2 offset:800
    s_waitcnt lgkmcnt(10)
    v_mfma_f32_16x16x32_bf16 v[72:75], v[48:51], v[132:135], v[72:75]
    v_mul_f32 v34, v34, v36
    v_mul_f32 v35, v35, v37
    v_mfma_f32_16x16x32_bf16 v[84:87], v[48:51], v[204:207], v[84:87]
    v_cvt_pk_bf16_f32 v39, v34, v35
    ds_read_b64_tr_b16 v[48:49], v2 offset:64
    ds_read_b64_tr_b16 v[50:51], v2 offset:832
    s_waitcnt lgkmcnt(10)
    v_mfma_f32_16x16x32_bf16 v[88:91], v[52:55], v[132:135], v[88:91]
    s_mov_b32 s52, 0
    buffer_store_dwordx2 v[38:39], v5, s[16:19], s52 offen offset:512 sc1
    v_lshlrev_b32 v32, 16, v10
    v_mfma_f32_16x16x32_bf16 v[100:103], v[52:55], v[204:207], v[100:103]
    v_and_b32 v33, s50, v10
    ds_read_b64_tr_b16 v[52:53], v2 offset:6144
    ds_read_b64_tr_b16 v[54:55], v2 offset:6912
    s_waitcnt lgkmcnt(10)
    v_mfma_f32_16x16x32_bf16 v[92:95], v[56:59], v[132:135], v[92:95]
    v_mul_f32 v34, 0xbfb8aa3b, v32
    v_mul_f32 v35, 0xbfb8aa3b, v33
    v_mfma_f32_16x16x32_bf16 v[104:107], v[56:59], v[204:207], v[104:107]
    v_exp_f32 v34, v34
    ds_read_b64_tr_b16 v[56:57], v2 offset:6176
    ds_read_b64_tr_b16 v[58:59], v2 offset:6944
    s_waitcnt lgkmcnt(10)
    v_mfma_f32_16x16x32_bf16 v[96:99], v[60:63], v[132:135], v[96:99]
    v_exp_f32 v35, v35
    v_lshlrev_b32 v36, 16, v22
    v_mfma_f32_16x16x32_bf16 v[108:111], v[60:63], v[204:207], v[108:111]
    v_add_f32 v34, 1.0, v34
    ds_read_b64_tr_b16 v[60:61], v2 offset:6208
    ds_read_b64_tr_b16 v[62:63], v2 offset:6976
    s_waitcnt vmcnt(12)
    s_barrier
    s_waitcnt lgkmcnt(10)
    v_mfma_f32_16x16x32_bf16 v[64:67], v[40:43], v[136:139], v[64:67]
    s_add_u32 s49, s41, s61
    s_add_u32 s49, s49, 192
    s_add_u32 m0, s47, 36864
    s_nop 0
    buffer_load_dwordx4 v3, s[12:15], s49 offen lds
    v_add_f32 v35, 1.0, v35
    v_rcp_f32 v34, v34
    v_mfma_f32_16x16x32_bf16 v[76:79], v[40:43], v[208:211], v[76:79]
    v_rcp_f32 v35, v35
    ds_read_b64_tr_b16 v[40:41], v2 offset:3072
    ds_read_b64_tr_b16 v[42:43], v2 offset:3840
    s_waitcnt lgkmcnt(10)
    v_mfma_f32_16x16x32_bf16 v[68:71], v[44:47], v[136:139], v[68:71]
    v_and_b32 v37, s50, v22
    v_mul_f32 v34, v32, v34
    v_mfma_f32_16x16x32_bf16 v[80:83], v[44:47], v[208:211], v[80:83]
    v_mul_f32 v35, v33, v35
    ds_read_b64_tr_b16 v[44:45], v2 offset:3104
    ds_read_b64_tr_b16 v[46:47], v2 offset:3872
    s_waitcnt lgkmcnt(10)
    v_mfma_f32_16x16x32_bf16 v[72:75], v[48:51], v[136:139], v[72:75]
    v_cvt_pk_bf16_f32 v30, v34, v35
    v_lshlrev_b32 v34, 16, v30
    v_mfma_f32_16x16x32_bf16 v[84:87], v[48:51], v[208:211], v[84:87]
    v_and_b32 v35, s50, v30
    ds_read_b64_tr_b16 v[48:49], v2 offset:3136
    ds_read_b64_tr_b16 v[50:51], v2 offset:3904
    s_waitcnt lgkmcnt(10)
    v_mfma_f32_16x16x32_bf16 v[88:91], v[52:55], v[136:139], v[88:91]
    v_mul_f32 v34, v34, v36
    v_mul_f32 v35, v35, v37
    v_mfma_f32_16x16x32_bf16 v[100:103], v[52:55], v[208:211], v[100:103]
    v_cvt_pk_bf16_f32 v38, v34, v35
    ds_read_b64_tr_b16 v[52:53], v2 offset:9216
    ds_read_b64_tr_b16 v[54:55], v2 offset:9984
    s_waitcnt lgkmcnt(10)
    v_mfma_f32_16x16x32_bf16 v[92:95], v[56:59], v[136:139], v[92:95]
    v_lshlrev_b32 v32, 16, v11
    v_and_b32 v33, s50, v11
    v_mfma_f32_16x16x32_bf16 v[104:107], v[56:59], v[208:211], v[104:107]
    v_mul_f32 v34, 0xbfb8aa3b, v32
    ds_read_b64_tr_b16 v[56:57], v2 offset:9248
    ds_read_b64_tr_b16 v[58:59], v2 offset:10016
    s_waitcnt lgkmcnt(10)
    v_mfma_f32_16x16x32_bf16 v[96:99], v[60:63], v[136:139], v[96:99]
    v_mul_f32 v35, 0xbfb8aa3b, v33
    v_exp_f32 v34, v34
    v_mfma_f32_16x16x32_bf16 v[108:111], v[60:63], v[208:211], v[108:111]
    s_add_u32 s49, s41, s61
    s_add_u32 s49, s49, 192
    s_mov_b32 exec_hi, 0
    s_add_u32 m0, s47, 37888
    s_nop 0
    buffer_load_dwordx4 v4, s[12:15], s49 offen lds
    s_mov_b32 exec_hi, -1
    v_exp_f32 v35, v35
    ds_read_b64_tr_b16 v[60:61], v2 offset:9280
    ds_read_b64_tr_b16 v[62:63], v2 offset:10048
    s_waitcnt lgkmcnt(10)
    v_mfma_f32_16x16x32_bf16 v[64:67], v[40:43], v[140:143], v[64:67]
    v_lshlrev_b32 v36, 16, v23
    v_add_f32 v34, 1.0, v34
    v_mfma_f32_16x16x32_bf16 v[76:79], v[40:43], v[212:215], v[76:79]
    v_add_f32 v35, 1.0, v35
    ds_read_b64_tr_b16 v[40:41], v2 offset:12288
    ds_read_b64_tr_b16 v[42:43], v2 offset:13056
    s_waitcnt lgkmcnt(10)
    v_mfma_f32_16x16x32_bf16 v[68:71], v[44:47], v[140:143], v[68:71]
    v_rcp_f32 v34, v34
    v_rcp_f32 v35, v35
    v_mfma_f32_16x16x32_bf16 v[80:83], v[44:47], v[212:215], v[80:83]
    v_and_b32 v37, s50, v23
    ds_read_b64_tr_b16 v[44:45], v2 offset:12320
    ds_read_b64_tr_b16 v[46:47], v2 offset:13088
    s_waitcnt lgkmcnt(10)
    v_mfma_f32_16x16x32_bf16 v[72:75], v[48:51], v[140:143], v[72:75]
    v_mul_f32 v34, v32, v34
    v_mul_f32 v35, v33, v35
    v_mfma_f32_16x16x32_bf16 v[84:87], v[48:51], v[212:215], v[84:87]
    v_cvt_pk_bf16_f32 v30, v34, v35
    ds_read_b64_tr_b16 v[48:49], v2 offset:12352
    ds_read_b64_tr_b16 v[50:51], v2 offset:13120
    s_waitcnt lgkmcnt(10)
    v_mfma_f32_16x16x32_bf16 v[88:91], v[52:55], v[140:143], v[88:91]
    v_lshlrev_b32 v34, 16, v30
    v_and_b32 v35, s50, v30
    v_mfma_f32_16x16x32_bf16 v[100:103], v[52:55], v[212:215], v[100:103]
    v_mul_f32 v34, v34, v36
    ds_read_b64_tr_b16 v[52:53], v2 offset:18432
    ds_read_b64_tr_b16 v[54:55], v2 offset:19200
    s_waitcnt lgkmcnt(10)
    v_mfma_f32_16x16x32_bf16 v[92:95], v[56:59], v[140:143], v[92:95]
    v_mul_f32 v35, v35, v37
    v_cvt_pk_bf16_f32 v39, v34, v35
    v_mfma_f32_16x16x32_bf16 v[104:107], v[56:59], v[212:215], v[104:107]
    s_mov_b32 s52, 0
    buffer_store_dwordx2 v[38:39], v5, s[16:19], s52 offen offset:1024 sc1
    ds_read_b64_tr_b16 v[56:57], v2 offset:18464
    ds_read_b64_tr_b16 v[58:59], v2 offset:19232
    s_waitcnt lgkmcnt(10)
    v_mfma_f32_16x16x32_bf16 v[96:99], v[60:63], v[140:143], v[96:99]
    v_lshlrev_b32 v32, 16, v12
    v_and_b32 v33, s50, v12
    v_mfma_f32_16x16x32_bf16 v[108:111], v[60:63], v[212:215], v[108:111]
    v_mul_f32 v34, 0xbfb8aa3b, v32
    ds_read_b64_tr_b16 v[60:61], v2 offset:18496
    ds_read_b64_tr_b16 v[62:63], v2 offset:19264
    s_waitcnt vmcnt(13)
    s_barrier
    s_waitcnt lgkmcnt(10)
    v_mfma_f32_16x16x32_bf16 v[64:67], v[40:43], v[144:147], v[64:67]
    s_add_u32 s49, s41, s62
    s_add_u32 s49, s49, 192
    s_add_u32 m0, s47, 49152
    s_nop 0
    buffer_load_dwordx4 v3, s[12:15], s49 offen lds
    v_mul_f32 v35, 0xbfb8aa3b, v33
    v_exp_f32 v34, v34
    v_mfma_f32_16x16x32_bf16 v[76:79], v[40:43], v[216:219], v[76:79]
    v_exp_f32 v35, v35
    ds_read_b64_tr_b16 v[40:41], v2 offset:15360
    ds_read_b64_tr_b16 v[42:43], v2 offset:16128
    s_waitcnt lgkmcnt(10)
    v_mfma_f32_16x16x32_bf16 v[68:71], v[44:47], v[144:147], v[68:71]
    v_lshlrev_b32 v36, 16, v24
    v_add_f32 v34, 1.0, v34
    v_mfma_f32_16x16x32_bf16 v[80:83], v[44:47], v[216:219], v[80:83]
    v_add_f32 v35, 1.0, v35
    ds_read_b64_tr_b16 v[44:45], v2 offset:15392
    ds_read_b64_tr_b16 v[46:47], v2 offset:16160
    s_waitcnt lgkmcnt(10)
    v_mfma_f32_16x16x32_bf16 v[72:75], v[48:51], v[144:147], v[72:75]
    v_rcp_f32 v34, v34
    v_rcp_f32 v35, v35
    v_mfma_f32_16x16x32_bf16 v[84:87], v[48:51], v[216:219], v[84:87]
    v_and_b32 v37, s50, v24
    ds_read_b64_tr_b16 v[48:49], v2 offset:15424
    ds_read_b64_tr_b16 v[50:51], v2 offset:16192
    s_waitcnt lgkmcnt(10)
    v_mfma_f32_16x16x32_bf16 v[88:91], v[52:55], v[144:147], v[88:91]
    v_mul_f32 v34, v32, v34
    v_mul_f32 v35, v33, v35
    v_mfma_f32_16x16x32_bf16 v[100:103], v[52:55], v[216:219], v[100:103]
    v_cvt_pk_bf16_f32 v30, v34, v35
    ds_read_b64_tr_b16 v[52:53], v2 offset:21504
    ds_read_b64_tr_b16 v[54:55], v2 offset:22272
    s_waitcnt lgkmcnt(10)
    v_mfma_f32_16x16x32_bf16 v[92:95], v[56:59], v[144:147], v[92:95]
    v_lshlrev_b32 v34, 16, v30
    v_and_b32 v35, s50, v30
    v_mfma_f32_16x16x32_bf16 v[104:107], v[56:59], v[216:219], v[104:107]
    v_mul_f32 v34, v34, v36
    ds_read_b64_tr_b16 v[56:57], v2 offset:21536
    ds_read_b64_tr_b16 v[58:59], v2 offset:22304
    s_waitcnt lgkmcnt(10)
    v_mfma_f32_16x16x32_bf16 v[96:99], v[60:63], v[144:147], v[96:99]
    v_mul_f32 v35, v35, v37
    v_cvt_pk_bf16_f32 v38, v34, v35
    v_mfma_f32_16x16x32_bf16 v[108:111], v[60:63], v[216:219], v[108:111]
    s_add_u32 s49, s41, s62
    s_add_u32 s49, s49, 192
    s_mov_b32 exec_hi, 0
    s_add_u32 m0, s47, 50176
    s_nop 0
    buffer_load_dwordx4 v4, s[12:15], s49 offen lds
    s_mov_b32 exec_hi, -1
    v_lshlrev_b32 v32, 16, v13
    ds_read_b64_tr_b16 v[60:61], v2 offset:21568
    ds_read_b64_tr_b16 v[62:63], v2 offset:22336
    s_waitcnt lgkmcnt(10)
    v_mfma_f32_16x16x32_bf16 v[64:67], v[40:43], v[148:151], v[64:67]
    v_and_b32 v33, s50, v13
    v_mul_f32 v34, 0xbfb8aa3b, v32
    v_mfma_f32_16x16x32_bf16 v[76:79], v[40:43], v[220:223], v[76:79]
    v_mul_f32 v35, 0xbfb8aa3b, v33
    ds_read_b64_tr_b16 v[40:41], v2 offset:24576
    ds_read_b64_tr_b16 v[42:43], v2 offset:25344
    s_waitcnt lgkmcnt(10)
    v_mfma_f32_16x16x32_bf16 v[68:71], v[44:47], v[148:151], v[68:71]
    v_exp_f32 v34, v34
    v_exp_f32 v35, v35
    v_mfma_f32_16x16x32_bf16 v[80:83], v[44:47], v[220:223], v[80:83]
    v_lshlrev_b32 v36, 16, v25
    ds_read_b64_tr_b16 v[44:45], v2 offset:24608
    ds_read_b64_tr_b16 v[46:47], v2 offset:25376
    s_waitcnt lgkmcnt(10)
    v_mfma_f32_16x16x32_bf16 v[72:75], v[48:51], v[148:151], v[72:75]
    v_add_f32 v34, 1.0, v34
    v_add_f32 v35, 1.0, v35
    v_mfma_f32_16x16x32_bf16 v[84:87], v[48:51], v[220:223], v[84:87]
    v_rcp_f32 v34, v34
    ds_read_b64_tr_b16 v[48:49], v2 offset:24640
    ds_read_b64_tr_b16 v[50:51], v2 offset:25408
    s_waitcnt lgkmcnt(10)
    v_mfma_f32_16x16x32_bf16 v[88:91], v[52:55], v[148:151], v[88:91]
    v_rcp_f32 v35, v35
    v_and_b32 v37, s50, v25
    v_mfma_f32_16x16x32_bf16 v[100:103], v[52:55], v[220:223], v[100:103]
    v_mul_f32 v34, v32, v34
    ds_read_b64_tr_b16 v[52:53], v2 offset:30720
    ds_read_b64_tr_b16 v[54:55], v2 offset:31488
    s_waitcnt lgkmcnt(10)
    v_mfma_f32_16x16x32_bf16 v[92:95], v[56:59], v[148:151], v[92:95]
    v_mul_f32 v35, v33, v35
    v_cvt_pk_bf16_f32 v30, v34, v35
    v_mfma_f32_16x16x32_bf16 v[104:107], v[56:59], v[220:223], v[104:107]
    v_lshlrev_b32 v34, 16, v30
    ds_read_b64_tr_b16 v[56:57], v2 offset:30752
    ds_read_b64_tr_b16 v[58:59], v2 offset:31520
    s_waitcnt lgkmcnt(10)
    v_mfma_f32_16x16x32_bf16 v[96:99], v[60:63], v[148:151], v[96:99]
    v_and_b32 v35, s50, v30
    v_mul_f32 v34, v34, v36
    v_mfma_f32_16x16x32_bf16 v[108:111], v[60:63], v[220:223], v[108:111]
    v_mul_f32 v35, v35, v37
    ds_read_b64_tr_b16 v[60:61], v2 offset:30784
    ds_read_b64_tr_b16 v[62:63], v2 offset:31552
    s_waitcnt vmcnt(13)
    s_barrier
    s_waitcnt lgkmcnt(10)
    v_mfma_f32_16x16x32_bf16 v[64:67], v[40:43], v[152:155], v[64:67]
    s_add_u32 s49, s41, s63
    s_add_u32 s49, s49, 192
    s_add_u32 m0, s47, 61440
    s_nop 0
    buffer_load_dwordx4 v3, s[12:15], s49 offen lds
    v_cvt_pk_bf16_f32 v39, v34, v35
    s_mov_b32 s52, 147456
    buffer_store_dwordx2 v[38:39], v5, s[16:19], s52 offen offset:0 sc1
    v_mfma_f32_16x16x32_bf16 v[76:79], v[40:43], v[224:227], v[76:79]
    v_lshlrev_b32 v32, 16, v14
    ds_read_b64_tr_b16 v[40:41], v2 offset:27648
    ds_read_b64_tr_b16 v[42:43], v2 offset:28416
    s_waitcnt lgkmcnt(10)
    v_mfma_f32_16x16x32_bf16 v[68:71], v[44:47], v[152:155], v[68:71]
    v_and_b32 v33, s50, v14
    v_mul_f32 v34, 0xbfb8aa3b, v32
    v_mfma_f32_16x16x32_bf16 v[80:83], v[44:47], v[224:227], v[80:83]
    v_mul_f32 v35, 0xbfb8aa3b, v33
    ds_read_b64_tr_b16 v[44:45], v2 offset:27680
    ds_read_b64_tr_b16 v[46:47], v2 offset:28448
    s_waitcnt lgkmcnt(10)
    v_mfma_f32_16x16x32_bf16 v[72:75], v[48:51], v[152:155], v[72:75]
    v_exp_f32 v34, v34
    v_exp_f32 v35, v35
    v_mfma_f32_16x16x32_bf16 v[84:87], v[48:51], v[224:227], v[84:87]
    v_lshlrev_b32 v36, 16, v26
    ds_read_b64_tr_b16 v[48:49], v2 offset:27712
    ds_read_b64_tr_b16 v[50:51], v2 offset:28480
    s_waitcnt lgkmcnt(10)
    v_mfma_f32_16x16x32_bf16 v[88:91], v[52:55], v[152:155], v[88:91]
    v_add_f32 v34, 1.0, v34
    v_add_f32 v35, 1.0, v35
    v_mfma_f32_16x16x32_bf16 v[100:103], v[52:55], v[224:227], v[100:103]
    v_rcp_f32 v34, v34
    ds_read_b64_tr_b16 v[52:53], v2 offset:33792
    ds_read_b64_tr_b16 v[54:55], v2 offset:34560
    s_waitcnt lgkmcnt(10)
    v_mfma_f32_16x16x32_bf16 v[92:95], v[56:59], v[152:155], v[92:95]
    v_rcp_f32 v35, v35
    v_and_b32 v37, s50, v26
    v_mfma_f32_16x16x32_bf16 v[104:107], v[56:59], v[224:227], v[104:107]
    v_mul_f32 v34, v32, v34
    ds_read_b64_tr_b16 v[56:57], v2 offset:33824
    ds_read_b64_tr_b16 v[58:59], v2 offset:34592
    s_waitcnt lgkmcnt(10)
    v_mfma_f32_16x16x32_bf16 v[96:99], v[60:63], v[152:155], v[96:99]
    v_mul_f32 v35, v33, v35
    v_cvt_pk_bf16_f32 v30, v34, v35
    v_mfma_f32_16x16x32_bf16 v[108:111], v[60:63], v[224:227], v[108:111]
    s_add_u32 s49, s41, s63
    s_add_u32 s49, s49, 192
    s_mov_b32 exec_hi, 0
    s_add_u32 m0, s47, 62464
    s_nop 0
    buffer_load_dwordx4 v4, s[12:15], s49 offen lds
    s_mov_b32 exec_hi, -1
    v_lshlrev_b32 v34, 16, v30
    ds_read_b64_tr_b16 v[60:61], v2 offset:33856
    ds_read_b64_tr_b16 v[62:63], v2 offset:34624
    s_waitcnt lgkmcnt(10)
    v_mfma_f32_16x16x32_bf16 v[64:67], v[40:43], v[156:159], v[64:67]
    v_and_b32 v35, s50, v30
    v_mul_f32 v34, v34, v36
    v_mfma_f32_16x16x32_bf16 v[76:79], v[40:43], v[228:231], v[76:79]
    v_mul_f32 v35, v35, v37
    ds_read_b64_tr_b16 v[40:41], v2 offset:36864
    ds_read_b64_tr_b16 v[42:43], v2 offset:37632
    s_waitcnt lgkmcnt(10)
    v_mfma_f32_16x16x32_bf16 v[68:71], v[44:47], v[156:159], v[68:71]
    v_cvt_pk_bf16_f32 v38, v34, v35
    v_lshlrev_b32 v32, 16, v15
    v_mfma_f32_16x16x32_bf16 v[80:83], v[44:47], v[228:231], v[80:83]
    v_and_b32 v33, s50, v15
    ds_read_b64_tr_b16 v[44:45], v2 offset:36896
    ds_read_b64_tr_b16 v[46:47], v2 offset:37664
    s_waitcnt lgkmcnt(10)
    v_mfma_f32_16x16x32_bf16 v[72:75], v[48:51], v[156:159], v[72:75]
    v_mul_f32 v34, 0xbfb8aa3b, v32
    v_mul_f32 v35, 0xbfb8aa3b, v33
    v_mfma_f32_16x16x32_bf16 v[84:87], v[48:51], v[228:231], v[84:87]
    v_exp_f32 v34, v34
    ds_read_b64_tr_b16 v[48:49], v2 offset:36928
    ds_read_b64_tr_b16 v[50:51], v2 offset:37696
    s_waitcnt lgkmcnt(10)
    v_mfma_f32_16x16x32_bf16 v[88:91], v[52:55], v[156:159], v[88:91]
    v_exp_f32 v35, v35
    v_lshlrev_b32 v36, 16, v27
    v_mfma_f32_16x16x32_bf16 v[100:103], v[52:55], v[228:231], v[100:103]
    v_add_f32 v34, 1.0, v34
    ds_read_b64_tr_b16 v[52:53], v2 offset:43008
    ds_read_b64_tr_b16 v[54:55], v2 offset:43776
    s_waitcnt lgkmcnt(10)
    v_mfma_f32_16x16x32_bf16 v[92:95], v[56:59], v[156:159], v[92:95]
    v_add_f32 v35, 1.0, v35
    v_rcp_f32 v34, v34
    v_mfma_f32_16x16x32_bf16 v[104:107], v[56:59], v[228:231], v[104:107]
    v_rcp_f32 v35, v35
    ds_read_b64_tr_b16 v[56:57], v2 offset:43040
    ds_read_b64_tr_b16 v[58:59], v2 offset:43808
    s_waitcnt lgkmcnt(10)
    v_mfma_f32_16x16x32_bf16 v[96:99], v[60:63], v[156:159], v[96:99]
    v_and_b32 v37, s50, v27
    v_mul_f32 v34, v32, v34
    v_mfma_f32_16x16x32_bf16 v[108:111], v[60:63], v[228:231], v[108:111]
    v_mul_f32 v35, v33, v35
    ds_read_b64_tr_b16 v[60:61], v2 offset:43072
    ds_read_b64_tr_b16 v[62:63], v2 offset:43840
    s_waitcnt vmcnt(14)
    s_barrier
    s_waitcnt lgkmcnt(10)
    v_mfma_f32_16x16x32_bf16 v[64:67], v[40:43], v[160:163], v[64:67]
    s_add_u32 s49, s41, s64
    s_add_u32 s49, s49, 192
    s_add_u32 m0, s47, 73728
    s_nop 0
    buffer_load_dwordx4 v3, s[12:15], s49 offen lds
    v_cvt_pk_bf16_f32 v30, v34, v35
    v_lshlrev_b32 v34, 16, v30
    v_mfma_f32_16x16x32_bf16 v[76:79], v[40:43], v[232:235], v[76:79]
    v_and_b32 v35, s50, v30
    ds_read_b64_tr_b16 v[40:41], v2 offset:39936
    ds_read_b64_tr_b16 v[42:43], v2 offset:40704
    s_waitcnt lgkmcnt(10)
    v_mfma_f32_16x16x32_bf16 v[68:71], v[44:47], v[160:163], v[68:71]
    v_mul_f32 v34, v34, v36
    v_mul_f32 v35, v35, v37
    v_mfma_f32_16x16x32_bf16 v[80:83], v[44:47], v[232:235], v[80:83]
    v_cvt_pk_bf16_f32 v39, v34, v35
    ds_read_b64_tr_b16 v[44:45], v2 offset:39968
    ds_read_b64_tr_b16 v[46:47], v2 offset:40736
    s_waitcnt lgkmcnt(10)
    v_mfma_f32_16x16x32_bf16 v[72:75], v[48:51], v[160:163], v[72:75]
    s_mov_b32 s52, 147456
    buffer_store_dwordx2 v[38:39], v5, s[16:19], s52 offen offset:512 sc1
    v_lshlrev_b32 v32, 16, v16
    v_mfma_f32_16x16x32_bf16 v[84:87], v[48:51], v[232:235], v[84:87]
    v_and_b32 v33, s50, v16
    ds_read_b64_tr_b16 v[48:49], v2 offset:40000
    ds_read_b64_tr_b16 v[50:51], v2 offset:40768
    s_waitcnt lgkmcnt(10)
    v_mfma_f32_16x16x32_bf16 v[88:91], v[52:55], v[160:163], v[88:91]
    v_mul_f32 v34, 0xbfb8aa3b, v32
    v_mul_f32 v35, 0xbfb8aa3b, v33
    v_mfma_f32_16x16x32_bf16 v[100:103], v[52:55], v[232:235], v[100:103]
    v_exp_f32 v34, v34
    ds_read_b64_tr_b16 v[52:53], v2 offset:46080
    ds_read_b64_tr_b16 v[54:55], v2 offset:46848
    s_waitcnt lgkmcnt(10)
    v_mfma_f32_16x16x32_bf16 v[92:95], v[56:59], v[160:163], v[92:95]
    v_exp_f32 v35, v35
    v_lshlrev_b32 v36, 16, v28
    v_mfma_f32_16x16x32_bf16 v[104:107], v[56:59], v[232:235], v[104:107]
    v_add_f32 v34, 1.0, v34
    ds_read_b64_tr_b16 v[56:57], v2 offset:46112
    ds_read_b64_tr_b16 v[58:59], v2 offset:46880
    s_waitcnt lgkmcnt(10)
    v_mfma_f32_16x16x32_bf16 v[96:99], v[60:63], v[160:163], v[96:99]
    v_add_f32 v35, 1.0, v35
    v_rcp_f32 v34, v34
    v_mfma_f32_16x16x32_bf16 v[108:111], v[60:63], v[232:235], v[108:111]
    s_add_u32 s49, s41, s64
    s_add_u32 s49, s49, 192
    s_mov_b32 exec_hi, 0
    s_add_u32 m0, s47, 74752
    s_nop 0
    buffer_load_dwordx4 v4, s[12:15], s49 offen lds
    s_mov_b32 exec_hi, -1
    v_rcp_f32 v35, v35
    ds_read_b64_tr_b16 v[60:61], v2 offset:46144
    ds_read_b64_tr_b16 v[62:63], v2 offset:46912
    s_waitcnt lgkmcnt(10)
    v_mfma_f32_16x16x32_bf16 v[64:67], v[40:43], v[164:167], v[64:67]
    v_and_b32 v37, s50, v28
    v_mul_f32 v34, v32, v34
    v_mfma_f32_16x16x32_bf16 v[76:79], v[40:43], v[236:239], v[76:79]
    v_mul_f32 v35, v33, v35
    ds_read_b64_tr_b16 v[40:41], v1 offset:0
    ds_read_b64_tr_b16 v[42:43], v1 offset:768
    s_waitcnt lgkmcnt(10)
    v_mfma_f32_16x16x32_bf16 v[68:71], v[44:47], v[164:167], v[68:71]
    v_cvt_pk_bf16_f32 v30, v34, v35
    v_lshlrev_b32 v34, 16, v30
    v_mfma_f32_16x16x32_bf16 v[80:83], v[44:47], v[236:239], v[80:83]
    v_and_b32 v35, s50, v30
    ds_read_b64_tr_b16 v[44:45], v1 offset:32
    ds_read_b64_tr_b16 v[46:47], v1 offset:800
    s_waitcnt lgkmcnt(10)
    v_mfma_f32_16x16x32_bf16 v[72:75], v[48:51], v[164:167], v[72:75]
    v_mul_f32 v34, v34, v36
    v_mul_f32 v35, v35, v37
    v_mfma_f32_16x16x32_bf16 v[84:87], v[48:51], v[236:239], v[84:87]
    v_cvt_pk_bf16_f32 v38, v34, v35
    ds_read_b64_tr_b16 v[48:49], v1 offset:64
    ds_read_b64_tr_b16 v[50:51], v1 offset:832
    s_waitcnt lgkmcnt(10)
    v_mfma_f32_16x16x32_bf16 v[88:91], v[52:55], v[164:167], v[88:91]
    v_lshlrev_b32 v32, 16, v17
    v_and_b32 v33, s50, v17
    v_mfma_f32_16x16x32_bf16 v[100:103], v[52:55], v[236:239], v[100:103]
    v_mul_f32 v34, 0xbfb8aa3b, v32
    ds_read_b64_tr_b16 v[52:53], v1 offset:6144
    ds_read_b64_tr_b16 v[54:55], v1 offset:6912
    s_waitcnt lgkmcnt(10)
    v_mfma_f32_16x16x32_bf16 v[92:95], v[56:59], v[164:167], v[92:95]
    v_mul_f32 v35, 0xbfb8aa3b, v33
    v_exp_f32 v34, v34
    v_mfma_f32_16x16x32_bf16 v[104:107], v[56:59], v[236:239], v[104:107]
    v_exp_f32 v35, v35
    ds_read_b64_tr_b16 v[56:57], v1 offset:6176
    ds_read_b64_tr_b16 v[58:59], v1 offset:6944
    s_waitcnt lgkmcnt(10)
    v_mfma_f32_16x16x32_bf16 v[96:99], v[60:63], v[164:167], v[96:99]
    v_lshlrev_b32 v36, 16, v29
    v_add_f32 v34, 1.0, v34
    v_mfma_f32_16x16x32_bf16 v[108:111], v[60:63], v[236:239], v[108:111]
    v_add_f32 v35, 1.0, v35
    ds_read_b64_tr_b16 v[60:61], v1 offset:6208
    ds_read_b64_tr_b16 v[62:63], v1 offset:6976
    s_waitcnt vmcnt(14)
    s_barrier
    s_waitcnt lgkmcnt(10)
    v_mfma_f32_16x16x32_bf16 v[64:67], v[40:43], v[168:171], v[64:67]
    s_add_u32 s49, s41, s65
    s_add_u32 s49, s49, 192
    s_add_u32 m0, s47, 86016
    s_nop 0
    buffer_load_dwordx4 v3, s[12:15], s49 offen lds
    v_rcp_f32 v34, v34
    v_rcp_f32 v35, v35
    v_mfma_f32_16x16x32_bf16 v[76:79], v[40:43], v[240:243], v[76:79]
    v_and_b32 v37, s50, v29
    ds_read_b64_tr_b16 v[40:41], v1 offset:3072
    ds_read_b64_tr_b16 v[42:43], v1 offset:3840
    s_waitcnt lgkmcnt(10)
    v_mfma_f32_16x16x32_bf16 v[68:71], v[44:47], v[168:171], v[68:71]
    v_mul_f32 v34, v32, v34
    v_mul_f32 v35, v33, v35
    v_mfma_f32_16x16x32_bf16 v[80:83], v[44:47], v[240:243], v[80:83]
    v_cvt_pk_bf16_f32 v30, v34, v35
    ds_read_b64_tr_b16 v[44:45], v1 offset:3104
    ds_read_b64_tr_b16 v[46:47], v1 offset:3872
    s_waitcnt lgkmcnt(10)
    v_mfma_f32_16x16x32_bf16 v[72:75], v[48:51], v[168:171], v[72:75]
    v_lshlrev_b32 v34, 16, v30
    v_and_b32 v35, s50, v30
    v_mfma_f32_16x16x32_bf16 v[84:87], v[48:51], v[240:243], v[84:87]
    v_mul_f32 v34, v34, v36
    ds_read_b64_tr_b16 v[48:49], v1 offset:3136
    ds_read_b64_tr_b16 v[50:51], v1 offset:3904
    s_waitcnt lgkmcnt(10)
    v_mfma_f32_16x16x32_bf16 v[88:91], v[52:55], v[168:171], v[88:91]
    v_mul_f32 v35, v35, v37
    v_cvt_pk_bf16_f32 v39, v34, v35
    v_mfma_f32_16x16x32_bf16 v[100:103], v[52:55], v[240:243], v[100:103]
    s_mov_b32 s52, 147456
    buffer_store_dwordx2 v[38:39], v5, s[16:19], s52 offen offset:1024 sc1
    ds_read_b64_tr_b16 v[52:53], v1 offset:9216
    ds_read_b64_tr_b16 v[54:55], v1 offset:9984
    s_waitcnt lgkmcnt(10)
    v_mfma_f32_16x16x32_bf16 v[92:95], v[56:59], v[168:171], v[92:95]
    v_mfma_f32_16x16x32_bf16 v[104:107], v[56:59], v[240:243], v[104:107]
    ds_read_b64_tr_b16 v[56:57], v1 offset:9248
    ds_read_b64_tr_b16 v[58:59], v1 offset:10016
    s_waitcnt lgkmcnt(10)
    v_mfma_f32_16x16x32_bf16 v[96:99], v[60:63], v[168:171], v[96:99]
    v_mfma_f32_16x16x32_bf16 v[108:111], v[60:63], v[240:243], v[108:111]
    s_add_u32 s49, s41, s65
    s_add_u32 s49, s49, 192
    s_mov_b32 exec_hi, 0
    s_add_u32 m0, s47, 87040
    s_nop 0
    buffer_load_dwordx4 v4, s[12:15], s49 offen lds
    s_mov_b32 exec_hi, -1
    ds_read_b64_tr_b16 v[60:61], v1 offset:9280
    ds_read_b64_tr_b16 v[62:63], v1 offset:10048
    s_waitcnt lgkmcnt(10)
    v_mfma_f32_16x16x32_bf16 v[64:67], v[40:43], v[172:175], v[64:67]
    v_mfma_f32_16x16x32_bf16 v[76:79], v[40:43], v[244:247], v[76:79]
    ds_read_b64_tr_b16 v[40:41], v1 offset:12288
    ds_read_b64_tr_b16 v[42:43], v1 offset:13056
    s_waitcnt lgkmcnt(10)
    v_mfma_f32_16x16x32_bf16 v[68:71], v[44:47], v[172:175], v[68:71]
    v_mfma_f32_16x16x32_bf16 v[80:83], v[44:47], v[244:247], v[80:83]
    ds_read_b64_tr_b16 v[44:45], v1 offset:12320
    ds_read_b64_tr_b16 v[46:47], v1 offset:13088
    s_waitcnt lgkmcnt(10)
    v_mfma_f32_16x16x32_bf16 v[72:75], v[48:51], v[172:175], v[72:75]
    v_mfma_f32_16x16x32_bf16 v[84:87], v[48:51], v[244:247], v[84:87]
    ds_read_b64_tr_b16 v[48:49], v1 offset:12352
    ds_read_b64_tr_b16 v[50:51], v1 offset:13120
    s_waitcnt lgkmcnt(10)
    v_mfma_f32_16x16x32_bf16 v[88:91], v[52:55], v[172:175], v[88:91]
    v_mfma_f32_16x16x32_bf16 v[100:103], v[52:55], v[244:247], v[100:103]
    ds_read_b64_tr_b16 v[52:53], v1 offset:18432
    ds_read_b64_tr_b16 v[54:55], v1 offset:19200
    s_waitcnt lgkmcnt(10)
    v_mfma_f32_16x16x32_bf16 v[92:95], v[56:59], v[172:175], v[92:95]
    v_mfma_f32_16x16x32_bf16 v[104:107], v[56:59], v[244:247], v[104:107]
    ds_read_b64_tr_b16 v[56:57], v1 offset:18464
    ds_read_b64_tr_b16 v[58:59], v1 offset:19232
    s_waitcnt lgkmcnt(10)
    v_mfma_f32_16x16x32_bf16 v[96:99], v[60:63], v[172:175], v[96:99]
    v_mfma_f32_16x16x32_bf16 v[108:111], v[60:63], v[244:247], v[108:111]
    ds_read_b64_tr_b16 v[60:61], v1 offset:18496
    ds_read_b64_tr_b16 v[62:63], v1 offset:19264
    s_waitcnt vmcnt(15)
    s_barrier
    s_waitcnt lgkmcnt(10)
    v_mfma_f32_16x16x32_bf16 v[64:67], v[40:43], v[176:179], v[64:67]
    s_add_u32 s49, s41, s66
    s_add_u32 s49, s49, 192
    s_add_u32 m0, s47, 0
    s_nop 0
    buffer_load_dwordx4 v3, s[12:15], s49 offen lds
    v_mfma_f32_16x16x32_bf16 v[76:79], v[40:43], v[248:251], v[76:79]
    ds_read_b64_tr_b16 v[40:41], v1 offset:15360
    ds_read_b64_tr_b16 v[42:43], v1 offset:16128
    s_waitcnt lgkmcnt(10)
    v_mfma_f32_16x16x32_bf16 v[68:71], v[44:47], v[176:179], v[68:71]
    v_mfma_f32_16x16x32_bf16 v[80:83], v[44:47], v[248:251], v[80:83]
    ds_read_b64_tr_b16 v[44:45], v1 offset:15392
    ds_read_b64_tr_b16 v[46:47], v1 offset:16160
    s_waitcnt lgkmcnt(10)
    v_mfma_f32_16x16x32_bf16 v[72:75], v[48:51], v[176:179], v[72:75]
    v_mfma_f32_16x16x32_bf16 v[84:87], v[48:51], v[248:251], v[84:87]
    ds_read_b64_tr_b16 v[48:49], v1 offset:15424
    ds_read_b64_tr_b16 v[50:51], v1 offset:16192
    s_waitcnt lgkmcnt(10)
    v_mfma_f32_16x16x32_bf16 v[88:91], v[52:55], v[176:179], v[88:91]
    v_mfma_f32_16x16x32_bf16 v[100:103], v[52:55], v[248:251], v[100:103]
    ds_read_b64_tr_b16 v[52:53], v1 offset:21504
    ds_read_b64_tr_b16 v[54:55], v1 offset:22272
    s_waitcnt lgkmcnt(10)
    v_mfma_f32_16x16x32_bf16 v[92:95], v[56:59], v[176:179], v[92:95]
    v_mfma_f32_16x16x32_bf16 v[104:107], v[56:59], v[248:251], v[104:107]
    ds_read_b64_tr_b16 v[56:57], v1 offset:21536
    ds_read_b64_tr_b16 v[58:59], v1 offset:22304
    s_waitcnt lgkmcnt(10)
    v_mfma_f32_16x16x32_bf16 v[96:99], v[60:63], v[176:179], v[96:99]
    v_mfma_f32_16x16x32_bf16 v[108:111], v[60:63], v[248:251], v[108:111]
    s_add_u32 s49, s41, s66
    s_add_u32 s49, s49, 192
    s_mov_b32 exec_hi, 0
    s_add_u32 m0, s47, 1024
    s_nop 0
    buffer_load_dwordx4 v4, s[12:15], s49 offen lds
    s_mov_b32 exec_hi, -1
    ds_read_b64_tr_b16 v[60:61], v1 offset:21568
    ds_read_b64_tr_b16 v[62:63], v1 offset:22336
    s_waitcnt lgkmcnt(10)
    v_mfma_f32_16x16x32_bf16 v[64:67], v[40:43], v[180:183], v[64:67]
    v_mfma_f32_16x16x32_bf16 v[76:79], v[40:43], v[252:255], v[76:79]
    ds_read_b64_tr_b16 v[40:41], v1 offset:24576
    ds_read_b64_tr_b16 v[42:43], v1 offset:25344
    s_waitcnt lgkmcnt(10)
    v_mfma_f32_16x16x32_bf16 v[68:71], v[44:47], v[180:183], v[68:71]
    v_mfma_f32_16x16x32_bf16 v[80:83], v[44:47], v[252:255], v[80:83]
    ds_read_b64_tr_b16 v[44:45], v1 offset:24608
    ds_read_b64_tr_b16 v[46:47], v1 offset:25376
    s_waitcnt lgkmcnt(10)
    v_mfma_f32_16x16x32_bf16 v[72:75], v[48:51], v[180:183], v[72:75]
    v_mfma_f32_16x16x32_bf16 v[84:87], v[48:51], v[252:255], v[84:87]
    ds_read_b64_tr_b16 v[48:49], v1 offset:24640
    ds_read_b64_tr_b16 v[50:51], v1 offset:25408
    s_waitcnt lgkmcnt(10)
    v_mfma_f32_16x16x32_bf16 v[88:91], v[52:55], v[180:183], v[88:91]
    v_mfma_f32_16x16x32_bf16 v[100:103], v[52:55], v[252:255], v[100:103]
    ds_read_b64_tr_b16 v[52:53], v1 offset:30720
    ds_read_b64_tr_b16 v[54:55], v1 offset:31488
    s_waitcnt lgkmcnt(10)
    v_mfma_f32_16x16x32_bf16 v[92:95], v[56:59], v[180:183], v[92:95]
    v_mfma_f32_16x16x32_bf16 v[104:107], v[56:59], v[252:255], v[104:107]
    ds_read_b64_tr_b16 v[56:57], v1 offset:30752
    ds_read_b64_tr_b16 v[58:59], v1 offset:31520
    s_waitcnt lgkmcnt(10)
    v_mfma_f32_16x16x32_bf16 v[96:99], v[60:63], v[180:183], v[96:99]
    v_mfma_f32_16x16x32_bf16 v[108:111], v[60:63], v[252:255], v[108:111]
    ds_read_b64_tr_b16 v[60:61], v1 offset:30784
    ds_read_b64_tr_b16 v[62:63], v1 offset:31552
    s_nop 7
    s_nop 1
    v_cvt_pk_bf16_f32 v6, v64, v65
    v_cvt_pk_bf16_f32 v18, v88, v89
    v_cvt_pk_bf16_f32 v7, v66, v67
    v_cvt_pk_bf16_f32 v19, v90, v91
    v_cvt_pk_bf16_f32 v8, v68, v69
    v_cvt_pk_bf16_f32 v20, v92, v93
    v_cvt_pk_bf16_f32 v9, v70, v71
    v_cvt_pk_bf16_f32 v21, v94, v95
    v_cvt_pk_bf16_f32 v10, v72, v73
    v_cvt_pk_bf16_f32 v22, v96, v97
    v_cvt_pk_bf16_f32 v11, v74, v75
    v_cvt_pk_bf16_f32 v23, v98, v99
    v_cvt_pk_bf16_f32 v12, v76, v77
    v_cvt_pk_bf16_f32 v24, v100, v101
    v_cvt_pk_bf16_f32 v13, v78, v79
    v_cvt_pk_bf16_f32 v25, v102, v103
    v_cvt_pk_bf16_f32 v14, v80, v81
    v_cvt_pk_bf16_f32 v26, v104, v105
    v_cvt_pk_bf16_f32 v15, v82, v83
    v_cvt_pk_bf16_f32 v27, v106, v107
    v_cvt_pk_bf16_f32 v16, v84, v85
    v_cvt_pk_bf16_f32 v28, v108, v109
    v_cvt_pk_bf16_f32 v17, v86, v87
    v_cvt_pk_bf16_f32 v29, v110, v111
    s_waitcnt vmcnt(14)
    s_barrier
    s_waitcnt lgkmcnt(10)
    v_mfma_f32_16x16x32_bf16 v[64:67], v[40:43], v[112:115], 0
    s_add_u32 s49, s41, s67
    s_add_u32 s49, s49, 192
    s_add_u32 m0, s47, 12288
    s_nop 0
    buffer_load_dwordx4 v3, s[12:15], s49 offen lds
    v_mfma_f32_16x16x32_bf16 v[76:79], v[40:43], v[184:187], 0
    ds_read_b64_tr_b16 v[40:41], v1 offset:27648
    ds_read_b64_tr_b16 v[42:43], v1 offset:28416
    s_waitcnt lgkmcnt(10)
    v_mfma_f32_16x16x32_bf16 v[68:71], v[44:47], v[112:115], 0
    v_mfma_f32_16x16x32_bf16 v[80:83], v[44:47], v[184:187], 0
    ds_read_b64_tr_b16 v[44:45], v1 offset:27680
    ds_read_b64_tr_b16 v[46:47], v1 offset:28448
    s_waitcnt lgkmcnt(10)
    v_mfma_f32_16x16x32_bf16 v[72:75], v[48:51], v[112:115], 0
    v_mfma_f32_16x16x32_bf16 v[84:87], v[48:51], v[184:187], 0
    ds_read_b64_tr_b16 v[48:49], v1 offset:27712
    ds_read_b64_tr_b16 v[50:51], v1 offset:28480
    s_waitcnt lgkmcnt(10)
    v_mfma_f32_16x16x32_bf16 v[88:91], v[52:55], v[112:115], 0
    v_mfma_f32_16x16x32_bf16 v[100:103], v[52:55], v[184:187], 0
    ds_read_b64_tr_b16 v[52:53], v1 offset:33792
    ds_read_b64_tr_b16 v[54:55], v1 offset:34560
    s_waitcnt lgkmcnt(10)
    v_mfma_f32_16x16x32_bf16 v[92:95], v[56:59], v[112:115], 0
    v_mfma_f32_16x16x32_bf16 v[104:107], v[56:59], v[184:187], 0
    ds_read_b64_tr_b16 v[56:57], v1 offset:33824
    ds_read_b64_tr_b16 v[58:59], v1 offset:34592
    s_waitcnt lgkmcnt(10)
    v_mfma_f32_16x16x32_bf16 v[96:99], v[60:63], v[112:115], 0
    v_mfma_f32_16x16x32_bf16 v[108:111], v[60:63], v[184:187], 0
    s_add_u32 s49, s41, s67
    s_add_u32 s49, s49, 192
    s_mov_b32 exec_hi, 0
    s_add_u32 m0, s47, 13312
    s_nop 0
    buffer_load_dwordx4 v4, s[12:15], s49 offen lds
    s_mov_b32 exec_hi, -1
    ds_read_b64_tr_b16 v[60:61], v1 offset:33856
    ds_read_b64_tr_b16 v[62:63], v1 offset:34624
    s_waitcnt lgkmcnt(10)
    v_mfma_f32_16x16x32_bf16 v[64:67], v[40:43], v[116:119], v[64:67]
    v_lshlrev_b32 v32, 16, v6
    v_and_b32 v33, s50, v6
    v_mfma_f32_16x16x32_bf16 v[76:79], v[40:43], v[188:191], v[76:79]
    v_mul_f32 v34, 0xbfb8aa3b, v32
    ds_read_b64_tr_b16 v[40:41], v1 offset:36864
    ds_read_b64_tr_b16 v[42:43], v1 offset:37632
    s_waitcnt lgkmcnt(10)
    v_mfma_f32_16x16x32_bf16 v[68:71], v[44:47], v[116:119], v[68:71]
    v_mul_f32 v35, 0xbfb8aa3b, v33
    v_exp_f32 v34, v34
    v_mfma_f32_16x16x32_bf16 v[80:83], v[44:47], v[188:191], v[80:83]
    v_exp_f32 v35, v35
    ds_read_b64_tr_b16 v[44:45], v1 offset:36896
    ds_read_b64_tr_b16 v[46:47], v1 offset:37664
    s_waitcnt lgkmcnt(10)
    v_mfma_f32_16x16x32_bf16 v[72:75], v[48:51], v[116:119], v[72:75]
    v_lshlrev_b32 v36, 16, v18
    v_add_f32 v34, 1.0, v34
    v_mfma_f32_16x16x32_bf16 v[84:87], v[48:51], v[188:191], v[84:87]
    v_add_f32 v35, 1.0, v35
    ds_read_b64_tr_b16 v[48:49], v1 offset:36928
    ds_read_b64_tr_b16 v[50:51], v1 offset:37696
    s_waitcnt lgkmcnt(10)
    v_mfma_f32_16x16x32_bf16 v[88:91], v[52:55], v[116:119], v[88:91]
    v_rcp_f32 v34, v34
    v_rcp_f32 v35, v35
    v_mfma_f32_16x16x32_bf16 v[100:103], v[52:55], v[188:191], v[100:103]
    v_and_b32 v37, s50, v18
    ds_read_b64_tr_b16 v[52:53], v1 offset:43008
    ds_read_b64_tr_b16 v[54:55], v1 offset:43776
    s_waitcnt lgkmcnt(10)
    v_mfma_f32_16x16x32_bf16 v[92:95], v[56:59], v[116:119], v[92:95]
    v_mul_f32 v34, v32, v34
    v_mul_f32 v35, v33, v35
    v_mfma_f32_16x16x32_bf16 v[104:107], v[56:59], v[188:191], v[104:107]
    v_cvt_pk_bf16_f32 v30, v34, v35
    ds_read_b64_tr_b16 v[56:57], v1 offset:43040
    ds_read_b64_tr_b16 v[58:59], v1 offset:43808
    s_waitcnt lgkmcnt(10)
    v_mfma_f32_16x16x32_bf16 v[96:99], v[60:63], v[116:119], v[96:99]
    v_lshlrev_b32 v34, 16, v30
    v_and_b32 v35, s50, v30
    v_mfma_f32_16x16x32_bf16 v[108:111], v[60:63], v[188:191], v[108:111]
    v_mul_f32 v34, v34, v36
    ds_read_b64_tr_b16 v[60:61], v1 offset:43072
    ds_read_b64_tr_b16 v[62:63], v1 offset:43840
    s_waitcnt vmcnt(13)
    s_barrier
    s_waitcnt lgkmcnt(10)
    v_mfma_f32_16x16x32_bf16 v[64:67], v[40:43], v[120:123], v[64:67]
    s_add_u32 s49, s41, s68
    s_add_u32 s49, s49, 192
    s_add_u32 m0, s47, 24576
    s_nop 0
    buffer_load_dwordx4 v3, s[12:15], s49 offen lds
    v_mul_f32 v35, v35, v37
    v_cvt_pk_bf16_f32 v38, v34, v35
    v_mfma_f32_16x16x32_bf16 v[76:79], v[40:43], v[192:195], v[76:79]
    v_lshlrev_b32 v32, 16, v7
    ds_read_b64_tr_b16 v[40:41], v1 offset:39936
    ds_read_b64_tr_b16 v[42:43], v1 offset:40704
    s_waitcnt lgkmcnt(10)
    v_mfma_f32_16x16x32_bf16 v[68:71], v[44:47], v[120:123], v[68:71]
    v_and_b32 v33, s50, v7
    v_mul_f32 v34, 0xbfb8aa3b, v32
    v_mfma_f32_16x16x32_bf16 v[80:83], v[44:47], v[192:195], v[80:83]
    v_mul_f32 v35, 0xbfb8aa3b, v33
    ds_read_b64_tr_b16 v[44:45], v1 offset:39968
    ds_read_b64_tr_b16 v[46:47], v1 offset:40736
    s_waitcnt lgkmcnt(10)
    v_mfma_f32_16x16x32_bf16 v[72:75], v[48:51], v[120:123], v[72:75]
    v_exp_f32 v34, v34
    v_exp_f32 v35, v35
    v_mfma_f32_16x16x32_bf16 v[84:87], v[48:51], v[192:195], v[84:87]
    v_lshlrev_b32 v36, 16, v19
    ds_read_b64_tr_b16 v[48:49], v1 offset:40000
    ds_read_b64_tr_b16 v[50:51], v1 offset:40768
    s_waitcnt lgkmcnt(10)
    v_mfma_f32_16x16x32_bf16 v[88:91], v[52:55], v[120:123], v[88:91]
    v_add_f32 v34, 1.0, v34
    v_add_f32 v35, 1.0, v35
    v_mfma_f32_16x16x32_bf16 v[100:103], v[52:55], v[192:195], v[100:103]
    s_add_u32 s49, s41, s68
    s_add_u32 s49, s49, 192
    s_mov_b32 exec_hi, 0
    s_add_u32 m0, s47, 25600
    s_nop 0
    buffer_load_dwordx4 v4, s[12:15], s49 offen lds
    s_mov_b32 exec_hi, -1
    v_rcp_f32 v34, v34
    ds_read_b64_tr_b16 v[52:53], v1 offset:46080
    ds_read_b64_tr_b16 v[54:55], v1 offset:46848
    s_waitcnt lgkmcnt(10)
    v_mfma_f32_16x16x32_bf16 v[92:95], v[56:59], v[120:123], v[92:95]
    v_rcp_f32 v35, v35
    v_and_b32 v37, s50, v19
    v_mfma_f32_16x16x32_bf16 v[104:107], v[56:59], v[192:195], v[104:107]
    v_mul_f32 v34, v32, v34
    ds_read_b64_tr_b16 v[56:57], v1 offset:46112
    ds_read_b64_tr_b16 v[58:59], v1 offset:46880
    s_waitcnt lgkmcnt(10)
    v_mfma_f32_16x16x32_bf16 v[96:99], v[60:63], v[120:123], v[96:99]
    v_mul_f32 v35, v33, v35
    v_cvt_pk_bf16_f32 v30, v34, v35
    v_mfma_f32_16x16x32_bf16 v[108:111], v[60:63], v[192:195], v[108:111]
    v_lshlrev_b32 v34, 16, v30
    ds_read_b64_tr_b16 v[60:61], v1 offset:46144
    ds_read_b64_tr_b16 v[62:63], v1 offset:46912
    s_waitcnt lgkmcnt(10)
    v_mfma_f32_16x16x32_bf16 v[64:67], v[40:43], v[124:127], v[64:67]
    v_and_b32 v35, s50, v30
    v_mul_f32 v34, v34, v36
    v_mfma_f32_16x16x32_bf16 v[76:79], v[40:43], v[196:199], v[76:79]
    v_mul_f32 v35, v35, v37
    ds_read_b64_tr_b16 v[40:41], v2 offset:0
    ds_read_b64_tr_b16 v[42:43], v2 offset:768
    s_waitcnt lgkmcnt(10)
    v_mfma_f32_16x16x32_bf16 v[68:71], v[44:47], v[124:127], v[68:71]
    s_add_u32 s56, s27, 0
    s_add_u32 m0, s57, 100352
    s_nop 0
    buffer_load_dwordx4 v31, s[4:7], s56 offen lds
    v_cvt_pk_bf16_f32 v39, v34, v35
    s_mov_b32 s52, 1536
    buffer_store_dwordx2 v[38:39], v5, s[16:19], s52 offen offset:0 sc1
    v_mfma_f32_16x16x32_bf16 v[80:83], v[44:47], v[196:199], v[80:83]
    v_lshlrev_b32 v32, 16, v8
    ds_read_b64_tr_b16 v[44:45], v2 offset:32
    ds_read_b64_tr_b16 v[46:47], v2 offset:800
    s_waitcnt lgkmcnt(10)
    v_mfma_f32_16x16x32_bf16 v[72:75], v[48:51], v[124:127], v[72:75]
    v_and_b32 v33, s50, v8
    v_mul_f32 v34, 0xbfb8aa3b, v32
    v_mfma_f32_16x16x32_bf16 v[84:87], v[48:51], v[196:199], v[84:87]
    v_mul_f32 v35, 0xbfb8aa3b, v33
    ds_read_b64_tr_b16 v[48:49], v2 offset:64
    ds_read_b64_tr_b16 v[50:51], v2 offset:832
    s_waitcnt lgkmcnt(10)
    v_mfma_f32_16x16x32_bf16 v[88:91], v[52:55], v[124:127], v[88:91]
    v_exp_f32 v34, v34
    v_exp_f32 v35, v35
    v_mfma_f32_16x16x32_bf16 v[100:103], v[52:55], v[196:199], v[100:103]
    v_lshlrev_b32 v36, 16, v20
    ds_read_b64_tr_b16 v[52:53], v2 offset:6144
    ds_read_b64_tr_b16 v[54:55], v2 offset:6912
    s_waitcnt lgkmcnt(10)
    v_mfma_f32_16x16x32_bf16 v[92:95], v[56:59], v[124:127], v[92:95]
    v_add_f32 v34, 1.0, v34
    v_add_f32 v35, 1.0, v35
    v_mfma_f32_16x16x32_bf16 v[104:107], v[56:59], v[196:199], v[104:107]
    v_rcp_f32 v34, v34
    ds_read_b64_tr_b16 v[56:57], v2 offset:6176
    ds_read_b64_tr_b16 v[58:59], v2 offset:6944
    s_waitcnt lgkmcnt(10)
    v_mfma_f32_16x16x32_bf16 v[96:99], v[60:63], v[124:127], v[96:99]
    v_rcp_f32 v35, v35
    v_and_b32 v37, s50, v20
    v_mfma_f32_16x16x32_bf16 v[108:111], v[60:63], v[196:199], v[108:111]
    v_mul_f32 v34, v32, v34
    ds_read_b64_tr_b16 v[60:61], v2 offset:6208
    ds_read_b64_tr_b16 v[62:63], v2 offset:6976
    s_waitcnt vmcnt(14)
    s_barrier
    s_waitcnt lgkmcnt(10)
    v_mfma_f32_16x16x32_bf16 v[64:67], v[40:43], v[128:131], v[64:67]
    s_mov_b32 s58, s12
    s_mov_b32 s12, s24
    s_mov_b32 s24, s58
    s_mov_b32 s58, s13
    s_mov_b32 s13, s25
    s_mov_b32 s25, s58
    s_mov_b32 s58, s14
    s_mov_b32 s14, s26
    s_mov_b32 s26, s58
    s_add_u32 s49, s44, s60
    s_add_u32 m0, s47, 36864
    s_nop 0
    buffer_load_dwordx4 v3, s[12:15], s49 offen lds
    v_mul_f32 v35, v33, v35
    v_cvt_pk_bf16_f32 v30, v34, v35
    v_mfma_f32_16x16x32_bf16 v[76:79], v[40:43], v[200:203], v[76:79]
    v_lshlrev_b32 v34, 16, v30
    ds_read_b64_tr_b16 v[40:41], v2 offset:3072
    ds_read_b64_tr_b16 v[42:43], v2 offset:3840
    s_waitcnt lgkmcnt(10)
    v_mfma_f32_16x16x32_bf16 v[68:71], v[44:47], v[128:131], v[68:71]
    v_and_b32 v35, s50, v30
    v_mul_f32 v34, v34, v36
    v_mfma_f32_16x16x32_bf16 v[80:83], v[44:47], v[200:203], v[80:83]
    v_mul_f32 v35, v35, v37
    ds_read_b64_tr_b16 v[44:45], v2 offset:3104
    ds_read_b64_tr_b16 v[46:47], v2 offset:3872
    s_waitcnt lgkmcnt(10)
    v_mfma_f32_16x16x32_bf16 v[72:75], v[48:51], v[128:131], v[72:75]
    v_cvt_pk_bf16_f32 v38, v34, v35
    v_lshlrev_b32 v32, 16, v9
    v_mfma_f32_16x16x32_bf16 v[84:87], v[48:51], v[200:203], v[84:87]
    v_and_b32 v33, s50, v9
    ds_read_b64_tr_b16 v[48:49], v2 offset:3136
    ds_read_b64_tr_b16 v[50:51], v2 offset:3904
    s_waitcnt lgkmcnt(10)
    v_mfma_f32_16x16x32_bf16 v[88:91], v[52:55], v[128:131], v[88:91]
    v_mul_f32 v34, 0xbfb8aa3b, v32
    v_mul_f32 v35, 0xbfb8aa3b, v33
    v_mfma_f32_16x16x32_bf16 v[100:103], v[52:55], v[200:203], v[100:103]
    s_add_u32 s49, s44, s60
    s_mov_b32 exec_hi, 0
    s_add_u32 m0, s47, 37888
    s_nop 0
    buffer_load_dwordx4 v4, s[12:15], s49 offen lds
    s_mov_b32 exec_hi, -1
    v_exp_f32 v34, v34
    ds_read_b64_tr_b16 v[52:53], v2 offset:9216
    ds_read_b64_tr_b16 v[54:55], v2 offset:9984
    s_waitcnt lgkmcnt(10)
    v_mfma_f32_16x16x32_bf16 v[92:95], v[56:59], v[128:131], v[92:95]
    v_exp_f32 v35, v35
    v_lshlrev_b32 v36, 16, v21
    v_mfma_f32_16x16x32_bf16 v[104:107], v[56:59], v[200:203], v[104:107]
    v_add_f32 v34, 1.0, v34
    ds_read_b64_tr_b16 v[56:57], v2 offset:9248
    ds_read_b64_tr_b16 v[58:59], v2 offset:10016
    s_waitcnt lgkmcnt(10)
    v_mfma_f32_16x16x32_bf16 v[96:99], v[60:63], v[128:131], v[96:99]
    v_add_f32 v35, 1.0, v35
    v_rcp_f32 v34, v34
    v_mfma_f32_16x16x32_bf16 v[108:111], v[60:63], v[200:203], v[108:111]
    v_rcp_f32 v35, v35
    ds_read_b64_tr_b16 v[60:61], v2 offset:9280
    ds_read_b64_tr_b16 v[62:63], v2 offset:10048
    s_waitcnt lgkmcnt(10)
    v_mfma_f32_16x16x32_bf16 v[64:67], v[40:43], v[132:135], v[64:67]
    v_and_b32 v37, s50, v21
    v_mul_f32 v34, v32, v34
    v_mfma_f32_16x16x32_bf16 v[76:79], v[40:43], v[204:207], v[76:79]
    v_mul_f32 v35, v33, v35
    ds_read_b64_tr_b16 v[40:41], v2 offset:12288
    ds_read_b64_tr_b16 v[42:43], v2 offset:13056
    s_waitcnt lgkmcnt(10)
    v_mfma_f32_16x16x32_bf16 v[68:71], v[44:47], v[132:135], v[68:71]
    s_add_u32 s56, s27, 1024
    s_add_u32 m0, s57, 100352
    s_nop 0
    buffer_load_dwordx4 v31, s[4:7], s56 offen lds
    v_cvt_pk_bf16_f32 v30, v34, v35
    v_lshlrev_b32 v34, 16, v30
    v_mfma_f32_16x16x32_bf16 v[80:83], v[44:47], v[204:207], v[80:83]
    v_and_b32 v35, s50, v30
    ds_read_b64_tr_b16 v[44:45], v2 offset:12320
    ds_read_b64_tr_b16 v[46:47], v2 offset:13088
    s_waitcnt lgkmcnt(10)
    v_mfma_f32_16x16x32_bf16 v[72:75], v[48:51], v[132:135], v[72:75]
    v_mul_f32 v34, v34, v36
    v_mul_f32 v35, v35, v37
    v_mfma_f32_16x16x32_bf16 v[84:87], v[48:51], v[204:207], v[84:87]
    v_cvt_pk_bf16_f32 v39, v34, v35
    ds_read_b64_tr_b16 v[48:49], v2 offset:12352
    ds_read_b64_tr_b16 v[50:51], v2 offset:13120
    s_waitcnt lgkmcnt(10)
    v_mfma_f32_16x16x32_bf16 v[88:91], v[52:55], v[132:135], v[88:91]
    s_mov_b32 s52, 1536
    buffer_store_dwordx2 v[38:39], v5, s[16:19], s52 offen offset:512 sc1
    v_lshlrev_b32 v32, 16, v10
    v_mfma_f32_16x16x32_bf16 v[100:103], v[52:55], v[204:207], v[100:103]
    v_and_b32 v33, s50, v10
    ds_read_b64_tr_b16 v[52:53], v2 offset:18432
    ds_read_b64_tr_b16 v[54:55], v2 offset:19200
    s_waitcnt lgkmcnt(10)
    v_mfma_f32_16x16x32_bf16 v[92:95], v[56:59], v[132:135], v[92:95]
    v_mul_f32 v34, 0xbfb8aa3b, v32
    v_mul_f32 v35, 0xbfb8aa3b, v33
    v_mfma_f32_16x16x32_bf16 v[104:107], v[56:59], v[204:207], v[104:107]
    v_exp_f32 v34, v34
    ds_read_b64_tr_b16 v[56:57], v2 offset:18464
    ds_read_b64_tr_b16 v[58:59], v2 offset:19232
    s_waitcnt lgkmcnt(10)
    v_mfma_f32_16x16x32_bf16 v[96:99], v[60:63], v[132:135], v[96:99]
    v_exp_f32 v35, v35
    v_lshlrev_b32 v36, 16, v22
    v_mfma_f32_16x16x32_bf16 v[108:111], v[60:63], v[204:207], v[108:111]
    v_add_f32 v34, 1.0, v34
    ds_read_b64_tr_b16 v[60:61], v2 offset:18496
    ds_read_b64_tr_b16 v[62:63], v2 offset:19264
    s_waitcnt vmcnt(15)
    s_barrier
    s_waitcnt lgkmcnt(10)
    v_mfma_f32_16x16x32_bf16 v[64:67], v[40:43], v[136:139], v[64:67]
    s_add_u32 s49, s44, s61
    s_add_u32 m0, s47, 49152
    s_nop 0
    buffer_load_dwordx4 v3, s[12:15], s49 offen lds
    v_add_f32 v35, 1.0, v35
    v_rcp_f32 v34, v34
    v_mfma_f32_16x16x32_bf16 v[76:79], v[40:43], v[208:211], v[76:79]
    v_rcp_f32 v35, v35
    ds_read_b64_tr_b16 v[40:41], v2 offset:15360
    ds_read_b64_tr_b16 v[42:43], v2 offset:16128
    s_waitcnt lgkmcnt(10)
    v_mfma_f32_16x16x32_bf16 v[68:71], v[44:47], v[136:139], v[68:71]
    v_and_b32 v37, s50, v22
    v_mul_f32 v34, v32, v34
    v_mfma_f32_16x16x32_bf16 v[80:83], v[44:47], v[208:211], v[80:83]
    v_mul_f32 v35, v33, v35
    ds_read_b64_tr_b16 v[44:45], v2 offset:15392
    ds_read_b64_tr_b16 v[46:47], v2 offset:16160
    s_waitcnt lgkmcnt(10)
    v_mfma_f32_16x16x32_bf16 v[72:75], v[48:51], v[136:139], v[72:75]
    v_cvt_pk_bf16_f32 v30, v34, v35
    v_lshlrev_b32 v34, 16, v30
    v_mfma_f32_16x16x32_bf16 v[84:87], v[48:51], v[208:211], v[84:87]
    v_and_b32 v35, s50, v30
    ds_read_b64_tr_b16 v[48:49], v2 offset:15424
    ds_read_b64_tr_b16 v[50:51], v2 offset:16192
    s_waitcnt lgkmcnt(10)
    v_mfma_f32_16x16x32_bf16 v[88:91], v[52:55], v[136:139], v[88:91]
    v_mul_f32 v34, v34, v36
    v_mul_f32 v35, v35, v37
    v_mfma_f32_16x16x32_bf16 v[100:103], v[52:55], v[208:211], v[100:103]
    s_add_u32 s49, s44, s61
    s_mov_b32 exec_hi, 0
    s_add_u32 m0, s47, 50176
    s_nop 0
    buffer_load_dwordx4 v4, s[12:15], s49 offen lds
    s_mov_b32 exec_hi, -1
    v_cvt_pk_bf16_f32 v38, v34, v35
    ds_read_b64_tr_b16 v[52:53], v2 offset:21504
    ds_read_b64_tr_b16 v[54:55], v2 offset:22272
    s_waitcnt lgkmcnt(10)
    v_mfma_f32_16x16x32_bf16 v[92:95], v[56:59], v[136:139], v[92:95]
    v_lshlrev_b32 v32, 16, v11
    v_and_b32 v33, s50, v11
    v_mfma_f32_16x16x32_bf16 v[104:107], v[56:59], v[208:211], v[104:107]
    v_mul_f32 v34, 0xbfb8aa3b, v32
    ds_read_b64_tr_b16 v[56:57], v2 offset:21536
    ds_read_b64_tr_b16 v[58:59], v2 offset:22304
    s_waitcnt lgkmcnt(10)
    v_mfma_f32_16x16x32_bf16 v[96:99], v[60:63], v[136:139], v[96:99]
    v_mul_f32 v35, 0xbfb8aa3b, v33
    v_exp_f32 v34, v34
    v_mfma_f32_16x16x32_bf16 v[108:111], v[60:63], v[208:211], v[108:111]
    v_exp_f32 v35, v35
    ds_read_b64_tr_b16 v[60:61], v2 offset:21568
    ds_read_b64_tr_b16 v[62:63], v2 offset:22336
    s_waitcnt lgkmcnt(10)
    v_mfma_f32_16x16x32_bf16 v[64:67], v[40:43], v[140:143], v[64:67]
    v_lshlrev_b32 v36, 16, v23
    v_add_f32 v34, 1.0, v34
    v_mfma_f32_16x16x32_bf16 v[76:79], v[40:43], v[212:215], v[76:79]
    v_add_f32 v35, 1.0, v35
    ds_read_b64_tr_b16 v[40:41], v2 offset:24576
    ds_read_b64_tr_b16 v[42:43], v2 offset:25344
    s_waitcnt lgkmcnt(10)
    v_mfma_f32_16x16x32_bf16 v[68:71], v[44:47], v[140:143], v[68:71]
    s_add_u32 s56, s27, 2048
    s_add_u32 m0, s57, 100352
    s_nop 0
    buffer_load_dwordx4 v31, s[4:7], s56 offen lds
    v_rcp_f32 v34, v34
    v_rcp_f32 v35, v35
    v_mfma_f32_16x16x32_bf16 v[80:83], v[44:47], v[212:215], v[80:83]
    v_and_b32 v37, s50, v23
    ds_read_b64_tr_b16 v[44:45], v2 offset:24608
    ds_read_b64_tr_b16 v[46:47], v2 offset:25376
    s_waitcnt lgkmcnt(10)
    v_mfma_f32_16x16x32_bf16 v[72:75], v[48:51], v[140:143], v[72:75]
    v_mul_f32 v34, v32, v34
    v_mul_f32 v35, v33, v35
    v_mfma_f32_16x16x32_bf16 v[84:87], v[48:51], v[212:215], v[84:87]
    v_cvt_pk_bf16_f32 v30, v34, v35
    ds_read_b64_tr_b16 v[48:49], v2 offset:24640
    ds_read_b64_tr_b16 v[50:51], v2 offset:25408
    s_waitcnt lgkmcnt(10)
    v_mfma_f32_16x16x32_bf16 v[88:91], v[52:55], v[140:143], v[88:91]
    v_lshlrev_b32 v34, 16, v30
    v_and_b32 v35, s50, v30
    v_mfma_f32_16x16x32_bf16 v[100:103], v[52:55], v[212:215], v[100:103]
    v_mul_f32 v34, v34, v36
    ds_read_b64_tr_b16 v[52:53], v2 offset:30720
    ds_read_b64_tr_b16 v[54:55], v2 offset:31488
    s_waitcnt lgkmcnt(10)
    v_mfma_f32_16x16x32_bf16 v[92:95], v[56:59], v[140:143], v[92:95]
    v_mul_f32 v35, v35, v37
    v_cvt_pk_bf16_f32 v39, v34, v35
    v_mfma_f32_16x16x32_bf16 v[104:107], v[56:59], v[212:215], v[104:107]
    s_mov_b32 s52, 1536
    buffer_store_dwordx2 v[38:39], v5, s[16:19], s52 offen offset:1024 sc1
    ds_read_b64_tr_b16 v[56:57], v2 offset:30752
    ds_read_b64_tr_b16 v[58:59], v2 offset:31520
    s_waitcnt lgkmcnt(10)
    v_mfma_f32_16x16x32_bf16 v[96:99], v[60:63], v[140:143], v[96:99]
    v_lshlrev_b32 v32, 16, v12
    v_and_b32 v33, s50, v12
    v_mfma_f32_16x16x32_bf16 v[108:111], v[60:63], v[212:215], v[108:111]
    v_mul_f32 v34, 0xbfb8aa3b, v32
    ds_read_b64_tr_b16 v[60:61], v2 offset:30784
    ds_read_b64_tr_b16 v[62:63], v2 offset:31552
    s_waitcnt vmcnt(16)
    s_barrier
    s_waitcnt lgkmcnt(10)
    v_mfma_f32_16x16x32_bf16 v[64:67], v[40:43], v[144:147], v[64:67]
    s_add_u32 s49, s44, s62
    s_add_u32 m0, s47, 61440
    s_nop 0
    buffer_load_dwordx4 v3, s[12:15], s49 offen lds
    v_mul_f32 v35, 0xbfb8aa3b, v33
    v_exp_f32 v34, v34
    v_mfma_f32_16x16x32_bf16 v[76:79], v[40:43], v[216:219], v[76:79]
    v_exp_f32 v35, v35
    ds_read_b64_tr_b16 v[40:41], v2 offset:27648
    ds_read_b64_tr_b16 v[42:43], v2 offset:28416
    s_waitcnt lgkmcnt(10)
    v_mfma_f32_16x16x32_bf16 v[68:71], v[44:47], v[144:147], v[68:71]
    v_lshlrev_b32 v36, 16, v24
    v_add_f32 v34, 1.0, v34
    v_mfma_f32_16x16x32_bf16 v[80:83], v[44:47], v[216:219], v[80:83]
    v_add_f32 v35, 1.0, v35
    ds_read_b64_tr_b16 v[44:45], v2 offset:27680
    ds_read_b64_tr_b16 v[46:47], v2 offset:28448
    s_waitcnt lgkmcnt(10)
    v_mfma_f32_16x16x32_bf16 v[72:75], v[48:51], v[144:147], v[72:75]
    v_rcp_f32 v34, v34
    v_rcp_f32 v35, v35
    v_mfma_f32_16x16x32_bf16 v[84:87], v[48:51], v[216:219], v[84:87]
    v_and_b32 v37, s50, v24
    ds_read_b64_tr_b16 v[48:49], v2 offset:27712
    ds_read_b64_tr_b16 v[50:51], v2 offset:28480
    s_waitcnt lgkmcnt(10)
    v_mfma_f32_16x16x32_bf16 v[88:91], v[52:55], v[144:147], v[88:91]
    v_mul_f32 v34, v32, v34
    v_mul_f32 v35, v33, v35
    v_mfma_f32_16x16x32_bf16 v[100:103], v[52:55], v[216:219], v[100:103]
    s_add_u32 s49, s44, s62
    s_mov_b32 exec_hi, 0
    s_add_u32 m0, s47, 62464
    s_nop 0
    buffer_load_dwordx4 v4, s[12:15], s49 offen lds
    s_mov_b32 exec_hi, -1
    v_cvt_pk_bf16_f32 v30, v34, v35
    ds_read_b64_tr_b16 v[52:53], v2 offset:33792
    ds_read_b64_tr_b16 v[54:55], v2 offset:34560
    s_waitcnt lgkmcnt(10)
    v_mfma_f32_16x16x32_bf16 v[92:95], v[56:59], v[144:147], v[92:95]
    v_lshlrev_b32 v34, 16, v30
    v_and_b32 v35, s50, v30
    v_mfma_f32_16x16x32_bf16 v[104:107], v[56:59], v[216:219], v[104:107]
    v_mul_f32 v34, v34, v36
    ds_read_b64_tr_b16 v[56:57], v2 offset:33824
    ds_read_b64_tr_b16 v[58:59], v2 offset:34592
    s_waitcnt lgkmcnt(10)
    v_mfma_f32_16x16x32_bf16 v[96:99], v[60:63], v[144:147], v[96:99]
    v_mul_f32 v35, v35, v37
    v_cvt_pk_bf16_f32 v38, v34, v35
    v_mfma_f32_16x16x32_bf16 v[108:111], v[60:63], v[216:219], v[108:111]
    v_lshlrev_b32 v32, 16, v13
    ds_read_b64_tr_b16 v[60:61], v2 offset:33856
    ds_read_b64_tr_b16 v[62:63], v2 offset:34624
    s_waitcnt lgkmcnt(10)
    v_mfma_f32_16x16x32_bf16 v[64:67], v[40:43], v[148:151], v[64:67]
    v_and_b32 v33, s50, v13
    v_mul_f32 v34, 0xbfb8aa3b, v32
    v_mfma_f32_16x16x32_bf16 v[76:79], v[40:43], v[220:223], v[76:79]
    v_mul_f32 v35, 0xbfb8aa3b, v33
    ds_read_b64_tr_b16 v[40:41], v2 offset:36864
    ds_read_b64_tr_b16 v[42:43], v2 offset:37632
    s_waitcnt lgkmcnt(10)
    v_mfma_f32_16x16x32_bf16 v[68:71], v[44:47], v[148:151], v[68:71]
    s_add_u32 s56, s27, 3072
    s_add_u32 m0, s57, 100352
    s_nop 0
    buffer_load_dwordx4 v31, s[4:7], s56 offen lds
    v_exp_f32 v34, v34
    v_exp_f32 v35, v35
    v_mfma_f32_16x16x32_bf16 v[80:83], v[44:47], v[220:223], v[80:83]
    v_lshlrev_b32 v36, 16, v25
    ds_read_b64_tr_b16 v[44:45], v2 offset:36896
    ds_read_b64_tr_b16 v[46:47], v2 offset:37664
    s_waitcnt lgkmcnt(10)
    v_mfma_f32_16x16x32_bf16 v[72:75], v[48:51], v[148:151], v[72:75]
    v_add_f32 v34, 1.0, v34
    v_add_f32 v35, 1.0, v35
    v_mfma_f32_16x16x32_bf16 v[84:87], v[48:51], v[220:223], v[84:87]
    v_rcp_f32 v34, v34
    ds_read_b64_tr_b16 v[48:49], v2 offset:36928
    ds_read_b64_tr_b16 v[50:51], v2 offset:37696
    s_waitcnt lgkmcnt(10)
    v_mfma_f32_16x16x32_bf16 v[88:91], v[52:55], v[148:151], v[88:91]
    v_rcp_f32 v35, v35
    v_and_b32 v37, s50, v25
    v_mfma_f32_16x16x32_bf16 v[100:103], v[52:55], v[220:223], v[100:103]
    v_mul_f32 v34, v32, v34
    ds_read_b64_tr_b16 v[52:53], v2 offset:43008
    ds_read_b64_tr_b16 v[54:55], v2 offset:43776
    s_waitcnt lgkmcnt(10)
    v_mfma_f32_16x16x32_bf16 v[92:95], v[56:59], v[148:151], v[92:95]
    v_mul_f32 v35, v33, v35
    v_cvt_pk_bf16_f32 v30, v34, v35
    v_mfma_f32_16x16x32_bf16 v[104:107], v[56:59], v[220:223], v[104:107]
    v_lshlrev_b32 v34, 16, v30
    ds_read_b64_tr_b16 v[56:57], v2 offset:43040
    ds_read_b64_tr_b16 v[58:59], v2 offset:43808
    s_waitcnt lgkmcnt(10)
    v_mfma_f32_16x16x32_bf16 v[96:99], v[60:63], v[148:151], v[96:99]
    v_and_b32 v35, s50, v30
    v_mul_f32 v34, v34, v36
    v_mfma_f32_16x16x32_bf16 v[108:111], v[60:63], v[220:223], v[108:111]
    v_mul_f32 v35, v35, v37
    ds_read_b64_tr_b16 v[60:61], v2 offset:43072
    ds_read_b64_tr_b16 v[62:63], v2 offset:43840
    s_waitcnt vmcnt(17)
    s_barrier
    s_waitcnt lgkmcnt(10)
    v_mfma_f32_16x16x32_bf16 v[64:67], v[40:43], v[152:155], v[64:67]
    s_add_u32 s49, s44, s63
    s_add_u32 m0, s47, 73728
    s_nop 0
    buffer_load_dwordx4 v3, s[12:15], s49 offen lds
    v_cvt_pk_bf16_f32 v39, v34, v35
    s_mov_b32 s52, 148992
    buffer_store_dwordx2 v[38:39], v5, s[16:19], s52 offen offset:0 sc1
    v_mfma_f32_16x16x32_bf16 v[76:79], v[40:43], v[224:227], v[76:79]
    v_lshlrev_b32 v32, 16, v14
    ds_read_b64_tr_b16 v[40:41], v2 offset:39936
    ds_read_b64_tr_b16 v[42:43], v2 offset:40704
    s_waitcnt lgkmcnt(10)
    v_mfma_f32_16x16x32_bf16 v[68:71], v[44:47], v[152:155], v[68:71]
    v_and_b32 v33, s50, v14
    v_mul_f32 v34, 0xbfb8aa3b, v32
    v_mfma_f32_16x16x32_bf16 v[80:83], v[44:47], v[224:227], v[80:83]
    v_mul_f32 v35, 0xbfb8aa3b, v33
    ds_read_b64_tr_b16 v[44:45], v2 offset:39968
    ds_read_b64_tr_b16 v[46:47], v2 offset:40736
    s_waitcnt lgkmcnt(10)
    v_mfma_f32_16x16x32_bf16 v[72:75], v[48:51], v[152:155], v[72:75]
    v_exp_f32 v34, v34
    v_exp_f32 v35, v35
    v_mfma_f32_16x16x32_bf16 v[84:87], v[48:51], v[224:227], v[84:87]
    v_lshlrev_b32 v36, 16, v26
    ds_read_b64_tr_b16 v[48:49], v2 offset:40000
    ds_read_b64_tr_b16 v[50:51], v2 offset:40768
    s_waitcnt lgkmcnt(10)
    v_mfma_f32_16x16x32_bf16 v[88:91], v[52:55], v[152:155], v[88:91]
    v_add_f32 v34, 1.0, v34
    v_add_f32 v35, 1.0, v35
    v_mfma_f32_16x16x32_bf16 v[100:103], v[52:55], v[224:227], v[100:103]
    s_add_u32 s49, s44, s63
    s_mov_b32 exec_hi, 0
    s_add_u32 m0, s47, 74752
    s_nop 0
    buffer_load_dwordx4 v4, s[12:15], s49 offen lds
    s_mov_b32 exec_hi, -1
    v_rcp_f32 v34, v34
    ds_read_b64_tr_b16 v[52:53], v2 offset:46080
    ds_read_b64_tr_b16 v[54:55], v2 offset:46848
    s_waitcnt lgkmcnt(10)
    v_mfma_f32_16x16x32_bf16 v[92:95], v[56:59], v[152:155], v[92:95]
    v_rcp_f32 v35, v35
    v_and_b32 v37, s50, v26
    v_mfma_f32_16x16x32_bf16 v[104:107], v[56:59], v[224:227], v[104:107]
    v_mul_f32 v34, v32, v34
    ds_read_b64_tr_b16 v[56:57], v2 offset:46112
    ds_read_b64_tr_b16 v[58:59], v2 offset:46880
    s_waitcnt lgkmcnt(10)
    v_mfma_f32_16x16x32_bf16 v[96:99], v[60:63], v[152:155], v[96:99]
    v_mul_f32 v35, v33, v35
    v_cvt_pk_bf16_f32 v30, v34, v35
    v_mfma_f32_16x16x32_bf16 v[108:111], v[60:63], v[224:227], v[108:111]
    v_lshlrev_b32 v34, 16, v30
    ds_read_b64_tr_b16 v[60:61], v2 offset:46144
    ds_read_b64_tr_b16 v[62:63], v2 offset:46912
    s_waitcnt lgkmcnt(10)
    v_mfma_f32_16x16x32_bf16 v[64:67], v[40:43], v[156:159], v[64:67]
    v_and_b32 v35, s50, v30
    v_mul_f32 v34, v34, v36
    v_mfma_f32_16x16x32_bf16 v[76:79], v[40:43], v[228:231], v[76:79]
    v_mul_f32 v35, v35, v37
    ds_read_b64_tr_b16 v[40:41], v1 offset:0
    ds_read_b64_tr_b16 v[42:43], v1 offset:768
    s_waitcnt lgkmcnt(10)
    v_mfma_f32_16x16x32_bf16 v[68:71], v[44:47], v[156:159], v[68:71]
    s_add_u32 s56, s27, 4096
    s_add_u32 m0, s57, 100352
    s_nop 0
    buffer_load_dwordx4 v31, s[4:7], s56 offen lds
    v_cvt_pk_bf16_f32 v38, v34, v35
    v_lshlrev_b32 v32, 16, v15
    v_mfma_f32_16x16x32_bf16 v[80:83], v[44:47], v[228:231], v[80:83]
    v_and_b32 v33, s50, v15
    ds_read_b64_tr_b16 v[44:45], v1 offset:32
    ds_read_b64_tr_b16 v[46:47], v1 offset:800
    s_waitcnt lgkmcnt(10)
    v_mfma_f32_16x16x32_bf16 v[72:75], v[48:51], v[156:159], v[72:75]
    v_mul_f32 v34, 0xbfb8aa3b, v32
    v_mul_f32 v35, 0xbfb8aa3b, v33
    v_mfma_f32_16x16x32_bf16 v[84:87], v[48:51], v[228:231], v[84:87]
    v_exp_f32 v34, v34
    ds_read_b64_tr_b16 v[48:49], v1 offset:64
    ds_read_b64_tr_b16 v[50:51], v1 offset:832
    s_waitcnt lgkmcnt(10)
    v_mfma_f32_16x16x32_bf16 v[88:91], v[52:55], v[156:159], v[88:91]
    v_exp_f32 v35, v35
    v_lshlrev_b32 v36, 16, v27
    v_mfma_f32_16x16x32_bf16 v[100:103], v[52:55], v[228:231], v[100:103]
    v_add_f32 v34, 1.0, v34
    ds_read_b64_tr_b16 v[52:53], v1 offset:6144
    ds_read_b64_tr_b16 v[54:55], v1 offset:6912
    s_waitcnt lgkmcnt(10)
    v_mfma_f32_16x16x32_bf16 v[92:95], v[56:59], v[156:159], v[92:95]
    v_add_f32 v35, 1.0, v35
    v_rcp_f32 v34, v34
    v_mfma_f32_16x16x32_bf16 v[104:107], v[56:59], v[228:231], v[104:107]
    v_rcp_f32 v35, v35
    ds_read_b64_tr_b16 v[56:57], v1 offset:6176
    ds_read_b64_tr_b16 v[58:59], v1 offset:6944
    s_waitcnt lgkmcnt(10)
    v_mfma_f32_16x16x32_bf16 v[96:99], v[60:63], v[156:159], v[96:99]
    v_and_b32 v37, s50, v27
    v_mul_f32 v34, v32, v34
    v_mfma_f32_16x16x32_bf16 v[108:111], v[60:63], v[228:231], v[108:111]
    v_mul_f32 v35, v33, v35
    ds_read_b64_tr_b16 v[60:61], v1 offset:6208
    ds_read_b64_tr_b16 v[62:63], v1 offset:6976
    s_waitcnt vmcnt(19)
    s_barrier
    s_waitcnt lgkmcnt(10)
    v_mfma_f32_16x16x32_bf16 v[64:67], v[40:43], v[160:163], v[64:67]
    s_add_u32 s49, s44, s64
    s_add_u32 m0, s47, 86016
    s_nop 0
    buffer_load_dwordx4 v3, s[12:15], s49 offen lds
    v_cvt_pk_bf16_f32 v30, v34, v35
    v_lshlrev_b32 v34, 16, v30
    v_mfma_f32_16x16x32_bf16 v[76:79], v[40:43], v[232:235], v[76:79]
    v_and_b32 v35, s50, v30
    ds_read_b64_tr_b16 v[40:41], v1 offset:3072
    ds_read_b64_tr_b16 v[42:43], v1 offset:3840
    s_waitcnt lgkmcnt(10)
    v_mfma_f32_16x16x32_bf16 v[68:71], v[44:47], v[160:163], v[68:71]
    v_mul_f32 v34, v34, v36
    v_mul_f32 v35, v35, v37
    v_mfma_f32_16x16x32_bf16 v[80:83], v[44:47], v[232:235], v[80:83]
    v_cvt_pk_bf16_f32 v39, v34, v35
    ds_read_b64_tr_b16 v[44:45], v1 offset:3104
    ds_read_b64_tr_b16 v[46:47], v1 offset:3872
    s_waitcnt lgkmcnt(10)
    v_mfma_f32_16x16x32_bf16 v[72:75], v[48:51], v[160:163], v[72:75]
    s_mov_b32 s52, 148992
    buffer_store_dwordx2 v[38:39], v5, s[16:19], s52 offen offset:512 sc1
    v_lshlrev_b32 v32, 16, v16
    v_mfma_f32_16x16x32_bf16 v[84:87], v[48:51], v[232:235], v[84:87]
    v_and_b32 v33, s50, v16
    ds_read_b64_tr_b16 v[48:49], v1 offset:3136
    ds_read_b64_tr_b16 v[50:51], v1 offset:3904
    s_waitcnt lgkmcnt(10)
    v_mfma_f32_16x16x32_bf16 v[88:91], v[52:55], v[160:163], v[88:91]
    v_mul_f32 v34, 0xbfb8aa3b, v32
    v_mul_f32 v35, 0xbfb8aa3b, v33
    v_mfma_f32_16x16x32_bf16 v[100:103], v[52:55], v[232:235], v[100:103]
    s_add_u32 s49, s44, s64
    s_mov_b32 exec_hi, 0
    s_add_u32 m0, s47, 87040
    s_nop 0
    buffer_load_dwordx4 v4, s[12:15], s49 offen lds
    s_mov_b32 exec_hi, -1
    v_exp_f32 v34, v34
    ds_read_b64_tr_b16 v[52:53], v1 offset:9216
    ds_read_b64_tr_b16 v[54:55], v1 offset:9984
    s_waitcnt lgkmcnt(10)
    v_mfma_f32_16x16x32_bf16 v[92:95], v[56:59], v[160:163], v[92:95]
    v_exp_f32 v35, v35
    v_lshlrev_b32 v36, 16, v28
    v_mfma_f32_16x16x32_bf16 v[104:107], v[56:59], v[232:235], v[104:107]
    v_add_f32 v34, 1.0, v34
    ds_read_b64_tr_b16 v[56:57], v1 offset:9248
    ds_read_b64_tr_b16 v[58:59], v1 offset:10016
    s_waitcnt lgkmcnt(10)
    v_mfma_f32_16x16x32_bf16 v[96:99], v[60:63], v[160:163], v[96:99]
    v_add_f32 v35, 1.0, v35
    v_rcp_f32 v34, v34
    v_mfma_f32_16x16x32_bf16 v[108:111], v[60:63], v[232:235], v[108:111]
    v_rcp_f32 v35, v35
    ds_read_b64_tr_b16 v[60:61], v1 offset:9280
    ds_read_b64_tr_b16 v[62:63], v1 offset:10048
    s_waitcnt lgkmcnt(10)
    v_mfma_f32_16x16x32_bf16 v[64:67], v[40:43], v[164:167], v[64:67]
    v_and_b32 v37, s50, v28
    v_mul_f32 v34, v32, v34
    v_mfma_f32_16x16x32_bf16 v[76:79], v[40:43], v[236:239], v[76:79]
    v_mul_f32 v35, v33, v35
    ds_read_b64_tr_b16 v[40:41], v1 offset:12288
    ds_read_b64_tr_b16 v[42:43], v1 offset:13056
    s_waitcnt lgkmcnt(10)
    v_mfma_f32_16x16x32_bf16 v[68:71], v[44:47], v[164:167], v[68:71]
    s_add_u32 s56, s27, 5120
    s_add_u32 m0, s57, 100352
    s_nop 0
    buffer_load_dwordx4 v31, s[4:7], s56 offen lds
    v_cvt_pk_bf16_f32 v30, v34, v35
    v_lshlrev_b32 v34, 16, v30
    v_mfma_f32_16x16x32_bf16 v[80:83], v[44:47], v[236:239], v[80:83]
    v_and_b32 v35, s50, v30
    ds_read_b64_tr_b16 v[44:45], v1 offset:12320
    ds_read_b64_tr_b16 v[46:47], v1 offset:13088
    s_waitcnt lgkmcnt(10)
    v_mfma_f32_16x16x32_bf16 v[72:75], v[48:51], v[164:167], v[72:75]
    v_mul_f32 v34, v34, v36
    v_mul_f32 v35, v35, v37
    v_mfma_f32_16x16x32_bf16 v[84:87], v[48:51], v[236:239], v[84:87]
    v_cvt_pk_bf16_f32 v38, v34, v35
    ds_read_b64_tr_b16 v[48:49], v1 offset:12352
    ds_read_b64_tr_b16 v[50:51], v1 offset:13120
    s_waitcnt lgkmcnt(10)
    v_mfma_f32_16x16x32_bf16 v[88:91], v[52:55], v[164:167], v[88:91]
    v_lshlrev_b32 v32, 16, v17
    v_and_b32 v33, s50, v17
    v_mfma_f32_16x16x32_bf16 v[100:103], v[52:55], v[236:239], v[100:103]
    v_mul_f32 v34, 0xbfb8aa3b, v32
    ds_read_b64_tr_b16 v[52:53], v1 offset:18432
    ds_read_b64_tr_b16 v[54:55], v1 offset:19200
    s_waitcnt lgkmcnt(10)
    v_mfma_f32_16x16x32_bf16 v[92:95], v[56:59], v[164:167], v[92:95]
    v_mul_f32 v35, 0xbfb8aa3b, v33
    v_exp_f32 v34, v34
    v_mfma_f32_16x16x32_bf16 v[104:107], v[56:59], v[236:239], v[104:107]
    v_exp_f32 v35, v35
    ds_read_b64_tr_b16 v[56:57], v1 offset:18464
    ds_read_b64_tr_b16 v[58:59], v1 offset:19232
    s_waitcnt lgkmcnt(10)
    v_mfma_f32_16x16x32_bf16 v[96:99], v[60:63], v[164:167], v[96:99]
    v_lshlrev_b32 v36, 16, v29
    v_add_f32 v34, 1.0, v34
    v_mfma_f32_16x16x32_bf16 v[108:111], v[60:63], v[236:239], v[108:111]
    v_add_f32 v35, 1.0, v35
    ds_read_b64_tr_b16 v[60:61], v1 offset:18496
    ds_read_b64_tr_b16 v[62:63], v1 offset:19264
    s_waitcnt vmcnt(21)
    s_barrier
    s_waitcnt lgkmcnt(10)
    v_mfma_f32_16x16x32_bf16 v[64:67], v[40:43], v[168:171], v[64:67]
    s_add_u32 s49, s44, s65
    s_add_u32 m0, s47, 0
    s_nop 0
    buffer_load_dwordx4 v3, s[12:15], s49 offen lds
    v_rcp_f32 v34, v34
    v_rcp_f32 v35, v35
    v_mfma_f32_16x16x32_bf16 v[76:79], v[40:43], v[240:243], v[76:79]
    v_and_b32 v37, s50, v29
    ds_read_b64_tr_b16 v[40:41], v1 offset:15360
    ds_read_b64_tr_b16 v[42:43], v1 offset:16128
    s_waitcnt lgkmcnt(10)
    v_mfma_f32_16x16x32_bf16 v[68:71], v[44:47], v[168:171], v[68:71]
    v_mul_f32 v34, v32, v34
    v_mul_f32 v35, v33, v35
    v_mfma_f32_16x16x32_bf16 v[80:83], v[44:47], v[240:243], v[80:83]
    v_cvt_pk_bf16_f32 v30, v34, v35
    ds_read_b64_tr_b16 v[44:45], v1 offset:15392
    ds_read_b64_tr_b16 v[46:47], v1 offset:16160
    s_waitcnt lgkmcnt(10)
    v_mfma_f32_16x16x32_bf16 v[72:75], v[48:51], v[168:171], v[72:75]
    v_lshlrev_b32 v34, 16, v30
    v_and_b32 v35, s50, v30
    v_mfma_f32_16x16x32_bf16 v[84:87], v[48:51], v[240:243], v[84:87]
    v_mul_f32 v34, v34, v36
    ds_read_b64_tr_b16 v[48:49], v1 offset:15424
    ds_read_b64_tr_b16 v[50:51], v1 offset:16192
    s_waitcnt lgkmcnt(10)
    v_mfma_f32_16x16x32_bf16 v[88:91], v[52:55], v[168:171], v[88:91]
    v_mul_f32 v35, v35, v37
    v_cvt_pk_bf16_f32 v39, v34, v35
    v_mfma_f32_16x16x32_bf16 v[100:103], v[52:55], v[240:243], v[100:103]
    s_mov_b32 s52, 148992
    buffer_store_dwordx2 v[38:39], v5, s[16:19], s52 offen offset:1024 sc1
    ds_read_b64_tr_b16 v[52:53], v1 offset:21504
    ds_read_b64_tr_b16 v[54:55], v1 offset:22272
    s_waitcnt lgkmcnt(10)
    v_mfma_f32_16x16x32_bf16 v[92:95], v[56:59], v[168:171], v[92:95]
    v_mfma_f32_16x16x32_bf16 v[104:107], v[56:59], v[240:243], v[104:107]
    ds_read_b64_tr_b16 v[56:57], v1 offset:21536
    ds_read_b64_tr_b16 v[58:59], v1 offset:22304
    s_waitcnt lgkmcnt(10)
    v_mfma_f32_16x16x32_bf16 v[96:99], v[60:63], v[168:171], v[96:99]
    v_mfma_f32_16x16x32_bf16 v[108:111], v[60:63], v[240:243], v[108:111]
    s_add_u32 s49, s44, s65
    s_mov_b32 exec_hi, 0
    s_add_u32 m0, s47, 1024
    s_nop 0
    buffer_load_dwordx4 v4, s[12:15], s49 offen lds
    s_mov_b32 exec_hi, -1
    ds_read_b64_tr_b16 v[60:61], v1 offset:21568
    ds_read_b64_tr_b16 v[62:63], v1 offset:22336
    s_waitcnt lgkmcnt(10)
    v_mfma_f32_16x16x32_bf16 v[64:67], v[40:43], v[172:175], v[64:67]
    v_mfma_f32_16x16x32_bf16 v[76:79], v[40:43], v[244:247], v[76:79]
    ds_read_b64_tr_b16 v[40:41], v1 offset:24576
    ds_read_b64_tr_b16 v[42:43], v1 offset:25344
    s_waitcnt lgkmcnt(10)
    v_mfma_f32_16x16x32_bf16 v[68:71], v[44:47], v[172:175], v[68:71]
    v_mfma_f32_16x16x32_bf16 v[80:83], v[44:47], v[244:247], v[80:83]
    ds_read_b64_tr_b16 v[44:45], v1 offset:24608
    ds_read_b64_tr_b16 v[46:47], v1 offset:25376
    s_waitcnt lgkmcnt(10)
    v_mfma_f32_16x16x32_bf16 v[72:75], v[48:51], v[172:175], v[72:75]
    v_mfma_f32_16x16x32_bf16 v[84:87], v[48:51], v[244:247], v[84:87]
    ds_read_b64_tr_b16 v[48:49], v1 offset:24640
    ds_read_b64_tr_b16 v[50:51], v1 offset:25408
    s_waitcnt lgkmcnt(10)
    v_mfma_f32_16x16x32_bf16 v[88:91], v[52:55], v[172:175], v[88:91]
    v_mfma_f32_16x16x32_bf16 v[100:103], v[52:55], v[244:247], v[100:103]
    ds_read_b64_tr_b16 v[52:53], v1 offset:30720
    ds_read_b64_tr_b16 v[54:55], v1 offset:31488
    s_waitcnt lgkmcnt(10)
    v_mfma_f32_16x16x32_bf16 v[92:95], v[56:59], v[172:175], v[92:95]
    v_mfma_f32_16x16x32_bf16 v[104:107], v[56:59], v[244:247], v[104:107]
    ds_read_b64_tr_b16 v[56:57], v1 offset:30752
    ds_read_b64_tr_b16 v[58:59], v1 offset:31520
    s_waitcnt lgkmcnt(10)
    v_mfma_f32_16x16x32_bf16 v[96:99], v[60:63], v[172:175], v[96:99]
    v_mfma_f32_16x16x32_bf16 v[108:111], v[60:63], v[244:247], v[108:111]
    ds_read_b64_tr_b16 v[60:61], v1 offset:30784
    ds_read_b64_tr_b16 v[62:63], v1 offset:31552
    s_waitcnt vmcnt(20)
    s_barrier
    s_waitcnt lgkmcnt(10)
    v_mfma_f32_16x16x32_bf16 v[64:67], v[40:43], v[176:179], v[64:67]
    s_add_u32 s49, s44, s66
    s_add_u32 m0, s47, 12288
    s_nop 0
    buffer_load_dwordx4 v3, s[12:15], s49 offen lds
    v_mfma_f32_16x16x32_bf16 v[76:79], v[40:43], v[248:251], v[76:79]
    ds_read_b64_tr_b16 v[40:41], v1 offset:27648
    ds_read_b64_tr_b16 v[42:43], v1 offset:28416
    s_waitcnt lgkmcnt(10)
    v_mfma_f32_16x16x32_bf16 v[68:71], v[44:47], v[176:179], v[68:71]
    v_mfma_f32_16x16x32_bf16 v[80:83], v[44:47], v[248:251], v[80:83]
    ds_read_b64_tr_b16 v[44:45], v1 offset:27680
    ds_read_b64_tr_b16 v[46:47], v1 offset:28448
    s_waitcnt lgkmcnt(10)
    v_mfma_f32_16x16x32_bf16 v[72:75], v[48:51], v[176:179], v[72:75]
    v_mfma_f32_16x16x32_bf16 v[84:87], v[48:51], v[248:251], v[84:87]
    ds_read_b64_tr_b16 v[48:49], v1 offset:27712
    ds_read_b64_tr_b16 v[50:51], v1 offset:28480
    s_waitcnt lgkmcnt(10)
    v_mfma_f32_16x16x32_bf16 v[88:91], v[52:55], v[176:179], v[88:91]
    v_mfma_f32_16x16x32_bf16 v[100:103], v[52:55], v[248:251], v[100:103]
    ds_read_b64_tr_b16 v[52:53], v1 offset:33792
    ds_read_b64_tr_b16 v[54:55], v1 offset:34560
    s_waitcnt lgkmcnt(10)
    v_mfma_f32_16x16x32_bf16 v[92:95], v[56:59], v[176:179], v[92:95]
    v_mfma_f32_16x16x32_bf16 v[104:107], v[56:59], v[248:251], v[104:107]
    ds_read_b64_tr_b16 v[56:57], v1 offset:33824
    ds_read_b64_tr_b16 v[58:59], v1 offset:34592
    s_waitcnt lgkmcnt(10)
    v_mfma_f32_16x16x32_bf16 v[96:99], v[60:63], v[176:179], v[96:99]
    v_mfma_f32_16x16x32_bf16 v[108:111], v[60:63], v[248:251], v[108:111]
    s_add_u32 s49, s44, s66
    s_mov_b32 exec_hi, 0
    s_add_u32 m0, s47, 13312
    s_nop 0
    buffer_load_dwordx4 v4, s[12:15], s49 offen lds
    s_mov_b32 exec_hi, -1
    ds_read_b64_tr_b16 v[60:61], v1 offset:33856
    ds_read_b64_tr_b16 v[62:63], v1 offset:34624
    s_waitcnt lgkmcnt(10)
    v_mfma_f32_16x16x32_bf16 v[64:67], v[40:43], v[180:183], v[64:67]
    v_mfma_f32_16x16x32_bf16 v[76:79], v[40:43], v[252:255], v[76:79]
    ds_read_b64_tr_b16 v[40:41], v1 offset:36864
    ds_read_b64_tr_b16 v[42:43], v1 offset:37632
    s_waitcnt lgkmcnt(10)
    v_mfma_f32_16x16x32_bf16 v[68:71], v[44:47], v[180:183], v[68:71]
    v_mfma_f32_16x16x32_bf16 v[80:83], v[44:47], v[252:255], v[80:83]
    ds_read_b64_tr_b16 v[44:45], v1 offset:36896
    ds_read_b64_tr_b16 v[46:47], v1 offset:37664
    s_waitcnt lgkmcnt(10)
    v_mfma_f32_16x16x32_bf16 v[72:75], v[48:51], v[180:183], v[72:75]
    v_mfma_f32_16x16x32_bf16 v[84:87], v[48:51], v[252:255], v[84:87]
    ds_read_b64_tr_b16 v[48:49], v1 offset:36928
    ds_read_b64_tr_b16 v[50:51], v1 offset:37696
    s_waitcnt lgkmcnt(10)
    v_mfma_f32_16x16x32_bf16 v[88:91], v[52:55], v[180:183], v[88:91]
    v_mfma_f32_16x16x32_bf16 v[100:103], v[52:55], v[252:255], v[100:103]
    s_waitcnt lgkmcnt(8)
    v_mfma_f32_16x16x32_bf16 v[92:95], v[56:59], v[180:183], v[92:95]
    v_mfma_f32_16x16x32_bf16 v[104:107], v[56:59], v[252:255], v[104:107]
    s_waitcnt lgkmcnt(6)
    v_mfma_f32_16x16x32_bf16 v[96:99], v[60:63], v[180:183], v[96:99]
    v_mfma_f32_16x16x32_bf16 v[108:111], v[60:63], v[252:255], v[108:111]
    s_nop 7
    s_nop 1
    v_cvt_pk_bf16_f32 v6, v64, v65
    v_cvt_pk_bf16_f32 v18, v88, v89
    v_cvt_pk_bf16_f32 v7, v66, v67
    v_cvt_pk_bf16_f32 v19, v90, v91
    v_cvt_pk_bf16_f32 v8, v68, v69
    v_cvt_pk_bf16_f32 v20, v92, v93
    v_cvt_pk_bf16_f32 v9, v70, v71
    v_cvt_pk_bf16_f32 v21, v94, v95
    v_cvt_pk_bf16_f32 v10, v72, v73
    v_cvt_pk_bf16_f32 v22, v96, v97
    v_cvt_pk_bf16_f32 v11, v74, v75
    v_cvt_pk_bf16_f32 v23, v98, v99
    v_cvt_pk_bf16_f32 v12, v76, v77
    v_cvt_pk_bf16_f32 v24, v100, v101
    v_cvt_pk_bf16_f32 v13, v78, v79
    v_cvt_pk_bf16_f32 v25, v102, v103
    v_cvt_pk_bf16_f32 v14, v80, v81
    v_cvt_pk_bf16_f32 v26, v104, v105
    v_cvt_pk_bf16_f32 v15, v82, v83
    v_cvt_pk_bf16_f32 v27, v106, v107
    v_cvt_pk_bf16_f32 v16, v84, v85
    v_cvt_pk_bf16_f32 v28, v108, v109
    v_cvt_pk_bf16_f32 v17, v86, v87
    v_cvt_pk_bf16_f32 v29, v110, v111
    s_waitcnt vmcnt(18)
    s_barrier
    s_waitcnt lgkmcnt(4)
    v_mfma_f32_16x16x32_bf16 v[64:67], v[40:43], v[112:115], 0
    s_add_u32 s49, s44, s67
    s_add_u32 m0, s47, 24576
    s_nop 0
    buffer_load_dwordx4 v3, s[12:15], s49 offen lds
    v_lshlrev_b32 v32, 16, v6
    v_and_b32 v33, s50, v6
    v_mul_f32 v34, 0xbfb8aa3b, v32
    v_mfma_f32_16x16x32_bf16 v[76:79], v[40:43], v[184:187], 0
    v_mul_f32 v35, 0xbfb8aa3b, v33
    v_exp_f32 v34, v34
    v_exp_f32 v35, v35
    ds_read_b64_tr_b16 v[40:41], v1 offset:39936
    ds_read_b64_tr_b16 v[42:43], v1 offset:40704
    s_waitcnt lgkmcnt(4)
    v_mfma_f32_16x16x32_bf16 v[68:71], v[44:47], v[112:115], 0
    v_lshlrev_b32 v36, 16, v18
    v_add_f32 v34, 1.0, v34
    v_add_f32 v35, 1.0, v35
    v_mfma_f32_16x16x32_bf16 v[80:83], v[44:47], v[184:187], 0
    v_rcp_f32 v34, v34
    v_rcp_f32 v35, v35
    v_and_b32 v37, s50, v18
    ds_read_b64_tr_b16 v[44:45], v1 offset:39968
    ds_read_b64_tr_b16 v[46:47], v1 offset:40736
    s_waitcnt lgkmcnt(4)
    v_mfma_f32_16x16x32_bf16 v[72:75], v[48:51], v[112:115], 0
    v_mul_f32 v34, v32, v34
    v_mul_f32 v35, v33, v35
    v_cvt_pk_bf16_f32 v30, v34, v35
    v_mfma_f32_16x16x32_bf16 v[84:87], v[48:51], v[184:187], 0
    s_add_u32 s49, s44, s67
    s_mov_b32 exec_hi, 0
    s_add_u32 m0, s47, 25600
    s_nop 0
    buffer_load_dwordx4 v4, s[12:15], s49 offen lds
    s_mov_b32 exec_hi, -1
    v_lshlrev_b32 v34, 16, v30
    v_and_b32 v35, s50, v30
    v_mul_f32 v34, v34, v36
    ds_read_b64_tr_b16 v[48:49], v1 offset:40000
    ds_read_b64_tr_b16 v[50:51], v1 offset:40768
    s_waitcnt lgkmcnt(4)
    v_mfma_f32_16x16x32_bf16 v[64:67], v[40:43], v[116:119], v[64:67]
    v_mul_f32 v35, v35, v37
    v_cvt_pk_bf16_f32 v38, v34, v35
    v_lshlrev_b32 v32, 16, v7
    v_mfma_f32_16x16x32_bf16 v[76:79], v[40:43], v[188:191], v[76:79]
    v_and_b32 v33, s50, v7
    v_mul_f32 v34, 0xbfb8aa3b, v32
    v_mul_f32 v35, 0xbfb8aa3b, v33
    ds_read_b64_tr_b16 v[40:41], v2 offset:0
    ds_read_b64_tr_b16 v[42:43], v2 offset:768
    s_waitcnt lgkmcnt(4)
    v_mfma_f32_16x16x32_bf16 v[68:71], v[44:47], v[116:119], v[68:71]
    v_exp_f32 v34, v34
    v_exp_f32 v35, v35
    v_lshlrev_b32 v36, 16, v19
    v_mfma_f32_16x16x32_bf16 v[80:83], v[44:47], v[188:191], v[80:83]
    v_add_f32 v34, 1.0, v34
    v_add_f32 v35, 1.0, v35
    v_rcp_f32 v34, v34
    ds_read_b64_tr_b16 v[44:45], v2 offset:32
    ds_read_b64_tr_b16 v[46:47], v2 offset:800
    s_waitcnt lgkmcnt(4)
    v_mfma_f32_16x16x32_bf16 v[72:75], v[48:51], v[116:119], v[72:75]
    v_rcp_f32 v35, v35
    v_and_b32 v37, s50, v19
    v_mul_f32 v34, v32, v34
    v_mfma_f32_16x16x32_bf16 v[84:87], v[48:51], v[188:191], v[84:87]
    v_mul_f32 v35, v33, v35
    v_cvt_pk_bf16_f32 v30, v34, v35
    v_lshlrev_b32 v34, 16, v30
    ds_read_b64_tr_b16 v[48:49], v2 offset:64
    ds_read_b64_tr_b16 v[50:51], v2 offset:832
    s_waitcnt vmcnt(16)
    s_barrier
    s_waitcnt lgkmcnt(4)
    v_mfma_f32_16x16x32_bf16 v[64:67], v[40:43], v[120:123], v[64:67]
    s_add_u32 s49, s44, s68
    s_add_u32 m0, s47, 36864
    s_nop 0
    buffer_load_dwordx4 v3, s[12:15], s49 offen lds
    v_and_b32 v35, s50, v30
    v_mul_f32 v34, v34, v36
    v_mul_f32 v35, v35, v37
    v_mfma_f32_16x16x32_bf16 v[76:79], v[40:43], v[192:195], v[76:79]
    v_cvt_pk_bf16_f32 v39, v34, v35
    s_mov_b32 s52, 3072
    buffer_store_dwordx2 v[38:39], v5, s[16:19], s52 offen offset:0 sc1
    v_lshlrev_b32 v32, 16, v8
    ds_read_b64_tr_b16 v[40:41], v2 offset:3072
    ds_read_b64_tr_b16 v[42:43], v2 offset:3840
    s_waitcnt lgkmcnt(4)
    v_mfma_f32_16x16x32_bf16 v[68:71], v[44:47], v[120:123], v[68:71]
    v_and_b32 v33, s50, v8
    v_mul_f32 v34, 0xbfb8aa3b, v32
    v_mul_f32 v35, 0xbfb8aa3b, v33
    v_mfma_f32_16x16x32_bf16 v[80:83], v[44:47], v[192:195], v[80:83]
    v_exp_f32 v34, v34
    v_exp_f32 v35, v35
    v_lshlrev_b32 v36, 16, v20
    ds_read_b64_tr_b16 v[44:45], v2 offset:3104
    ds_read_b64_tr_b16 v[46:47], v2 offset:3872
    s_waitcnt lgkmcnt(4)
    v_mfma_f32_16x16x32_bf16 v[72:75], v[48:51], v[120:123], v[72:75]
    v_add_f32 v34, 1.0, v34
    v_add_f32 v35, 1.0, v35
    v_rcp_f32 v34, v34
    v_mfma_f32_16x16x32_bf16 v[84:87], v[48:51], v[192:195], v[84:87]
    s_add_u32 s49, s44, s68
    s_mov_b32 exec_hi, 0
    s_add_u32 m0, s47, 37888
    s_nop 0
    buffer_load_dwordx4 v4, s[12:15], s49 offen lds
    s_mov_b32 exec_hi, -1
    v_rcp_f32 v35, v35
    v_and_b32 v37, s50, v20
    v_mul_f32 v34, v32, v34
    ds_read_b64_tr_b16 v[48:49], v2 offset:3136
    ds_read_b64_tr_b16 v[50:51], v2 offset:3904
    s_waitcnt lgkmcnt(4)
    v_mfma_f32_16x16x32_bf16 v[64:67], v[40:43], v[124:127], v[64:67]
    v_mul_f32 v35, v33, v35
    v_cvt_pk_bf16_f32 v30, v34, v35
    v_lshlrev_b32 v34, 16, v30
    v_mfma_f32_16x16x32_bf16 v[76:79], v[40:43], v[196:199], v[76:79]
    v_and_b32 v35, s50, v30
    v_mul_f32 v34, v34, v36
    v_mul_f32 v35, v35, v37
    ds_read_b64_tr_b16 v[40:41], v2 offset:12288
    ds_read_b64_tr_b16 v[42:43], v2 offset:13056
    s_waitcnt lgkmcnt(4)
    v_mfma_f32_16x16x32_bf16 v[68:71], v[44:47], v[124:127], v[68:71]
    v_cvt_pk_bf16_f32 v38, v34, v35
    v_lshlrev_b32 v32, 16, v9
    v_and_b32 v33, s50, v9
    v_mfma_f32_16x16x32_bf16 v[80:83], v[44:47], v[196:199], v[80:83]
    v_mul_f32 v34, 0xbfb8aa3b, v32
    v_mul_f32 v35, 0xbfb8aa3b, v33
    v_exp_f32 v34, v34
    ds_read_b64_tr_b16 v[44:45], v2 offset:12320
    ds_read_b64_tr_b16 v[46:47], v2 offset:13088
    s_waitcnt lgkmcnt(4)
    v_mfma_f32_16x16x32_bf16 v[72:75], v[48:51], v[124:127], v[72:75]
    v_exp_f32 v35, v35
    v_lshlrev_b32 v36, 16, v21
    v_add_f32 v34, 1.0, v34
    v_mfma_f32_16x16x32_bf16 v[84:87], v[48:51], v[196:199], v[84:87]
    v_add_f32 v35, 1.0, v35
    v_rcp_f32 v34, v34
    v_rcp_f32 v35, v35
    ds_read_b64_tr_b16 v[48:49], v2 offset:12352
    ds_read_b64_tr_b16 v[50:51], v2 offset:13120
    s_waitcnt vmcnt(15)
    s_barrier
    s_waitcnt lgkmcnt(4)
    v_mfma_f32_16x16x32_bf16 v[64:67], v[40:43], v[128:131], v[64:67]
    v_and_b32 v37, s50, v21
    v_mul_f32 v34, v32, v34
    v_mul_f32 v35, v33, v35
    v_mfma_f32_16x16x32_bf16 v[76:79], v[40:43], v[200:203], v[76:79]
    v_cvt_pk_bf16_f32 v30, v34, v35
    v_lshlrev_b32 v34, 16, v30
    v_and_b32 v35, s50, v30
    ds_read_b64_tr_b16 v[40:41], v2 offset:15360
    ds_read_b64_tr_b16 v[42:43], v2 offset:16128
    s_waitcnt lgkmcnt(4)
    v_mfma_f32_16x16x32_bf16 v[68:71], v[44:47], v[128:131], v[68:71]
    v_mul_f32 v34, v34, v36
    v_mul_f32 v35, v35, v37
    v_cvt_pk_bf16_f32 v39, v34, v35
    v_mfma_f32_16x16x32_bf16 v[80:83], v[44:47], v[200:203], v[80:83]
    s_mov_b32 s52, 3072
    buffer_store_dwordx2 v[38:39], v5, s[16:19], s52 offen offset:512 sc1
    v_lshlrev_b32 v32, 16, v10
    v_and_b32 v33, s50, v10
    ds_read_b64_tr_b16 v[44:45], v2 offset:15392
    ds_read_b64_tr_b16 v[46:47], v2 offset:16160
    s_waitcnt lgkmcnt(4)
    v_mfma_f32_16x16x32_bf16 v[72:75], v[48:51], v[128:131], v[72:75]
    v_mul_f32 v34, 0xbfb8aa3b, v32
    v_mul_f32 v35, 0xbfb8aa3b, v33
    v_exp_f32 v34, v34
    v_mfma_f32_16x16x32_bf16 v[84:87], v[48:51], v[200:203], v[84:87]
    v_exp_f32 v35, v35
    v_lshlrev_b32 v36, 16, v22
    v_add_f32 v34, 1.0, v34
    ds_read_b64_tr_b16 v[48:49], v2 offset:15424
    ds_read_b64_tr_b16 v[50:51], v2 offset:16192
    s_waitcnt lgkmcnt(4)
    v_mfma_f32_16x16x32_bf16 v[64:67], v[40:43], v[132:135], v[64:67]
    v_add_f32 v35, 1.0, v35
    v_rcp_f32 v34, v34
    v_rcp_f32 v35, v35
    v_mfma_f32_16x16x32_bf16 v[76:79], v[40:43], v[204:207], v[76:79]
    v_and_b32 v37, s50, v22
    v_mul_f32 v34, v32, v34
    v_mul_f32 v35, v33, v35
    ds_read_b64_tr_b16 v[40:41], v2 offset:24576
    ds_read_b64_tr_b16 v[42:43], v2 offset:25344
    s_waitcnt lgkmcnt(4)
    v_mfma_f32_16x16x32_bf16 v[68:71], v[44:47], v[132:135], v[68:71]
    v_cvt_pk_bf16_f32 v30, v34, v35
    v_lshlrev_b32 v34, 16, v30
    v_and_b32 v35, s50, v30
    v_mfma_f32_16x16x32_bf16 v[80:83], v[44:47], v[204:207], v[80:83]
    v_mul_f32 v34, v34, v36
    v_mul_f32 v35, v35, v37
    v_cvt_pk_bf16_f32 v38, v34, v35
    ds_read_b64_tr_b16 v[44:45], v2 offset:24608
    ds_read_b64_tr_b16 v[46:47], v2 offset:25376
    s_waitcnt lgkmcnt(4)
    v_mfma_f32_16x16x32_bf16 v[72:75], v[48:51], v[132:135], v[72:75]
    v_lshlrev_b32 v32, 16, v11
    v_and_b32 v33, s50, v11
    v_mul_f32 v34, 0xbfb8aa3b, v32
    v_mfma_f32_16x16x32_bf16 v[84:87], v[48:51], v[204:207], v[84:87]
    v_mul_f32 v35, 0xbfb8aa3b, v33
    v_exp_f32 v34, v34
    v_exp_f32 v35, v35
    ds_read_b64_tr_b16 v[48:49], v2 offset:24640
    ds_read_b64_tr_b16 v[50:51], v2 offset:25408
    s_waitcnt vmcnt(12)
    s_barrier
    s_waitcnt lgkmcnt(4)
    v_mfma_f32_16x16x32_bf16 v[64:67], v[40:43], v[136:139], v[64:67]
    v_lshlrev_b32 v36, 16, v23
    v_add_f32 v34, 1.0, v34
    v_add_f32 v35, 1.0, v35
    v_mfma_f32_16x16x32_bf16 v[76:79], v[40:43], v[208:211], v[76:79]
    v_rcp_f32 v34, v34
    v_rcp_f32 v35, v35
    v_and_b32 v37, s50, v23
    ds_read_b64_tr_b16 v[40:41], v2 offset:27648
    ds_read_b64_tr_b16 v[42:43], v2 offset:28416
    s_waitcnt lgkmcnt(4)
    v_mfma_f32_16x16x32_bf16 v[68:71], v[44:47], v[136:139], v[68:71]
    v_mul_f32 v34, v32, v34
    v_mul_f32 v35, v33, v35
    v_cvt_pk_bf16_f32 v30, v34, v35
    v_mfma_f32_16x16x32_bf16 v[80:83], v[44:47], v[208:211], v[80:83]
    v_lshlrev_b32 v34, 16, v30
    v_and_b32 v35, s50, v30
    v_mul_f32 v34, v34, v36
    ds_read_b64_tr_b16 v[44:45], v2 offset:27680
    ds_read_b64_tr_b16 v[46:47], v2 offset:28448
    s_waitcnt lgkmcnt(4)
    v_mfma_f32_16x16x32_bf16 v[72:75], v[48:51], v[136:139], v[72:75]
    v_mul_f32 v35, v35, v37
    v_cvt_pk_bf16_f32 v39, v34, v35
    s_mov_b32 s52, 3072
    buffer_store_dwordx2 v[38:39], v5, s[16:19], s52 offen offset:1024 sc1
    v_mfma_f32_16x16x32_bf16 v[84:87], v[48:51], v[208:211], v[84:87]
    v_lshlrev_b32 v32, 16, v12
    v_and_b32 v33, s50, v12
    v_mul_f32 v34, 0xbfb8aa3b, v32
    ds_read_b64_tr_b16 v[48:49], v2 offset:27712
    ds_read_b64_tr_b16 v[50:51], v2 offset:28480
    s_waitcnt lgkmcnt(4)
    v_mfma_f32_16x16x32_bf16 v[64:67], v[40:43], v[140:143], v[64:67]
    v_mul_f32 v35, 0xbfb8aa3b, v33
    v_exp_f32 v34, v34
    v_exp_f32 v35, v35
    v_mfma_f32_16x16x32_bf16 v[76:79], v[40:43], v[212:215], v[76:79]
    v_lshlrev_b32 v36, 16, v24
    v_add_f32 v34, 1.0, v34
    v_add_f32 v35, 1.0, v35
    ds_read_b64_tr_b16 v[40:41], v2 offset:36864
    ds_read_b64_tr_b16 v[42:43], v2 offset:37632
    s_waitcnt lgkmcnt(4)
    v_mfma_f32_16x16x32_bf16 v[68:71], v[44:47], v[140:143], v[68:71]
    v_rcp_f32 v34, v34
    v_rcp_f32 v35, v35
    v_and_b32 v37, s50, v24
    v_mfma_f32_16x16x32_bf16 v[80:83], v[44:47], v[212:215], v[80:83]
    v_mul_f32 v34, v32, v34
    v_mul_f32 v35, v33, v35
    v_cvt_pk_bf16_f32 v30, v34, v35
    ds_read_b64_tr_b16 v[44:45], v2 offset:36896
    ds_read_b64_tr_b16 v[46:47], v2 offset:37664
    s_waitcnt lgkmcnt(4)
    v_mfma_f32_16x16x32_bf16 v[72:75], v[48:51], v[140:143], v[72:75]
    v_lshlrev_b32 v34, 16, v30
    v_and_b32 v35, s50, v30
    v_mul_f32 v34, v34, v36
    v_mfma_f32_16x16x32_bf16 v[84:87], v[48:51], v[212:215], v[84:87]
    v_mul_f32 v35, v35, v37
    v_cvt_pk_bf16_f32 v38, v34, v35
    v_lshlrev_b32 v32, 16, v13
    ds_read_b64_tr_b16 v[48:49], v2 offset:36928
    ds_read_b64_tr_b16 v[50:51], v2 offset:37696
    s_waitcnt vmcnt(9)
    s_barrier
    s_waitcnt lgkmcnt(4)
    v_mfma_f32_16x16x32_bf16 v[64:67], v[40:43], v[144:147], v[64:67]
    v_and_b32 v33, s50, v13
    v_mul_f32 v34, 0xbfb8aa3b, v32
    v_mul_f32 v35, 0xbfb8aa3b, v33
    v_mfma_f32_16x16x32_bf16 v[76:79], v[40:43], v[216:219], v[76:79]
    v_exp_f32 v34, v34
    v_exp_f32 v35, v35
    v_lshlrev_b32 v36, 16, v25
    ds_read_b64_tr_b16 v[40:41], v2 offset:39936
    ds_read_b64_tr_b16 v[42:43], v2 offset:40704
    s_waitcnt lgkmcnt(4)
    v_mfma_f32_16x16x32_bf16 v[68:71], v[44:47], v[144:147], v[68:71]
    v_add_f32 v34, 1.0, v34
    v_add_f32 v35, 1.0, v35
    v_rcp_f32 v34, v34
    v_mfma_f32_16x16x32_bf16 v[80:83], v[44:47], v[216:219], v[80:83]
    v_rcp_f32 v35, v35
    v_and_b32 v37, s50, v25
    v_mul_f32 v34, v32, v34
    ds_read_b64_tr_b16 v[44:45], v2 offset:39968
    ds_read_b64_tr_b16 v[46:47], v2 offset:40736
    s_waitcnt lgkmcnt(4)
    v_mfma_f32_16x16x32_bf16 v[72:75], v[48:51], v[144:147], v[72:75]
    v_mul_f32 v35, v33, v35
    v_cvt_pk_bf16_f32 v30, v34, v35
    v_lshlrev_b32 v34, 16, v30
    v_mfma_f32_16x16x32_bf16 v[84:87], v[48:51], v[216:219], v[84:87]
    v_and_b32 v35, s50, v30
    v_mul_f32 v34, v34, v36
    v_mul_f32 v35, v35, v37
    ds_read_b64_tr_b16 v[48:49], v2 offset:40000
    ds_read_b64_tr_b16 v[50:51], v2 offset:40768
    s_waitcnt lgkmcnt(4)
    v_mfma_f32_16x16x32_bf16 v[64:67], v[40:43], v[148:151], v[64:67]
    v_cvt_pk_bf16_f32 v39, v34, v35
    s_mov_b32 s52, 150528
    buffer_store_dwordx2 v[38:39], v5, s[16:19], s52 offen offset:0 sc1
    v_lshlrev_b32 v32, 16, v14
    v_mfma_f32_16x16x32_bf16 v[76:79], v[40:43], v[220:223], v[76:79]
    v_and_b32 v33, s50, v14
    v_mul_f32 v34, 0xbfb8aa3b, v32
    v_mul_f32 v35, 0xbfb8aa3b, v33
    ds_read_b64_tr_b16 v[40:41], v1 offset:0
    ds_read_b64_tr_b16 v[42:43], v1 offset:768
    s_waitcnt lgkmcnt(4)
    v_mfma_f32_16x16x32_bf16 v[68:71], v[44:47], v[148:151], v[68:71]
    v_exp_f32 v34, v34
    v_exp_f32 v35, v35
    v_lshlrev_b32 v36, 16, v26
    v_mfma_f32_16x16x32_bf16 v[80:83], v[44:47], v[220:223], v[80:83]
    v_add_f32 v34, 1.0, v34
    v_add_f32 v35, 1.0, v35
    v_rcp_f32 v34, v34
    ds_read_b64_tr_b16 v[44:45], v1 offset:32
    ds_read_b64_tr_b16 v[46:47], v1 offset:800
    s_waitcnt lgkmcnt(4)
    v_mfma_f32_16x16x32_bf16 v[72:75], v[48:51], v[148:151], v[72:75]
    v_rcp_f32 v35, v35
    v_and_b32 v37, s50, v26
    v_mul_f32 v34, v32, v34
    v_mfma_f32_16x16x32_bf16 v[84:87], v[48:51], v[220:223], v[84:87]
    v_mul_f32 v35, v33, v35
    v_cvt_pk_bf16_f32 v30, v34, v35
    v_lshlrev_b32 v34, 16, v30
    ds_read_b64_tr_b16 v[48:49], v1 offset:64
    ds_read_b64_tr_b16 v[50:51], v1 offset:832
    s_waitcnt vmcnt(8)
    s_barrier
    s_waitcnt lgkmcnt(4)
    v_mfma_f32_16x16x32_bf16 v[64:67], v[40:43], v[152:155], v[64:67]
    v_and_b32 v35, s50, v30
    v_mul_f32 v34, v34, v36
    v_mul_f32 v35, v35, v37
    v_mfma_f32_16x16x32_bf16 v[76:79], v[40:43], v[224:227], v[76:79]
    v_cvt_pk_bf16_f32 v38, v34, v35
    v_lshlrev_b32 v32, 16, v15
    v_and_b32 v33, s50, v15
    ds_read_b64_tr_b16 v[40:41], v1 offset:3072
    ds_read_b64_tr_b16 v[42:43], v1 offset:3840
    s_waitcnt lgkmcnt(4)
    v_mfma_f32_16x16x32_bf16 v[68:71], v[44:47], v[152:155], v[68:71]
    v_mul_f32 v34, 0xbfb8aa3b, v32
    v_mul_f32 v35, 0xbfb8aa3b, v33
    v_exp_f32 v34, v34
    v_mfma_f32_16x16x32_bf16 v[80:83], v[44:47], v[224:227], v[80:83]
    v_exp_f32 v35, v35
    v_lshlrev_b32 v36, 16, v27
    v_add_f32 v34, 1.0, v34
    ds_read_b64_tr_b16 v[44:45], v1 offset:3104
    ds_read_b64_tr_b16 v[46:47], v1 offset:3872
    s_waitcnt lgkmcnt(4)
    v_mfma_f32_16x16x32_bf16 v[72:75], v[48:51], v[152:155], v[72:75]
    v_add_f32 v35, 1.0, v35
    v_rcp_f32 v34, v34
    v_rcp_f32 v35, v35
    v_mfma_f32_16x16x32_bf16 v[84:87], v[48:51], v[224:227], v[84:87]
    v_and_b32 v37, s50, v27
    v_mul_f32 v34, v32, v34
    v_mul_f32 v35, v33, v35
    ds_read_b64_tr_b16 v[48:49], v1 offset:3136
    ds_read_b64_tr_b16 v[50:51], v1 offset:3904
    s_waitcnt lgkmcnt(4)
    v_mfma_f32_16x16x32_bf16 v[64:67], v[40:43], v[156:159], v[64:67]
    v_cvt_pk_bf16_f32 v30, v34, v35
    v_lshlrev_b32 v34, 16, v30
    v_and_b32 v35, s50, v30
    v_mfma_f32_16x16x32_bf16 v[76:79], v[40:43], v[228:231], v[76:79]
    v_mul_f32 v34, v34, v36
    v_mul_f32 v35, v35, v37
    v_cvt_pk_bf16_f32 v39, v34, v35
    ds_read_b64_tr_b16 v[40:41], v1 offset:12288
    ds_read_b64_tr_b16 v[42:43], v1 offset:13056
    s_waitcnt lgkmcnt(4)
    v_mfma_f32_16x16x32_bf16 v[68:71], v[44:47], v[156:159], v[68:71]
    s_mov_b32 s52, 150528
    buffer_store_dwordx2 v[38:39], v5, s[16:19], s52 offen offset:512 sc1
    v_lshlrev_b32 v32, 16, v16
    v_and_b32 v33, s50, v16
    v_mfma_f32_16x16x32_bf16 v[80:83], v[44:47], v[228:231], v[80:83]
    v_mul_f32 v34, 0xbfb8aa3b, v32
    v_mul_f32 v35, 0xbfb8aa3b, v33
    v_exp_f32 v34, v34
    ds_read_b64_tr_b16 v[44:45], v1 offset:12320
    ds_read_b64_tr_b16 v[46:47], v1 offset:13088
    s_waitcnt lgkmcnt(4)
    v_mfma_f32_16x16x32_bf16 v[72:75], v[48:51], v[156:159], v[72:75]
    v_exp_f32 v35, v35
    v_lshlrev_b32 v36, 16, v28
    v_add_f32 v34, 1.0, v34
    v_mfma_f32_16x16x32_bf16 v[84:87], v[48:51], v[228:231], v[84:87]
    v_add_f32 v35, 1.0, v35
    v_rcp_f32 v34, v34
    v_rcp_f32 v35, v35
    ds_read_b64_tr_b16 v[48:49], v1 offset:12352
    ds_read_b64_tr_b16 v[50:51], v1 offset:13120
    s_waitcnt vmcnt(7)
    s_barrier
    s_waitcnt lgkmcnt(4)
    v_mfma_f32_16x16x32_bf16 v[64:67], v[40:43], v[160:163], v[64:67]
    v_and_b32 v37, s50, v28
    v_mul_f32 v34, v32, v34
    v_mul_f32 v35, v33, v35
    v_mfma_f32_16x16x32_bf16 v[76:79], v[40:43], v[232:235], v[76:79]
    v_cvt_pk_bf16_f32 v30, v34, v35
    v_lshlrev_b32 v34, 16, v30
    v_and_b32 v35, s50, v30
    ds_read_b64_tr_b16 v[40:41], v1 offset:15360
    ds_read_b64_tr_b16 v[42:43], v1 offset:16128
    s_waitcnt lgkmcnt(4)
    v_mfma_f32_16x16x32_bf16 v[68:71], v[44:47], v[160:163], v[68:71]
    v_mul_f32 v34, v34, v36
    v_mul_f32 v35, v35, v37
    v_cvt_pk_bf16_f32 v38, v34, v35
    v_mfma_f32_16x16x32_bf16 v[80:83], v[44:47], v[232:235], v[80:83]
    v_lshlrev_b32 v32, 16, v17
    v_and_b32 v33, s50, v17
    v_mul_f32 v34, 0xbfb8aa3b, v32
    ds_read_b64_tr_b16 v[44:45], v1 offset:15392
    ds_read_b64_tr_b16 v[46:47], v1 offset:16160
    s_waitcnt lgkmcnt(4)
    v_mfma_f32_16x16x32_bf16 v[72:75], v[48:51], v[160:163], v[72:75]
    v_mul_f32 v35, 0xbfb8aa3b, v33
    v_exp_f32 v34, v34
    v_exp_f32 v35, v35
    v_mfma_f32_16x16x32_bf16 v[84:87], v[48:51], v[232:235], v[84:87]
    v_lshlrev_b32 v36, 16, v29
    v_add_f32 v34, 1.0, v34
    v_add_f32 v35, 1.0, v35
    ds_read_b64_tr_b16 v[48:49], v1 offset:15424
    ds_read_b64_tr_b16 v[50:51], v1 offset:16192
    s_waitcnt lgkmcnt(4)
    v_mfma_f32_16x16x32_bf16 v[64:67], v[40:43], v[164:167], v[64:67]
    v_rcp_f32 v34, v34
    v_rcp_f32 v35, v35
    v_and_b32 v37, s50, v29
    v_mfma_f32_16x16x32_bf16 v[76:79], v[40:43], v[236:239], v[76:79]
    v_mul_f32 v34, v32, v34
    v_mul_f32 v35, v33, v35
    v_cvt_pk_bf16_f32 v30, v34, v35
    ds_read_b64_tr_b16 v[40:41], v1 offset:24576
    ds_read_b64_tr_b16 v[42:43], v1 offset:25344
    s_waitcnt lgkmcnt(4)
    v_mfma_f32_16x16x32_bf16 v[68:71], v[44:47], v[164:167], v[68:71]
    v_lshlrev_b32 v34, 16, v30
    v_and_b32 v35, s50, v30
    v_mul_f32 v34, v34, v36
    v_mfma_f32_16x16x32_bf16 v[80:83], v[44:47], v[236:239], v[80:83]
    v_mul_f32 v35, v35, v37
    v_cvt_pk_bf16_f32 v39, v34, v35
    s_mov_b32 s52, 150528
    buffer_store_dwordx2 v[38:39], v5, s[16:19], s52 offen offset:1024 sc1
    ds_read_b64_tr_b16 v[44:45], v1 offset:24608
    ds_read_b64_tr_b16 v[46:47], v1 offset:25376
    s_waitcnt lgkmcnt(4)
    v_mfma_f32_16x16x32_bf16 v[72:75], v[48:51], v[164:167], v[72:75]
    v_mfma_f32_16x16x32_bf16 v[84:87], v[48:51], v[236:239], v[84:87]
    ds_read_b64_tr_b16 v[48:49], v1 offset:24640
    ds_read_b64_tr_b16 v[50:51], v1 offset:25408
    s_waitcnt vmcnt(5)
    s_barrier
    s_waitcnt lgkmcnt(4)
    v_mfma_f32_16x16x32_bf16 v[64:67], v[40:43], v[168:171], v[64:67]
    v_mfma_f32_16x16x32_bf16 v[76:79], v[40:43], v[240:243], v[76:79]
    ds_read_b64_tr_b16 v[40:41], v1 offset:27648
    ds_read_b64_tr_b16 v[42:43], v1 offset:28416
    s_waitcnt lgkmcnt(4)
    v_mfma_f32_16x16x32_bf16 v[68:71], v[44:47], v[168:171], v[68:71]
    v_mfma_f32_16x16x32_bf16 v[80:83], v[44:47], v[240:243], v[80:83]
    ds_read_b64_tr_b16 v[44:45], v1 offset:27680
    ds_read_b64_tr_b16 v[46:47], v1 offset:28448
    s_waitcnt lgkmcnt(4)
    v_mfma_f32_16x16x32_bf16 v[72:75], v[48:51], v[168:171], v[72:75]
    v_mfma_f32_16x16x32_bf16 v[84:87], v[48:51], v[240:243], v[84:87]
    ds_read_b64_tr_b16 v[48:49], v1 offset:27712
    ds_read_b64_tr_b16 v[50:51], v1 offset:28480
    s_waitcnt lgkmcnt(4)
    v_mfma_f32_16x16x32_bf16 v[64:67], v[40:43], v[172:175], v[64:67]
    v_mfma_f32_16x16x32_bf16 v[76:79], v[40:43], v[244:247], v[76:79]
    ds_read_b64_tr_b16 v[40:41], v1 offset:36864
    ds_read_b64_tr_b16 v[42:43], v1 offset:37632
    s_waitcnt lgkmcnt(4)
    v_mfma_f32_16x16x32_bf16 v[68:71], v[44:47], v[172:175], v[68:71]
    v_mfma_f32_16x16x32_bf16 v[80:83], v[44:47], v[244:247], v[80:83]
    ds_read_b64_tr_b16 v[44:45], v1 offset:36896
    ds_read_b64_tr_b16 v[46:47], v1 offset:37664
    s_waitcnt lgkmcnt(4)
    v_mfma_f32_16x16x32_bf16 v[72:75], v[48:51], v[172:175], v[72:75]
    v_mfma_f32_16x16x32_bf16 v[84:87], v[48:51], v[244:247], v[84:87]
    ds_read_b64_tr_b16 v[48:49], v1 offset:36928
    ds_read_b64_tr_b16 v[50:51], v1 offset:37696
    s_barrier
    s_waitcnt lgkmcnt(4)
    v_mfma_f32_16x16x32_bf16 v[64:67], v[40:43], v[176:179], v[64:67]
    v_mfma_f32_16x16x32_bf16 v[76:79], v[40:43], v[248:251], v[76:79]
    ds_read_b64_tr_b16 v[40:41], v1 offset:39936
    ds_read_b64_tr_b16 v[42:43], v1 offset:40704
    s_waitcnt lgkmcnt(4)
    v_mfma_f32_16x16x32_bf16 v[68:71], v[44:47], v[176:179], v[68:71]
    v_mfma_f32_16x16x32_bf16 v[80:83], v[44:47], v[248:251], v[80:83]
    ds_read_b64_tr_b16 v[44:45], v1 offset:39968
    ds_read_b64_tr_b16 v[46:47], v1 offset:40736
    s_waitcnt lgkmcnt(4)
    v_mfma_f32_16x16x32_bf16 v[72:75], v[48:51], v[176:179], v[72:75]
    v_mfma_f32_16x16x32_bf16 v[84:87], v[48:51], v[248:251], v[84:87]
    ds_read_b64_tr_b16 v[48:49], v1 offset:40000
    ds_read_b64_tr_b16 v[50:51], v1 offset:40768
    s_waitcnt lgkmcnt(4)
    v_mfma_f32_16x16x32_bf16 v[64:67], v[40:43], v[180:183], v[64:67]
    v_mfma_f32_16x16x32_bf16 v[76:79], v[40:43], v[252:255], v[76:79]
    s_waitcnt lgkmcnt(2)
    v_mfma_f32_16x16x32_bf16 v[68:71], v[44:47], v[180:183], v[68:71]
    v_mfma_f32_16x16x32_bf16 v[80:83], v[44:47], v[252:255], v[80:83]
    s_waitcnt lgkmcnt(0)
    v_mfma_f32_16x16x32_bf16 v[72:75], v[48:51], v[180:183], v[72:75]
    v_mfma_f32_16x16x32_bf16 v[84:87], v[48:51], v[252:255], v[84:87]
    s_nop 7
    s_nop 1
    buffer_store_dwordx4 v[64:67], v0, s[20:23], 0 offen offset:0 sc1
    buffer_store_dwordx4 v[68:71], v0, s[20:23], 0 offen offset:1024 sc1
    buffer_store_dwordx4 v[72:75], v0, s[20:23], 0 offen offset:2048 sc1
    buffer_store_dwordx4 v[76:79], v0, s[20:23], s51 offen offset:0 sc1
    buffer_store_dwordx4 v[80:83], v0, s[20:23], s51 offen offset:1024 sc1
    buffer_store_dwordx4 v[84:87], v0, s[20:23], s51 offen offset:2048 sc1
    s_nop 1
K1_END:
    s_endpgm
.globl k2_kernel
.p2align 8
.type k2_kernel,@function
k2_kernel:
    s_cmp_ge_u32 s2, 400
    s_cbranch_scc1 K2_END
    s_load_dwordx2 s[4:5], s[0:1], 96
    s_load_dwordx2 s[30:31], s[0:1], 120
    s_load_dwordx4 s[52:55], s[0:1], 8
    s_load_dwordx2 s[56:57], s[0:1], 56
    v_lshrrev_b32 v12, 6, v0
    s_nop 0
    v_readfirstlane_b32 s32, v12
    s_cmp_lt_u32 s2, 144
    s_cbranch_scc1 K2_SCAN
    s_sub_u32 s2, s2, 144
    s_and_b32 s33, s2, 7
    s_lshr_b32 s34, s2, 3
    s_lshr_b32 s35, s33, 1
    s_and_b32 s36, s33, 1
    s_lshl_b32 s36, s36, 3
    s_lshr_b32 s37, s34, 2
    s_add_u32 s36, s36, s37
    s_and_b32 s37, s34, 3
    s_waitcnt lgkmcnt(0)
    s_mov_b32 s12, s4
    s_mov_b32 s13, s5
    s_mov_b32 s14, 5308416
    s_mov_b32 s15, 0x00020000
    s_add_u32 s8, s30, 10485760
    s_addc_u32 s9, s31, 0
    s_mov_b32 s10, 18874368
    s_mov_b32 s11, 0x00020000
    s_add_u32 s16, s30, 45088768
    s_addc_u32 s17, s31, 0
    s_mov_b32 s18, 18874368
    s_mov_b32 s19, 0x00020000
    v_and_b32 v12, 63, v0
    v_lshrrev_b32 v13, 4, v12
    v_lshlrev_b32 v8, 4, v12
    s_lshl_b32 s39, s36, 3
    s_lshl_b32 s40, s32, 1
    s_add_u32 s39, s39, s40
    s_mul_i32 s41, s39, 144
    s_mul_i32 s42, s35, 36
    s_add_u32 s41, s41, s42
    s_lshl_b32 s41, s41, 10
    s_lshl_b32 s43, s35, 7
    s_add_u32 s43, s43, s39
    s_mul_i32 s43, s43, 36
    s_mul_i32 s44, s37, 9
    s_add_u32 s43, s43, s44
    s_lshl_b32 s43, s43, 10
    v_lshrrev_b32 v16, 1, v13
    v_and_b32 v17, 1, v13
    v_lshlrev_b32 v16, 4, v16
    v_lshl_add_u32 v16, v17, 2, v16
    v_bfe_u32 v17, v12, 2, 2
    v_add_u32 v16, v16, v17
    v_mul_u32_u24 v16, 288, v16
    v_and_b32 v17, 3, v12
    v_lshl_add_u32 v1, v17, 3, v16
    v_add_u32 v2, 36864, v1
    s_mul_i32 s46, s32, 288
    s_movk_i32 s45, 3641
    v_add_u32 v16, s46, v12
    v_mul_lo_u32 v17, v16, s45
    v_lshrrev_b32 v17, 16, v17
    v_mul_u32_u24 v18, 18, v17
    v_sub_u32 v18, v16, v18
    v_and_b32 v19, 0x33, v17
    v_bfe_u32 v20, v17, 2, 1
    v_lshl_add_u32 v19, v20, 3, v19
    v_bfe_u32 v20, v17, 3, 1
    v_lshl_add_u32 v19, v20, 2, v19
    v_mul_u32_u24 v19, 0x480, v19
    v_lshl_add_u32 v3, v18, 4, v19
    v_add_u32 v16, s46, v12
    v_add_u32 v16, 64, v16
    v_mul_lo_u32 v17, v16, s45
    v_lshrrev_b32 v17, 16, v17
    v_mul_u32_u24 v18, 18, v17
    v_sub_u32 v18, v16, v18
    v_and_b32 v19, 0x33, v17
    v_bfe_u32 v20, v17, 2, 1
    v_lshl_add_u32 v19, v20, 3, v19
    v_bfe_u32 v20, v17, 3, 1
    v_lshl_add_u32 v19, v20, 2, v19
    v_mul_u32_u24 v19, 0x480, v19
    v_lshl_add_u32 v4, v18, 4, v19
    v_add_u32 v16, s46, v12
    v_add_u32 v16, 128, v16
    v_mul_lo_u32 v17, v16, s45
    v_lshrrev_b32 v17, 16, v17
    v_mul_u32_u24 v18, 18, v17
    v_sub_u32 v18, v16, v18
    v_and_b32 v19, 0x33, v17
    v_bfe_u32 v20, v17, 2, 1
    v_lshl_add_u32 v19, v20, 3, v19
    v_bfe_u32 v20, v17, 3, 1
    v_lshl_add_u32 v19, v20, 2, v19
    v_mul_u32_u24 v19, 0x480, v19
    v_lshl_add_u32 v5, v18, 4, v19
    v_add_u32 v16, s46, v12
    v_add_u32 v16, 192, v16
    v_mul_lo_u32 v17, v16, s45
    v_lshrrev_b32 v17, 16, v17
    v_mul_u32_u24 v18, 18, v17
    v_sub_u32 v18, v16, v18
    v_and_b32 v19, 0x33, v17
    v_bfe_u32 v20, v17, 2, 1
    v_lshl_add_u32 v19, v20, 3, v19
    v_bfe_u32 v20, v17, 3, 1
    v_lshl_add_u32 v19, v20, 2, v19
    v_mul_u32_u24 v19, 0x480, v19
    v_lshl_add_u32 v6, v18, 4, v19
    v_add_u32 v16, s46, v12
    v_add_u32 v16, 256, v16
    v_mul_lo_u32 v17, v16, s45
    v_lshrrev_b32 v17, 16, v17
    v_mul_u32_u24 v18, 18, v17
    v_sub_u32 v18, v16, v18
    v_and_b32 v19, 0x33, v17
    v_bfe_u32 v20, v17, 2, 1
    v_lshl_add_u32 v19, v20, 3, v19
    v_bfe_u32 v20, v17, 3, 1
    v_lshl_add_u32 v19, v20, 2, v19
    v_mul_u32_u24 v19, 0x480, v19
    v_lshl_add_u32 v7, v18, 4, v19
    s_mul_i32 s47, s32, 4608
    s_mul_i32 s48, s35, 1327104
    s_mul_i32 s49, s37, 288
    s_add_u32 s48, s48, s49
    s_lshr_b32 s58, s34, 2
    s_mul_i32 s58, s58, 2
    s_mul_i32 s59, s37, 5
    s_add_u32 s58, s58, s59
    s_cmp_ge_u32 s58, 18
    s_cselect_b32 s59, 18, 0
    s_sub_u32 s58, s58, s59
    s_load_dwordx2 s[68:69], s[0:1], 112
    s_add_u32 s20, s30, 39845888
    s_addc_u32 s21, s31, 0
    s_mov_b32 s22, 4718592
    s_mov_b32 s23, 0x00020000
    s_add_u32 s64, s30, 2359296
    s_addc_u32 s65, s31, 0
    s_mul_i32 s66, s37, 9*36
    s_mul_i32 s67, s35, 9
    s_add_u32 s66, s66, s67
    s_lshl_b32 s66, s66, 10
    s_mul_i32 s70, s39, 36
    s_add_u32 s67, s67, s70
    s_lshl_b32 s67, s67, 10
    v_add_u32 v12, 36864, v8
    s_waitcnt lgkmcnt(0)
    s_mov_b32 s24, s68
    s_mov_b32 s25, s69
    s_mov_b32 s26, 256
    s_mov_b32 s27, 0x00020000
    s_add_u32 s57, s58, 0
    s_cmp_ge_u32 s57, 18
    s_cselect_b32 s59, 18, 0
    s_sub_u32 s57, s57, s59
    s_mul_i32 s57, s57, 73728
    s_add_u32 s49, s48, s57
    s_add_u32 m0, s47, 0
    s_nop 0
    buffer_load_dwordx4 v3, s[12:15], s49 offen lds
    s_add_u32 m0, s47, 1024
    s_nop 0
    buffer_load_dwordx4 v4, s[12:15], s49 offen lds
    s_add_u32 m0, s47, 2048
    s_nop 0
    buffer_load_dwordx4 v5, s[12:15], s49 offen lds
    s_add_u32 m0, s47, 3072
    s_nop 0
    buffer_load_dwordx4 v6, s[12:15], s49 offen lds
    s_mov_b32 exec_hi, 0
    s_add_u32 m0, s47, 4096
    s_nop 0
    buffer_load_dwordx4 v7, s[12:15], s49 offen lds
    s_mov_b32 exec_hi, -1
    s_add_u32 s56, s58, 0
    s_cmp_ge_u32 s56, 18
    s_cselect_b32 s59, 18, 0
    s_sub_u32 s56, s56, s59
    s_lshl_b32 s56, s56, 11
    s_add_u32 s56, s56, s41
    s_add_u32 s50, s56, 0
    buffer_load_dwordx4 v[48:51], v8, s[8:11], s50 offen
    s_add_u32 s50, s56, 147456
    buffer_load_dwordx4 v[52:55], v8, s[8:11], s50 offen
    s_add_u32 s56, s58, 0
    s_cmp_ge_u32 s56, 18
    s_cselect_b32 s59, 18, 0
    s_sub_u32 s56, s56, s59
    s_lshl_b32 s56, s56, 11
    s_add_u32 s56, s56, s41
    s_add_u32 s50, s56, 1024
    buffer_load_dwordx4 v[56:59], v8, s[8:11], s50 offen
    s_add_u32 s50, s56, 148480
    buffer_load_dwordx4 v[60:63], v8, s[8:11], s50 offen
    s_add_u32 s57, s58, 1
    s_cmp_ge_u32 s57, 18
    s_cselect_b32 s59, 18, 0
    s_sub_u32 s57, s57, s59
    s_mul_i32 s57, s57, 73728
    s_add_u32 s49, s48, s57
    s_add_u32 m0, s47, 18432
    s_nop 0
    buffer_load_dwordx4 v3, s[12:15], s49 offen lds
    s_add_u32 m0, s47, 19456
    s_nop 0
    buffer_load_dwordx4 v4, s[12:15], s49 offen lds
    s_add_u32 m0, s47, 20480
    s_nop 0
    buffer_load_dwordx4 v5, s[12:15], s49 offen lds
    s_add_u32 m0, s47, 21504
    s_nop 0
    buffer_load_dwordx4 v6, s[12:15], s49 offen lds
    s_mov_b32 exec_hi, 0
    s_add_u32 m0, s47, 22528
    s_nop 0
    buffer_load_dwordx4 v7, s[12:15], s49 offen lds
    s_mov_b32 exec_hi, -1
    s_add_u32 s56, s58, 1
    s_cmp_ge_u32 s56, 18
    s_cselect_b32 s59, 18, 0
    s_sub_u32 s56, s56, s59
    s_lshl_b32 s56, s56, 11
    s_add_u32 s56, s56, s41
    s_add_u32 s50, s56, 0
    buffer_load_dwordx4 v[64:67], v8, s[8:11], s50 offen
    s_add_u32 s50, s56, 147456
    buffer_load_dwordx4 v[68:71], v8, s[8:11], s50 offen
    s_add_u32 s56, s58, 1
    s_cmp_ge_u32 s56, 18
    s_cselect_b32 s59, 18, 0
    s_sub_u32 s56, s56, s59
    s_lshl_b32 s56, s56, 11
    s_add_u32 s56, s56, s41
    s_add_u32 s50, s56, 1024
    buffer_load_dwordx4 v[72:75], v8, s[8:11], s50 offen
    s_add_u32 s50, s56, 148480
    buffer_load_dwordx4 v[76:79], v8, s[8:11], s50 offen
    s_waitcnt vmcnt(4)
    s_barrier
    ds_read_b64_tr_b16 v[112:113], v1 offset:0
    ds_read_b64_tr_b16 v[114:115], v1 offset:2304
    ds_read_b64_tr_b16 v[116:117], v1 offset:32
    ds_read_b64_tr_b16 v[118:119], v1 offset:2336
    ds_read_b64_tr_b16 v[120:121], v1 offset:64
    ds_read_b64_tr_b16 v[122:123], v1 offset:2368
    ds_read_b64_tr_b16 v[124:125], v1 offset:96
    ds_read_b64_tr_b16 v[126:127], v1 offset:2400
    ds_read_b64_tr_b16 v[128:129], v1 offset:128
    ds_read_b64_tr_b16 v[130:131], v1 offset:2432
    ds_read_b64_tr_b16 v[132:133], v1 offset:160
    ds_read_b64_tr_b16 v[134:135], v1 offset:2464
    ds_read_b64_tr_b16 v[136:137], v1 offset:192
    ds_read_b64_tr_b16 v[138:139], v1 offset:2496
    ds_read_b64_tr_b16 v[140:141], v1 offset:224
    ds_read_b64_tr_b16 v[142:143], v1 offset:2528
    ds_read_b64_tr_b16 v[144:145], v1 offset:256
    ds_read_b64_tr_b16 v[146:147], v1 offset:2560
    ds_read_b64_tr_b16 v[148:149], v1 offset:9216
    ds_read_b64_tr_b16 v[150:151], v1 offset:11520
    s_waitcnt lgkmcnt(15)
    v_mfma_f32_16x16x32_bf16 v[184:187], v[112:115], v[48:51], 0
    s_add_u32 s57, s58, 2
    s_cmp_ge_u32 s57, 18
    s_cselect_b32 s59, 18, 0
    s_sub_u32 s57, s57, s59
    s_mul_i32 s57, s57, 73728
    s_add_u32 s49, s48, s57
    s_add_u32 m0, s47, 36864
    s_nop 0
    buffer_load_dwordx4 v3, s[12:15], s49 offen lds
    v_mfma_f32_16x16x32_bf16 v[220:223], v[112:115], v[52:55], 0
    s_add_u32 m0, s47, 37888
    s_nop 0
    buffer_load_dwordx4 v4, s[12:15], s49 offen lds
    ds_read_b64_tr_b16 v[152:153], v1 offset:9248
    ds_read_b64_tr_b16 v[154:155], v1 offset:11552
    v_mfma_f32_16x16x32_bf16 v[188:191], v[116:119], v[48:51], 0
    v_mfma_f32_16x16x32_bf16 v[224:227], v[116:119], v[52:55], 0
    s_add_u32 m0, s47, 38912
    s_nop 0
    buffer_load_dwordx4 v5, s[12:15], s49 offen lds
    ds_read_b64_tr_b16 v[156:157], v1 offset:9280
    ds_read_b64_tr_b16 v[158:159], v1 offset:11584
    s_waitcnt lgkmcnt(15)
    v_mfma_f32_16x16x32_bf16 v[192:195], v[120:123], v[48:51], 0
    v_mfma_f32_16x16x32_bf16 v[228:231], v[120:123], v[52:55], 0
    s_add_u32 m0, s47, 39936
    s_nop 0
    buffer_load_dwordx4 v6, s[12:15], s49 offen lds
    ds_read_b64_tr_b16 v[160:161], v1 offset:9312
    ds_read_b64_tr_b16 v[162:163], v1 offset:11616
    v_mfma_f32_16x16x32_bf16 v[196:199], v[124:127], v[48:51], 0
    v_mfma_f32_16x16x32_bf16 v[232:235], v[124:127], v[52:55], 0
    s_mov_b32 exec_hi, 0
    s_add_u32 m0, s47, 40960
    s_nop 0
    buffer_load_dwordx4 v7, s[12:15], s49 offen lds
    s_mov_b32 exec_hi, -1
    ds_read_b64_tr_b16 v[164:165], v1 offset:9344
    ds_read_b64_tr_b16 v[166:167], v1 offset:11648
    s_waitcnt lgkmcnt(15)
    v_mfma_f32_16x16x32_bf16 v[200:203], v[128:131], v[48:51], 0
    s_add_u32 s56, s58, 2
    s_cmp_ge_u32 s56, 18
    s_cselect_b32 s59, 18, 0
    s_sub_u32 s56, s56, s59
    s_lshl_b32 s56, s56, 11
    s_add_u32 s56, s56, s41
    s_add_u32 s50, s56, 0
    buffer_load_dwordx4 v[80:83], v8, s[8:11], s50 offen
    v_mfma_f32_16x16x32_bf16 v[236:239], v[128:131], v[52:55], 0
    ds_read_b64_tr_b16 v[168:169], v1 offset:9376
    ds_read_b64_tr_b16 v[170:171], v1 offset:11680
    v_mfma_f32_16x16x32_bf16 v[204:207], v[132:135], v[48:51], 0
    s_add_u32 s50, s56, 147456
    buffer_load_dwordx4 v[84:87], v8, s[8:11], s50 offen
    v_mfma_f32_16x16x32_bf16 v[240:243], v[132:135], v[52:55], 0
    ds_read_b64_tr_b16 v[172:173], v1 offset:9408
    ds_read_b64_tr_b16 v[174:175], v1 offset:11712
    s_waitcnt lgkmcnt(15)
    v_mfma_f32_16x16x32_bf16 v[208:211], v[136:139], v[48:51], 0
    s_add_u32 s56, s58, 2
    s_cmp_ge_u32 s56, 18
    s_cselect_b32 s59, 18, 0
    s_sub_u32 s56, s56, s59
    s_lshl_b32 s56, s56, 11
    s_add_u32 s56, s56, s41
    s_add_u32 s50, s56, 1024
    buffer_load_dwordx4 v[88:91], v8, s[8:11], s50 offen
    v_mfma_f32_16x16x32_bf16 v[244:247], v[136:139], v[52:55], 0
    ds_read_b64_tr_b16 v[176:177], v1 offset:9440
    ds_read_b64_tr_b16 v[178:179], v1 offset:11744
    v_mfma_f32_16x16x32_bf16 v[212:215], v[140:143], v[48:51], 0
    s_add_u32 s50, s56, 148480
    buffer_load_dwordx4 v[92:95], v8, s[8:11], s50 offen
    v_mfma_f32_16x16x32_bf16 v[248:251], v[140:143], v[52:55], 0
    ds_read_b64_tr_b16 v[180:181], v1 offset:9472
    ds_read_b64_tr_b16 v[182:183], v1 offset:11776
    s_waitcnt lgkmcnt(15)
    v_mfma_f32_16x16x32_bf16 v[216:219], v[144:147], v[48:51], 0
    v_mfma_f32_16x16x32_bf16 v[252:255], v[144:147], v[52:55], 0
    ds_read_b64_tr_b16 v[112:113], v1 offset:18432
    ds_read_b64_tr_b16 v[114:115], v1 offset:20736
    v_mfma_f32_16x16x32_bf16 v[184:187], v[148:151], v[56:59], v[184:187]
    s_add_u32 s57, s58, 3
    s_cmp_ge_u32 s57, 18
    s_cselect_b32 s59, 18, 0
    s_sub_u32 s57, s57, s59
    s_mul_i32 s57, s57, 73728
    s_add_u32 s49, s48, s57
    s_add_u32 m0, s47, 55296
    s_nop 0
    buffer_load_dwordx4 v3, s[12:15], s49 offen lds
    v_mfma_f32_16x16x32_bf16 v[220:223], v[148:151], v[60:63], v[220:223]
    ds_read_b64_tr_b16 v[116:117], v1 offset:18464
    ds_read_b64_tr_b16 v[118:119], v1 offset:20768
    s_waitcnt lgkmcnt(15)
    v_mfma_f32_16x16x32_bf16 v[188:191], v[152:155], v[56:59], v[188:191]
    s_add_u32 m0, s47, 56320
    s_nop 0
    buffer_load_dwordx4 v4, s[12:15], s49 offen lds
    v_mfma_f32_16x16x32_bf16 v[224:227], v[152:155], v[60:63], v[224:227]
    ds_read_b64_tr_b16 v[120:121], v1 offset:18496
    ds_read_b64_tr_b16 v[122:123], v1 offset:20800
    v_mfma_f32_16x16x32_bf16 v[192:195], v[156:159], v[56:59], v[192:195]
    s_add_u32 m0, s47, 57344
    s_nop 0
    buffer_load_dwordx4 v5, s[12:15], s49 offen lds
    v_mfma_f32_16x16x32_bf16 v[228:231], v[156:159], v[60:63], v[228:231]
    ds_read_b64_tr_b16 v[124:125], v1 offset:18528
    ds_read_b64_tr_b16 v[126:127], v1 offset:20832
    s_waitcnt lgkmcnt(15)
    v_mfma_f32_16x16x32_bf16 v[196:199], v[160:163], v[56:59], v[196:199]
    s_add_u32 m0, s47, 58368
    s_nop 0
    buffer_load_dwordx4 v6, s[12:15], s49 offen lds
    v_mfma_f32_16x16x32_bf16 v[232:235], v[160:163], v[60:63], v[232:235]
    ds_read_b64_tr_b16 v[128:129], v1 offset:18560
    ds_read_b64_tr_b16 v[130:131], v1 offset:20864
    v_mfma_f32_16x16x32_bf16 v[200:203], v[164:167], v[56:59], v[200:203]
    v_mfma_f32_16x16x32_bf16 v[236:239], v[164:167], v[60:63], v[236:239]
    s_mov_b32 exec_hi, 0
    s_add_u32 m0, s47, 59392
    s_nop 0
    buffer_load_dwordx4 v7, s[12:15], s49 offen lds
    s_mov_b32 exec_hi, -1
    ds_read_b64_tr_b16 v[132:133], v1 offset:18592
    ds_read_b64_tr_b16 v[134:135], v1 offset:20896
    s_waitcnt lgkmcnt(15)
    v_mfma_f32_16x16x32_bf16 v[204:207], v[168:171], v[56:59], v[204:207]
    v_mfma_f32_16x16x32_bf16 v[240:243], v[168:171], v[60:63], v[240:243]
    s_add_u32 s56, s58, 3
    s_cmp_ge_u32 s56, 18
    s_cselect_b32 s59, 18, 0
    s_sub_u32 s56, s56, s59
    s_lshl_b32 s56, s56, 11
    s_add_u32 s56, s56, s41
    s_add_u32 s50, s56, 0
    buffer_load_dwordx4 v[48:51], v8, s[8:11], s50 offen
    ds_read_b64_tr_b16 v[136:137], v1 offset:18624
    ds_read_b64_tr_b16 v[138:139], v1 offset:20928
    v_mfma_f32_16x16x32_bf16 v[208:211], v[172:175], v[56:59], v[208:211]
    v_mfma_f32_16x16x32_bf16 v[244:247], v[172:175], v[60:63], v[244:247]
    s_add_u32 s50, s56, 147456
    buffer_load_dwordx4 v[52:55], v8, s[8:11], s50 offen
    ds_read_b64_tr_b16 v[140:141], v1 offset:18656
    ds_read_b64_tr_b16 v[142:143], v1 offset:20960
    s_waitcnt lgkmcnt(15)
    v_mfma_f32_16x16x32_bf16 v[212:215], v[176:179], v[56:59], v[212:215]
    v_mfma_f32_16x16x32_bf16 v[248:251], v[176:179], v[60:63], v[248:251]
    ds_read_b64_tr_b16 v[144:145], v1 offset:18688
    ds_read_b64_tr_b16 v[146:147], v1 offset:20992
    v_mfma_f32_16x16x32_bf16 v[216:219], v[180:183], v[56:59], v[216:219]
    v_mfma_f32_16x16x32_bf16 v[252:255], v[180:183], v[60:63], v[252:255]
    s_waitcnt vmcnt(11)
    s_barrier
    ds_read_b64_tr_b16 v[148:149], v1 offset:27648
    ds_read_b64_tr_b16 v[150:151], v1 offset:29952
    s_waitcnt lgkmcnt(15)
    v_mfma_f32_16x16x32_bf16 v[184:187], v[112:115], v[64:67], v[184:187]
    s_add_u32 s57, s58, 4
    s_cmp_ge_u32 s57, 18
    s_cselect_b32 s59, 18, 0
    s_sub_u32 s57, s57, s59
    s_mul_i32 s57, s57, 73728
    s_add_u32 s49, s48, s57
    s_add_u32 m0, s47, 0
    s_nop 0
    buffer_load_dwordx4 v3, s[12:15], s49 offen lds
    v_mfma_f32_16x16x32_bf16 v[220:223], v[112:115], v[68:71], v[220:223]
    ds_read_b64_tr_b16 v[152:153], v1 offset:27680
    ds_read_b64_tr_b16 v[154:155], v1 offset:29984
    v_mfma_f32_16x16x32_bf16 v[188:191], v[116:119], v[64:67], v[188:191]
    s_add_u32 m0, s47, 1024
    s_nop 0
    buffer_load_dwordx4 v4, s[12:15], s49 offen lds
    v_mfma_f32_16x16x32_bf16 v[224:227], v[116:119], v[68:71], v[224:227]
    ds_read_b64_tr_b16 v[156:157], v1 offset:27712
    ds_read_b64_tr_b16 v[158:159], v1 offset:30016
    s_waitcnt lgkmcnt(15)
    v_mfma_f32_16x16x32_bf16 v[192:195], v[120:123], v[64:67], v[192:195]
    s_add_u32 m0, s47, 2048
    s_nop 0
    buffer_load_dwordx4 v5, s[12:15], s49 offen lds
    v_mfma_f32_16x16x32_bf16 v[228:231], v[120:123], v[68:71], v[228:231]
    ds_read_b64_tr_b16 v[160:161], v1 offset:27744
    ds_read_b64_tr_b16 v[162:163], v1 offset:30048
    v_mfma_f32_16x16x32_bf16 v[196:199], v[124:127], v[64:67], v[196:199]
    s_add_u32 m0, s47, 3072
    s_nop 0
    buffer_load_dwordx4 v6, s[12:15], s49 offen lds
    v_mfma_f32_16x16x32_bf16 v[232:235], v[124:127], v[68:71], v[232:235]
    ds_read_b64_tr_b16 v[164:165], v1 offset:27776
    ds_read_b64_tr_b16 v[166:167], v1 offset:30080
    s_waitcnt lgkmcnt(15)
    v_mfma_f32_16x16x32_bf16 v[200:203], v[128:131], v[64:67], v[200:203]
    v_mfma_f32_16x16x32_bf16 v[236:239], v[128:131], v[68:71], v[236:239]
    s_mov_b32 exec_hi, 0
    s_add_u32 m0, s47, 4096
    s_nop 0
    buffer_load_dwordx4 v7, s[12:15], s49 offen lds
    s_mov_b32 exec_hi, -1
    ds_read_b64_tr_b16 v[168:169], v1 offset:27808
    ds_read_b64_tr_b16 v[170:171], v1 offset:30112
    v_mfma_f32_16x16x32_bf16 v[204:207], v[132:135], v[64:67], v[204:207]
    v_mfma_f32_16x16x32_bf16 v[240:243], v[132:135], v[68:71], v[240:243]
    s_add_u32 s56, s58, 3
    s_cmp_ge_u32 s56, 18
    s_cselect_b32 s59, 18, 0
    s_sub_u32 s56, s56, s59
    s_lshl_b32 s56, s56, 11
    s_add_u32 s56, s56, s41
    s_add_u32 s50, s56, 1024
    buffer_load_dwordx4 v[56:59], v8, s[8:11], s50 offen
    ds_read_b64_tr_b16 v[172:173], v1 offset:27840
    ds_read_b64_tr_b16 v[174:175], v1 offset:30144
    s_waitcnt lgkmcnt(15)
    v_mfma_f32_16x16x32_bf16 v[208:211], v[136:139], v[64:67], v[208:211]
    v_mfma_f32_16x16x32_bf16 v[244:247], v[136:139], v[68:71], v[244:247]
    s_add_u32 s50, s56, 148480
    buffer_load_dwordx4 v[60:63], v8, s[8:11], s50 offen
    ds_read_b64_tr_b16 v[176:177], v1 offset:27872
    ds_read_b64_tr_b16 v[178:179], v1 offset:30176
    v_mfma_f32_16x16x32_bf16 v[212:215], v[140:143], v[64:67], v[212:215]
    v_mfma_f32_16x16x32_bf16 v[248:251], v[140:143], v[68:71], v[248:251]
    ds_read_b64_tr_b16 v[180:181], v1 offset:27904
    ds_read_b64_tr_b16 v[182:183], v1 offset:30208
    s_waitcnt lgkmcnt(15)
    v_mfma_f32_16x16x32_bf16 v[216:219], v[144:147], v[64:67], v[216:219]
    v_mfma_f32_16x16x32_bf16 v[252:255], v[144:147], v[68:71], v[252:255]
    ds_read_b64_tr_b16 v[112:113], v2 offset:0
    ds_read_b64_tr_b16 v[114:115], v2 offset:2304
    v_mfma_f32_16x16x32_bf16 v[184:187], v[148:151], v[72:75], v[184:187]
    s_add_u32 s56, s58, 4
    s_cmp_ge_u32 s56, 18
    s_cselect_b32 s59, 18, 0
    s_sub_u32 s56, s56, s59
    s_lshl_b32 s56, s56, 11
    s_add_u32 s56, s56, s41
    s_add_u32 s50, s56, 0
    buffer_load_dwordx4 v[64:67], v8, s[8:11], s50 offen
    v_mfma_f32_16x16x32_bf16 v[220:223], v[148:151], v[76:79], v[220:223]
    ds_read_b64_tr_b16 v[116:117], v2 offset:32
    ds_read_b64_tr_b16 v[118:119], v2 offset:2336
    s_waitcnt lgkmcnt(15)
    v_mfma_f32_16x16x32_bf16 v[188:191], v[152:155], v[72:75], v[188:191]
    v_mfma_f32_16x16x32_bf16 v[224:227], v[152:155], v[76:79], v[224:227]
    ds_read_b64_tr_b16 v[120:121], v2 offset:64
    ds_read_b64_tr_b16 v[122:123], v2 offset:2368
    v_mfma_f32_16x16x32_bf16 v[192:195], v[156:159], v[72:75], v[192:195]
    v_mfma_f32_16x16x32_bf16 v[228:231], v[156:159], v[76:79], v[228:231]
    ds_read_b64_tr_b16 v[124:125], v2 offset:96
    ds_read_b64_tr_b16 v[126:127], v2 offset:2400
    s_waitcnt lgkmcnt(15)
    v_mfma_f32_16x16x32_bf16 v[196:199], v[160:163], v[72:75], v[196:199]
    v_mfma_f32_16x16x32_bf16 v[232:235], v[160:163], v[76:79], v[232:235]
    ds_read_b64_tr_b16 v[128:129], v2 offset:128
    ds_read_b64_tr_b16 v[130:131], v2 offset:2432
    v_mfma_f32_16x16x32_bf16 v[200:203], v[164:167], v[72:75], v[200:203]
    s_add_u32 s50, s56, 147456
    buffer_load_dwordx4 v[68:71], v8, s[8:11], s50 offen
    v_mfma_f32_16x16x32_bf16 v[236:239], v[164:167], v[76:79], v[236:239]
    ds_read_b64_tr_b16 v[132:133], v2 offset:160
    ds_read_b64_tr_b16 v[134:135], v2 offset:2464
    s_waitcnt lgkmcnt(15)
    v_mfma_f32_16x16x32_bf16 v[204:207], v[168:171], v[72:75], v[204:207]
    v_mfma_f32_16x16x32_bf16 v[240:243], v[168:171], v[76:79], v[240:243]
    ds_read_b64_tr_b16 v[136:137], v2 offset:192
    ds_read_b64_tr_b16 v[138:139], v2 offset:2496
    v_mfma_f32_16x16x32_bf16 v[208:211], v[172:175], v[72:75], v[208:211]
    v_mfma_f32_16x16x32_bf16 v[244:247], v[172:175], v[76:79], v[244:247]
    ds_read_b64_tr_b16 v[140:141], v2 offset:224
    ds_read_b64_tr_b16 v[142:143], v2 offset:2528
    s_waitcnt lgkmcnt(15)
    v_mfma_f32_16x16x32_bf16 v[212:215], v[176:179], v[72:75], v[212:215]
    v_mfma_f32_16x16x32_bf16 v[248:251], v[176:179], v[76:79], v[248:251]
    ds_read_b64_tr_b16 v[144:145], v2 offset:256
    ds_read_b64_tr_b16 v[146:147], v2 offset:2560
    v_mfma_f32_16x16x32_bf16 v[216:219], v[180:183], v[72:75], v[216:219]
    v_mfma_f32_16x16x32_bf16 v[252:255], v[180:183], v[76:79], v[252:255]
    s_waitcnt vmcnt(11)
    s_barrier
    ds_read_b64_tr_b16 v[148:149], v2 offset:9216
    ds_read_b64_tr_b16 v[150:151], v2 offset:11520
    s_waitcnt lgkmcnt(15)
    v_mfma_f32_16x16x32_bf16 v[184:187], v[112:115], v[80:83], v[184:187]
    s_add_u32 s57, s58, 5
    s_cmp_ge_u32 s57, 18
    s_cselect_b32 s59, 18, 0
    s_sub_u32 s57, s57, s59
    s_mul_i32 s57, s57, 73728
    s_add_u32 s49, s48, s57
    s_add_u32 m0, s47, 18432
    s_nop 0
    buffer_load_dwordx4 v3, s[12:15], s49 offen lds
    v_mfma_f32_16x16x32_bf16 v[220:223], v[112:115], v[84:87], v[220:223]
    ds_read_b64_tr_b16 v[152:153], v2 offset:9248
    ds_read_b64_tr_b16 v[154:155], v2 offset:11552
    v_mfma_f32_16x16x32_bf16 v[188:191], v[116:119], v[80:83], v[188:191]
    s_add_u32 m0, s47, 19456
    s_nop 0
    buffer_load_dwordx4 v4, s[12:15], s49 offen lds
    v_mfma_f32_16x16x32_bf16 v[224:227], v[116:119], v[84:87], v[224:227]
    ds_read_b64_tr_b16 v[156:157], v2 offset:9280
    ds_read_b64_tr_b16 v[158:159], v2 offset:11584
    s_waitcnt lgkmcnt(15)
    v_mfma_f32_16x16x32_bf16 v[192:195], v[120:123], v[80:83], v[192:195]
    s_add_u32 m0, s47, 20480
    s_nop 0
    buffer_load_dwordx4 v5, s[12:15], s49 offen lds
    v_mfma_f32_16x16x32_bf16 v[228:231], v[120:123], v[84:87], v[228:231]
    ds_read_b64_tr_b16 v[160:161], v2 offset:9312
    ds_read_b64_tr_b16 v[162:163], v2 offset:11616
    v_mfma_f32_16x16x32_bf16 v[196:199], v[124:127], v[80:83], v[196:199]
    s_add_u32 m0, s47, 21504
    s_nop 0
    buffer_load_dwordx4 v6, s[12:15], s49 offen lds
    v_mfma_f32_16x16x32_bf16 v[232:235], v[124:127], v[84:87], v[232:235]
    ds_read_b64_tr_b16 v[164:165], v2 offset:9344
    ds_read_b64_tr_b16 v[166:167], v2 offset:11648
    s_waitcnt lgkmcnt(15)
    v_mfma_f32_16x16x32_bf16 v[200:203], v[128:131], v[80:83], v[200:203]
    v_mfma_f32_16x16x32_bf16 v[236:239], v[128:131], v[84:87], v[236:239]
    s_mov_b32 exec_hi, 0
    s_add_u32 m0, s47, 22528
    s_nop 0
    buffer_load_dwordx4 v7, s[12:15], s49 offen lds
    s_mov_b32 exec_hi, -1
    ds_read_b64_tr_b16 v[168:169], v2 offset:9376
    ds_read_b64_tr_b16 v[170:171], v2 offset:11680
    v_mfma_f32_16x16x32_bf16 v[204:207], v[132:135], v[80:83], v[204:207]
    v_mfma_f32_16x16x32_bf16 v[240:243], v[132:135], v[84:87], v[240:243]
    s_add_u32 s56, s58, 4
    s_cmp_ge_u32 s56, 18
    s_cselect_b32 s59, 18, 0
    s_sub_u32 s56, s56, s59
    s_lshl_b32 s56, s56, 11
    s_add_u32 s56, s56, s41
    s_add_u32 s50, s56, 1024
    buffer_load_dwordx4 v[72:75], v8, s[8:11], s50 offen
    ds_read_b64_tr_b16 v[172:173], v2 offset:9408
    ds_read_b64_tr_b16 v[174:175], v2 offset:11712
    s_waitcnt lgkmcnt(15)
    v_mfma_f32_16x16x32_bf16 v[208:211], v[136:139], v[80:83], v[208:211]
    v_mfma_f32_16x16x32_bf16 v[244:247], v[136:139], v[84:87], v[244:247]
    s_add_u32 s50, s56, 148480
    buffer_load_dwordx4 v[76:79], v8, s[8:11], s50 offen
    ds_read_b64_tr_b16 v[176:177], v2 offset:9440
    ds_read_b64_tr_b16 v[178:179], v2 offset:11744
    v_mfma_f32_16x16x32_bf16 v[212:215], v[140:143], v[80:83], v[212:215]
    v_mfma_f32_16x16x32_bf16 v[248:251], v[140:143], v[84:87], v[248:251]
    ds_read_b64_tr_b16 v[180:181], v2 offset:9472
    ds_read_b64_tr_b16 v[182:183], v2 offset:11776
    s_waitcnt lgkmcnt(15)
    v_mfma_f32_16x16x32_bf16 v[216:219], v[144:147], v[80:83], v[216:219]
    v_mfma_f32_16x16x32_bf16 v[252:255], v[144:147], v[84:87], v[252:255]
    ds_read_b64_tr_b16 v[112:113], v2 offset:18432
    ds_read_b64_tr_b16 v[114:115], v2 offset:20736
    v_mfma_f32_16x16x32_bf16 v[184:187], v[148:151], v[88:91], v[184:187]
    s_add_u32 s56, s58, 5
    s_cmp_ge_u32 s56, 18
    s_cselect_b32 s59, 18, 0
    s_sub_u32 s56, s56, s59
    s_lshl_b32 s56, s56, 11
    s_add_u32 s56, s56, s41
    s_add_u32 s50, s56, 0
    buffer_load_dwordx4 v[80:83], v8, s[8:11], s50 offen
    v_mfma_f32_16x16x32_bf16 v[220:223], v[148:151], v[92:95], v[220:223]
    ds_read_b64_tr_b16 v[116:117], v2 offset:18464
    ds_read_b64_tr_b16 v[118:119], v2 offset:20768
    s_waitcnt lgkmcnt(15)
    v_mfma_f32_16x16x32_bf16 v[188:191], v[152:155], v[88:91], v[188:191]
    v_mfma_f32_16x16x32_bf16 v[224:227], v[152:155], v[92:95], v[224:227]
    ds_read_b64_tr_b16 v[120:121], v2 offset:18496
    ds_read_b64_tr_b16 v[122:123], v2 offset:20800
    v_mfma_f32_16x16x32_bf16 v[192:195], v[156:159], v[88:91], v[192:195]
    v_mfma_f32_16x16x32_bf16 v[228:231], v[156:159], v[92:95], v[228:231]
    ds_read_b64_tr_b16 v[124:125], v2 offset:18528
    ds_read_b64_tr_b16 v[126:127], v2 offset:20832
    s_waitcnt lgkmcnt(15)
    v_mfma_f32_16x16x32_bf16 v[196:199], v[160:163], v[88:91], v[196:199]
    v_mfma_f32_16x16x32_bf16 v[232:235], v[160:163], v[92:95], v[232:235]
    ds_read_b64_tr_b16 v[128:129], v2 offset:18560
    ds_read_b64_tr_b16 v[130:131], v2 offset:20864
    v_mfma_f32_16x16x32_bf16 v[200:203], v[164:167], v[88:91], v[200:203]
    s_add_u32 s50, s56, 147456
    buffer_load_dwordx4 v[84:87], v8, s[8:11], s50 offen
    v_mfma_f32_16x16x32_bf16 v[236:239], v[164:167], v[92:95], v[236:239]
    ds_read_b64_tr_b16 v[132:133], v2 offset:18592
    ds_read_b64_tr_b16 v[134:135], v2 offset:20896
    s_waitcnt lgkmcnt(15)
    v_mfma_f32_16x16x32_bf16 v[204:207], v[168:171], v[88:91], v[204:207]
    v_mfma_f32_16x16x32_bf16 v[240:243], v[168:171], v[92:95], v[240:243]
    ds_read_b64_tr_b16 v[136:137], v2 offset:18624
    ds_read_b64_tr_b16 v[138:139], v2 offset:20928
    v_mfma_f32_16x16x32_bf16 v[208:211], v[172:175], v[88:91], v[208:211]
    v_mfma_f32_16x16x32_bf16 v[244:247], v[172:175], v[92:95], v[244:247]
    ds_read_b64_tr_b16 v[140:141], v2 offset:18656
    ds_read_b64_tr_b16 v[142:143], v2 offset:20960
    s_waitcnt lgkmcnt(15)
    v_mfma_f32_16x16x32_bf16 v[212:215], v[176:179], v[88:91], v[212:215]
    v_mfma_f32_16x16x32_bf16 v[248:251], v[176:179], v[92:95], v[248:251]
    ds_read_b64_tr_b16 v[144:145], v2 offset:18688
    ds_read_b64_tr_b16 v[146:147], v2 offset:20992
    v_mfma_f32_16x16x32_bf16 v[216:219], v[180:183], v[88:91], v[216:219]
    v_mfma_f32_16x16x32_bf16 v[252:255], v[180:183], v[92:95], v[252:255]
    s_waitcnt vmcnt(13)
    s_barrier
    ds_read_b64_tr_b16 v[148:149], v2 offset:27648
    ds_read_b64_tr_b16 v[150:151], v2 offset:29952
    s_waitcnt lgkmcnt(15)
    v_mfma_f32_16x16x32_bf16 v[184:187], v[112:115], v[48:51], v[184:187]
    s_add_u32 s57, s58, 6
    s_cmp_ge_u32 s57, 18
    s_cselect_b32 s59, 18, 0
    s_sub_u32 s57, s57, s59
    s_mul_i32 s57, s57, 73728
    s_add_u32 s49, s48, s57
    s_add_u32 m0, s47, 36864
    s_nop 0
    buffer_load_dwordx4 v3, s[12:15], s49 offen lds
    v_mfma_f32_16x16x32_bf16 v[220:223], v[112:115], v[52:55], v[220:223]
    ds_read_b64_tr_b16 v[152:153], v2 offset:27680
    ds_read_b64_tr_b16 v[154:155], v2 offset:29984
    v_mfma_f32_16x16x32_bf16 v[188:191], v[116:119], v[48:51], v[188:191]
    s_add_u32 m0, s47, 37888
    s_nop 0
    buffer_load_dwordx4 v4, s[12:15], s49 offen lds
    v_mfma_f32_16x16x32_bf16 v[224:227], v[116:119], v[52:55], v[224:227]
    ds_read_b64_tr_b16 v[156:157], v2 offset:27712
    ds_read_b64_tr_b16 v[158:159], v2 offset:30016
    s_waitcnt lgkmcnt(15)
    v_mfma_f32_16x16x32_bf16 v[192:195], v[120:123], v[48:51], v[192:195]
    s_add_u32 m0, s47, 38912
    s_nop 0
    buffer_load_dwordx4 v5, s[12:15], s49 offen lds
    v_mfma_f32_16x16x32_bf16 v[228:231], v[120:123], v[52:55], v[228:231]
    ds_read_b64_tr_b16 v[160:161], v2 offset:27744
    ds_read_b64_tr_b16 v[162:163], v2 offset:30048
    v_mfma_f32_16x16x32_bf16 v[196:199], v[124:127], v[48:51], v[196:199]
    s_add_u32 m0, s47, 39936
    s_nop 0
    buffer_load_dwordx4 v6, s[12:15], s49 offen lds
    v_mfma_f32_16x16x32_bf16 v[232:235], v[124:127], v[52:55], v[232:235]
    ds_read_b64_tr_b16 v[164:165], v2 offset:27776
    ds_read_b64_tr_b16 v[166:167], v2 offset:30080
    s_waitcnt lgkmcnt(15)
    v_mfma_f32_16x16x32_bf16 v[200:203], v[128:131], v[48:51], v[200:203]
    v_mfma_f32_16x16x32_bf16 v[236:239], v[128:131], v[52:55], v[236:239]
    s_mov_b32 exec_hi, 0
    s_add_u32 m0, s47, 40960
    s_nop 0
    buffer_load_dwordx4 v7, s[12:15], s49 offen lds
    s_mov_b32 exec_hi, -1
    ds_read_b64_tr_b16 v[168:169], v2 offset:27808
    ds_read_b64_tr_b16 v[170:171], v2 offset:30112
    v_mfma_f32_16x16x32_bf16 v[204:207], v[132:135], v[48:51], v[204:207]
    v_mfma_f32_16x16x32_bf16 v[240:243], v[132:135], v[52:55], v[240:243]
    s_add_u32 s56, s58, 5
    s_cmp_ge_u32 s56, 18
    s_cselect_b32 s59, 18, 0
    s_sub_u32 s56, s56, s59
    s_lshl_b32 s56, s56, 11
    s_add_u32 s56, s56, s41
    s_add_u32 s50, s56, 1024
    buffer_load_dwordx4 v[88:91], v8, s[8:11], s50 offen
    ds_read_b64_tr_b16 v[172:173], v2 offset:27840
    ds_read_b64_tr_b16 v[174:175], v2 offset:30144
    s_waitcnt lgkmcnt(15)
    v_mfma_f32_16x16x32_bf16 v[208:211], v[136:139], v[48:51], v[208:211]
    v_mfma_f32_16x16x32_bf16 v[244:247], v[136:139], v[52:55], v[244:247]
    s_add_u32 s50, s56, 148480
    buffer_load_dwordx4 v[92:95], v8, s[8:11], s50 offen
    ds_read_b64_tr_b16 v[176:177], v2 offset:27872
    ds_read_b64_tr_b16 v[178:179], v2 offset:30176
    v_mfma_f32_16x16x32_bf16 v[212:215], v[140:143], v[48:51], v[212:215]
    v_mfma_f32_16x16x32_bf16 v[248:251], v[140:143], v[52:55], v[248:251]
    ds_read_b64_tr_b16 v[180:181], v2 offset:27904
    ds_read_b64_tr_b16 v[182:183], v2 offset:30208
    s_waitcnt lgkmcnt(15)
    v_mfma_f32_16x16x32_bf16 v[216:219], v[144:147], v[48:51], v[216:219]
    v_mfma_f32_16x16x32_bf16 v[252:255], v[144:147], v[52:55], v[252:255]
    s_waitcnt vmcnt(18)
    ds_read_b64_tr_b16 v[112:113], v1 offset:0
    ds_read_b64_tr_b16 v[114:115], v1 offset:2304
    v_mfma_f32_16x16x32_bf16 v[184:187], v[148:151], v[56:59], v[184:187]
    s_add_u32 s56, s58, 6
    s_cmp_ge_u32 s56, 18
    s_cselect_b32 s59, 18, 0
    s_sub_u32 s56, s56, s59
    s_lshl_b32 s56, s56, 11
    s_add_u32 s56, s56, s41
    s_add_u32 s50, s56, 0
    buffer_load_dwordx4 v[48:51], v8, s[8:11], s50 offen
    v_mfma_f32_16x16x32_bf16 v[220:223], v[148:151], v[60:63], v[220:223]
    ds_read_b64_tr_b16 v[116:117], v1 offset:32
    ds_read_b64_tr_b16 v[118:119], v1 offset:2336
    s_waitcnt lgkmcnt(15)
    v_mfma_f32_16x16x32_bf16 v[188:191], v[152:155], v[56:59], v[188:191]
    v_mfma_f32_16x16x32_bf16 v[224:227], v[152:155], v[60:63], v[224:227]
    ds_read_b64_tr_b16 v[120:121], v1 offset:64
    ds_read_b64_tr_b16 v[122:123], v1 offset:2368
    v_mfma_f32_16x16x32_bf16 v[192:195], v[156:159], v[56:59], v[192:195]
    v_mfma_f32_16x16x32_bf16 v[228:231], v[156:159], v[60:63], v[228:231]
    ds_read_b64_tr_b16 v[124:125], v1 offset:96
    ds_read_b64_tr_b16 v[126:127], v1 offset:2400
    s_waitcnt lgkmcnt(15)
    v_mfma_f32_16x16x32_bf16 v[196:199], v[160:163], v[56:59], v[196:199]
    v_mfma_f32_16x16x32_bf16 v[232:235], v[160:163], v[60:63], v[232:235]
    ds_read_b64_tr_b16 v[128:129], v1 offset:128
    ds_read_b64_tr_b16 v[130:131], v1 offset:2432
    v_mfma_f32_16x16x32_bf16 v[200:203], v[164:167], v[56:59], v[200:203]
    s_add_u32 s50, s56, 147456
    buffer_load_dwordx4 v[52:55], v8, s[8:11], s50 offen
    v_mfma_f32_16x16x32_bf16 v[236:239], v[164:167], v[60:63], v[236:239]
    ds_read_b64_tr_b16 v[132:133], v1 offset:160
    ds_read_b64_tr_b16 v[134:135], v1 offset:2464
    s_waitcnt lgkmcnt(15)
    v_mfma_f32_16x16x32_bf16 v[204:207], v[168:171], v[56:59], v[204:207]
    v_mfma_f32_16x16x32_bf16 v[240:243], v[168:171], v[60:63], v[240:243]
    ds_read_b64_tr_b16 v[136:137], v1 offset:192
    ds_read_b64_tr_b16 v[138:139], v1 offset:2496
    v_mfma_f32_16x16x32_bf16 v[208:211], v[172:175], v[56:59], v[208:211]
    v_mfma_f32_16x16x32_bf16 v[244:247], v[172:175], v[60:63], v[244:247]
    ds_read_b64_tr_b16 v[140:141], v1 offset:224
    ds_read_b64_tr_b16 v[142:143], v1 offset:2528
    s_waitcnt lgkmcnt(15)
    v_mfma_f32_16x16x32_bf16 v[212:215], v[176:179], v[56:59], v[212:215]
    v_mfma_f32_16x16x32_bf16 v[248:251], v[176:179], v[60:63], v[248:251]
    ds_read_b64_tr_b16 v[144:145], v1 offset:256
    ds_read_b64_tr_b16 v[146:147], v1 offset:2560
    v_mfma_f32_16x16x32_bf16 v[216:219], v[180:183], v[56:59], v[216:219]
    v_mfma_f32_16x16x32_bf16 v[252:255], v[180:183], v[60:63], v[252:255]
    s_waitcnt vmcnt(13)
    s_barrier
    ds_read_b64_tr_b16 v[148:149], v1 offset:9216
    ds_read_b64_tr_b16 v[150:151], v1 offset:11520
    s_waitcnt lgkmcnt(15)
    v_mfma_f32_16x16x32_bf16 v[184:187], v[112:115], v[64:67], v[184:187]
    s_add_u32 s57, s58, 7
    s_cmp_ge_u32 s57, 18
    s_cselect_b32 s59, 18, 0
    s_sub_u32 s57, s57, s59
    s_mul_i32 s57, s57, 73728
    s_add_u32 s49, s48, s57
    s_add_u32 m0, s47, 55296
    s_nop 0
    buffer_load_dwordx4 v3, s[12:15], s49 offen lds
    v_mfma_f32_16x16x32_bf16 v[220:223], v[112:115], v[68:71], v[220:223]
    ds_read_b64_tr_b16 v[152:153], v1 offset:9248
    ds_read_b64_tr_b16 v[154:155], v1 offset:11552
    v_mfma_f32_16x16x32_bf16 v[188:191], v[116:119], v[64:67], v[188:191]
    s_add_u32 m0, s47, 56320
    s_nop 0
    buffer_load_dwordx4 v4, s[12:15], s49 offen lds
    v_mfma_f32_16x16x32_bf16 v[224:227], v[116:119], v[68:71], v[224:227]
    ds_read_b64_tr_b16 v[156:157], v1 offset:9280
    ds_read_b64_tr_b16 v[158:159], v1 offset:11584
    s_waitcnt lgkmcnt(15)
    v_mfma_f32_16x16x32_bf16 v[192:195], v[120:123], v[64:67], v[192:195]
    s_add_u32 m0, s47, 57344
    s_nop 0
    buffer_load_dwordx4 v5, s[12:15], s49 offen lds
    v_mfma_f32_16x16x32_bf16 v[228:231], v[120:123], v[68:71], v[228:231]
    ds_read_b64_tr_b16 v[160:161], v1 offset:9312
    ds_read_b64_tr_b16 v[162:163], v1 offset:11616
    v_mfma_f32_16x16x32_bf16 v[196:199], v[124:127], v[64:67], v[196:199]
    s_add_u32 m0, s47, 58368
    s_nop 0
    buffer_load_dwordx4 v6, s[12:15], s49 offen lds
    v_mfma_f32_16x16x32_bf16 v[232:235], v[124:127], v[68:71], v[232:235]
    ds_read_b64_tr_b16 v[164:165], v1 offset:9344
    ds_read_b64_tr_b16 v[166:167], v1 offset:11648
    s_waitcnt lgkmcnt(15)
    v_mfma_f32_16x16x32_bf16 v[200:203], v[128:131], v[64:67], v[200:203]
    v_mfma_f32_16x16x32_bf16 v[236:239], v[128:131], v[68:71], v[236:239]
    s_mov_b32 exec_hi, 0
    s_add_u32 m0, s47, 59392
    s_nop 0
    buffer_load_dwordx4 v7, s[12:15], s49 offen lds
    s_mov_b32 exec_hi, -1
    ds_read_b64_tr_b16 v[168:169], v1 offset:9376
    ds_read_b64_tr_b16 v[170:171], v1 offset:11680
    v_mfma_f32_16x16x32_bf16 v[204:207], v[132:135], v[64:67], v[204:207]
    v_mfma_f32_16x16x32_bf16 v[240:243], v[132:135], v[68:71], v[240:243]
    s_add_u32 s56, s58, 6
    s_cmp_ge_u32 s56, 18
    s_cselect_b32 s59, 18, 0
    s_sub_u32 s56, s56, s59
    s_lshl_b32 s56, s56, 11
    s_add_u32 s56, s56, s41
    s_add_u32 s50, s56, 1024
    buffer_load_dwordx4 v[56:59], v8, s[8:11], s50 offen
    ds_read_b64_tr_b16 v[172:173], v1 offset:9408
    ds_read_b64_tr_b16 v[174:175], v1 offset:11712
    s_waitcnt lgkmcnt(15)
    v_mfma_f32_16x16x32_bf16 v[208:211], v[136:139], v[64:67], v[208:211]
    v_mfma_f32_16x16x32_bf16 v[244:247], v[136:139], v[68:71], v[244:247]
    s_add_u32 s50, s56, 148480
    buffer_load_dwordx4 v[60:63], v8, s[8:11], s50 offen
    ds_read_b64_tr_b16 v[176:177], v1 offset:9440
    ds_read_b64_tr_b16 v[178:179], v1 offset:11744
    v_mfma_f32_16x16x32_bf16 v[212:215], v[140:143], v[64:67], v[212:215]
    v_mfma_f32_16x16x32_bf16 v[248:251], v[140:143], v[68:71], v[248:251]
    ds_read_b64_tr_b16 v[180:181], v1 offset:9472
    ds_read_b64_tr_b16 v[182:183], v1 offset:11776
    s_waitcnt lgkmcnt(15)
    v_mfma_f32_16x16x32_bf16 v[216:219], v[144:147], v[64:67], v[216:219]
    v_mfma_f32_16x16x32_bf16 v[252:255], v[144:147], v[68:71], v[252:255]
    s_waitcnt vmcnt(18)
    ds_read_b64_tr_b16 v[112:113], v1 offset:18432
    ds_read_b64_tr_b16 v[114:115], v1 offset:20736
    v_mfma_f32_16x16x32_bf16 v[184:187], v[148:151], v[72:75], v[184:187]
    s_add_u32 s56, s58, 7
    s_cmp_ge_u32 s56, 18
    s_cselect_b32 s59, 18, 0
    s_sub_u32 s56, s56, s59
    s_lshl_b32 s56, s56, 11
    s_add_u32 s56, s56, s41
    s_add_u32 s50, s56, 0
    buffer_load_dwordx4 v[64:67], v8, s[8:11], s50 offen
    v_mfma_f32_16x16x32_bf16 v[220:223], v[148:151], v[76:79], v[220:223]
    ds_read_b64_tr_b16 v[116:117], v1 offset:18464
    ds_read_b64_tr_b16 v[118:119], v1 offset:20768
    s_waitcnt lgkmcnt(15)
    v_mfma_f32_16x16x32_bf16 v[188:191], v[152:155], v[72:75], v[188:191]
    v_mfma_f32_16x16x32_bf16 v[224:227], v[152:155], v[76:79], v[224:227]
    ds_read_b64_tr_b16 v[120:121], v1 offset:18496
    ds_read_b64_tr_b16 v[122:123], v1 offset:20800
    v_mfma_f32_16x16x32_bf16 v[192:195], v[156:159], v[72:75], v[192:195]
    v_mfma_f32_16x16x32_bf16 v[228:231], v[156:159], v[76:79], v[228:231]
    ds_read_b64_tr_b16 v[124:125], v1 offset:18528
    ds_read_b64_tr_b16 v[126:127], v1 offset:20832
    s_waitcnt lgkmcnt(15)
    v_mfma_f32_16x16x32_bf16 v[196:199], v[160:163], v[72:75], v[196:199]
    v_mfma_f32_16x16x32_bf16 v[232:235], v[160:163], v[76:79], v[232:235]
    ds_read_b64_tr_b16 v[128:129], v1 offset:18560
    ds_read_b64_tr_b16 v[130:131], v1 offset:20864
    v_mfma_f32_16x16x32_bf16 v[200:203], v[164:167], v[72:75], v[200:203]
    s_add_u32 s50, s56, 147456
    buffer_load_dwordx4 v[68:71], v8, s[8:11], s50 offen
    v_mfma_f32_16x16x32_bf16 v[236:239], v[164:167], v[76:79], v[236:239]
    ds_read_b64_tr_b16 v[132:133], v1 offset:18592
    ds_read_b64_tr_b16 v[134:135], v1 offset:20896
    s_waitcnt lgkmcnt(15)
    v_mfma_f32_16x16x32_bf16 v[204:207], v[168:171], v[72:75], v[204:207]
    v_mfma_f32_16x16x32_bf16 v[240:243], v[168:171], v[76:79], v[240:243]
    ds_read_b64_tr_b16 v[136:137], v1 offset:18624
    ds_read_b64_tr_b16 v[138:139], v1 offset:20928
    v_mfma_f32_16x16x32_bf16 v[208:211], v[172:175], v[72:75], v[208:211]
    v_mfma_f32_16x16x32_bf16 v[244:247], v[172:175], v[76:79], v[244:247]
    ds_read_b64_tr_b16 v[140:141], v1 offset:18656
    ds_read_b64_tr_b16 v[142:143], v1 offset:20960
    s_waitcnt lgkmcnt(15)
    v_mfma_f32_16x16x32_bf16 v[212:215], v[176:179], v[72:75], v[212:215]
    v_mfma_f32_16x16x32_bf16 v[248:251], v[176:179], v[76:79], v[248:251]
    ds_read_b64_tr_b16 v[144:145], v1 offset:18688
    ds_read_b64_tr_b16 v[146:147], v1 offset:20992
    v_mfma_f32_16x16x32_bf16 v[216:219], v[180:183], v[72:75], v[216:219]
    v_mfma_f32_16x16x32_bf16 v[252:255], v[180:183], v[76:79], v[252:255]
    s_waitcnt vmcnt(13)
    s_barrier
    ds_read_b64_tr_b16 v[148:149], v1 offset:27648
    ds_read_b64_tr_b16 v[150:151], v1 offset:29952
    s_waitcnt lgkmcnt(15)
    v_mfma_f32_16x16x32_bf16 v[184:187], v[112:115], v[80:83], v[184:187]
    s_add_u32 s57, s58, 8
    s_cmp_ge_u32 s57, 18
    s_cselect_b32 s59, 18, 0
    s_sub_u32 s57, s57, s59
    s_mul_i32 s57, s57, 73728
    s_add_u32 s49, s48, s57
    s_add_u32 m0, s47, 0
    s_nop 0
    buffer_load_dwordx4 v3, s[12:15], s49 offen lds
    v_mfma_f32_16x16x32_bf16 v[220:223], v[112:115], v[84:87], v[220:223]
    ds_read_b64_tr_b16 v[152:153], v1 offset:27680
    ds_read_b64_tr_b16 v[154:155], v1 offset:29984
    v_mfma_f32_16x16x32_bf16 v[188:191], v[116:119], v[80:83], v[188:191]
    s_add_u32 m0, s47, 1024
    s_nop 0
    buffer_load_dwordx4 v4, s[12:15], s49 offen lds
    v_mfma_f32_16x16x32_bf16 v[224:227], v[116:119], v[84:87], v[224:227]
    ds_read_b64_tr_b16 v[156:157], v1 offset:27712
    ds_read_b64_tr_b16 v[158:159], v1 offset:30016
    s_waitcnt lgkmcnt(15)
    v_mfma_f32_16x16x32_bf16 v[192:195], v[120:123], v[80:83], v[192:195]
    s_add_u32 m0, s47, 2048
    s_nop 0
    buffer_load_dwordx4 v5, s[12:15], s49 offen lds
    v_mfma_f32_16x16x32_bf16 v[228:231], v[120:123], v[84:87], v[228:231]
    ds_read_b64_tr_b16 v[160:161], v1 offset:27744
    ds_read_b64_tr_b16 v[162:163], v1 offset:30048
    v_mfma_f32_16x16x32_bf16 v[196:199], v[124:127], v[80:83], v[196:199]
    s_add_u32 m0, s47, 3072
    s_nop 0
    buffer_load_dwordx4 v6, s[12:15], s49 offen lds
    v_mfma_f32_16x16x32_bf16 v[232:235], v[124:127], v[84:87], v[232:235]
    ds_read_b64_tr_b16 v[164:165], v1 offset:27776
    ds_read_b64_tr_b16 v[166:167], v1 offset:30080
    s_waitcnt lgkmcnt(15)
    v_mfma_f32_16x16x32_bf16 v[200:203], v[128:131], v[80:83], v[200:203]
    v_mfma_f32_16x16x32_bf16 v[236:239], v[128:131], v[84:87], v[236:239]
    s_mov_b32 exec_hi, 0
    s_add_u32 m0, s47, 4096
    s_nop 0
    buffer_load_dwordx4 v7, s[12:15], s49 offen lds
    s_mov_b32 exec_hi, -1
    ds_read_b64_tr_b16 v[168:169], v1 offset:27808
    ds_read_b64_tr_b16 v[170:171], v1 offset:30112
    v_mfma_f32_16x16x32_bf16 v[204:207], v[132:135], v[80:83], v[204:207]
    v_mfma_f32_16x16x32_bf16 v[240:243], v[132:135], v[84:87], v[240:243]
    s_add_u32 s56, s58, 7
    s_cmp_ge_u32 s56, 18
    s_cselect_b32 s59, 18, 0
    s_sub_u32 s56, s56, s59
    s_lshl_b32 s56, s56, 11
    s_add_u32 s56, s56, s41
    s_add_u32 s50, s56, 1024
    buffer_load_dwordx4 v[72:75], v8, s[8:11], s50 offen
    ds_read_b64_tr_b16 v[172:173], v1 offset:27840
    ds_read_b64_tr_b16 v[174:175], v1 offset:30144
    s_waitcnt lgkmcnt(15)
    v_mfma_f32_16x16x32_bf16 v[208:211], v[136:139], v[80:83], v[208:211]
    v_mfma_f32_16x16x32_bf16 v[244:247], v[136:139], v[84:87], v[244:247]
    s_add_u32 s50, s56, 148480
    buffer_load_dwordx4 v[76:79], v8, s[8:11], s50 offen
    ds_read_b64_tr_b16 v[176:177], v1 offset:27872
    ds_read_b64_tr_b16 v[178:179], v1 offset:30176
    v_mfma_f32_16x16x32_bf16 v[212:215], v[140:143], v[80:83], v[212:215]
    v_mfma_f32_16x16x32_bf16 v[248:251], v[140:143], v[84:87], v[248:251]
    ds_read_b64_tr_b16 v[180:181], v1 offset:27904
    ds_read_b64_tr_b16 v[182:183], v1 offset:30208
    s_waitcnt lgkmcnt(15)
    v_mfma_f32_16x16x32_bf16 v[216:219], v[144:147], v[80:83], v[216:219]
    v_mfma_f32_16x16x32_bf16 v[252:255], v[144:147], v[84:87], v[252:255]
    s_waitcnt vmcnt(18)
    ds_read_b64_tr_b16 v[112:113], v2 offset:0
    ds_read_b64_tr_b16 v[114:115], v2 offset:2304
    v_mfma_f32_16x16x32_bf16 v[184:187], v[148:151], v[88:91], v[184:187]
    s_add_u32 s56, s58, 8
    s_cmp_ge_u32 s56, 18
    s_cselect_b32 s59, 18, 0
    s_sub_u32 s56, s56, s59
    s_lshl_b32 s56, s56, 11
    s_add_u32 s56, s56, s41
    s_add_u32 s50, s56, 0
    buffer_load_dwordx4 v[80:83], v8, s[8:11], s50 offen
    v_mfma_f32_16x16x32_bf16 v[220:223], v[148:151], v[92:95], v[220:223]
    ds_read_b64_tr_b16 v[116:117], v2 offset:32
    ds_read_b64_tr_b16 v[118:119], v2 offset:2336
    s_waitcnt lgkmcnt(15)
    v_mfma_f32_16x16x32_bf16 v[188:191], v[152:155], v[88:91], v[188:191]
    v_mfma_f32_16x16x32_bf16 v[224:227], v[152:155], v[92:95], v[224:227]
    ds_read_b64_tr_b16 v[120:121], v2 offset:64
    ds_read_b64_tr_b16 v[122:123], v2 offset:2368
    v_mfma_f32_16x16x32_bf16 v[192:195], v[156:159], v[88:91], v[192:195]
    v_mfma_f32_16x16x32_bf16 v[228:231], v[156:159], v[92:95], v[228:231]
    ds_read_b64_tr_b16 v[124:125], v2 offset:96
    ds_read_b64_tr_b16 v[126:127], v2 offset:2400
    s_waitcnt lgkmcnt(15)
    v_mfma_f32_16x16x32_bf16 v[196:199], v[160:163], v[88:91], v[196:199]
    v_mfma_f32_16x16x32_bf16 v[232:235], v[160:163], v[92:95], v[232:235]
    ds_read_b64_tr_b16 v[128:129], v2 offset:128
    ds_read_b64_tr_b16 v[130:131], v2 offset:2432
    v_mfma_f32_16x16x32_bf16 v[200:203], v[164:167], v[88:91], v[200:203]
    s_add_u32 s50, s56, 147456
    buffer_load_dwordx4 v[84:87], v8, s[8:11], s50 offen
    v_mfma_f32_16x16x32_bf16 v[236:239], v[164:167], v[92:95], v[236:239]
    ds_read_b64_tr_b16 v[132:133], v2 offset:160
    ds_read_b64_tr_b16 v[134:135], v2 offset:2464
    s_waitcnt lgkmcnt(15)
    v_mfma_f32_16x16x32_bf16 v[204:207], v[168:171], v[88:91], v[204:207]
    v_mfma_f32_16x16x32_bf16 v[240:243], v[168:171], v[92:95], v[240:243]
    ds_read_b64_tr_b16 v[136:137], v2 offset:192
    ds_read_b64_tr_b16 v[138:139], v2 offset:2496
    v_mfma_f32_16x16x32_bf16 v[208:211], v[172:175], v[88:91], v[208:211]
    v_mfma_f32_16x16x32_bf16 v[244:247], v[172:175], v[92:95], v[244:247]
    ds_read_b64_tr_b16 v[140:141], v2 offset:224
    ds_read_b64_tr_b16 v[142:143], v2 offset:2528
    s_waitcnt lgkmcnt(15)
    v_mfma_f32_16x16x32_bf16 v[212:215], v[176:179], v[88:91], v[212:215]
    v_mfma_f32_16x16x32_bf16 v[248:251], v[176:179], v[92:95], v[248:251]
    ds_read_b64_tr_b16 v[144:145], v2 offset:256
    ds_read_b64_tr_b16 v[146:147], v2 offset:2560
    v_mfma_f32_16x16x32_bf16 v[216:219], v[180:183], v[88:91], v[216:219]
    v_mfma_f32_16x16x32_bf16 v[252:255], v[180:183], v[92:95], v[252:255]
    s_waitcnt vmcnt(13)
    s_barrier
    ds_read_b64_tr_b16 v[148:149], v2 offset:9216
    ds_read_b64_tr_b16 v[150:151], v2 offset:11520
    s_waitcnt lgkmcnt(15)
    v_mfma_f32_16x16x32_bf16 v[184:187], v[112:115], v[48:51], v[184:187]
    s_add_u32 s57, s58, 9
    s_cmp_ge_u32 s57, 18
    s_cselect_b32 s59, 18, 0
    s_sub_u32 s57, s57, s59
    s_mul_i32 s57, s57, 73728
    s_add_u32 s49, s48, s57
    s_add_u32 m0, s47, 18432
    s_nop 0
    buffer_load_dwordx4 v3, s[12:15], s49 offen lds
    v_mfma_f32_16x16x32_bf16 v[220:223], v[112:115], v[52:55], v[220:223]
    ds_read_b64_tr_b16 v[152:153], v2 offset:9248
    ds_read_b64_tr_b16 v[154:155], v2 offset:11552
    v_mfma_f32_16x16x32_bf16 v[188:191], v[116:119], v[48:51], v[188:191]
    s_add_u32 m0, s47, 19456
    s_nop 0
    buffer_load_dwordx4 v4, s[12:15], s49 offen lds
    v_mfma_f32_16x16x32_bf16 v[224:227], v[116:119], v[52:55], v[224:227]
    ds_read_b64_tr_b16 v[156:157], v2 offset:9280
    ds_read_b64_tr_b16 v[158:159], v2 offset:11584
    s_waitcnt lgkmcnt(15)
    v_mfma_f32_16x16x32_bf16 v[192:195], v[120:123], v[48:51], v[192:195]
    s_add_u32 m0, s47, 20480
    s_nop 0
    buffer_load_dwordx4 v5, s[12:15], s49 offen lds
    v_mfma_f32_16x16x32_bf16 v[228:231], v[120:123], v[52:55], v[228:231]
    ds_read_b64_tr_b16 v[160:161], v2 offset:9312
    ds_read_b64_tr_b16 v[162:163], v2 offset:11616
    v_mfma_f32_16x16x32_bf16 v[196:199], v[124:127], v[48:51], v[196:199]
    s_add_u32 m0, s47, 21504
    s_nop 0
    buffer_load_dwordx4 v6, s[12:15], s49 offen lds
    v_mfma_f32_16x16x32_bf16 v[232:235], v[124:127], v[52:55], v[232:235]
    ds_read_b64_tr_b16 v[164:165], v2 offset:9344
    ds_read_b64_tr_b16 v[166:167], v2 offset:11648
    s_waitcnt lgkmcnt(15)
    v_mfma_f32_16x16x32_bf16 v[200:203], v[128:131], v[48:51], v[200:203]
    v_mfma_f32_16x16x32_bf16 v[236:239], v[128:131], v[52:55], v[236:239]
    s_mov_b32 exec_hi, 0
    s_add_u32 m0, s47, 22528
    s_nop 0
    buffer_load_dwordx4 v7, s[12:15], s49 offen lds
    s_mov_b32 exec_hi, -1
    ds_read_b64_tr_b16 v[168:169], v2 offset:9376
    ds_read_b64_tr_b16 v[170:171], v2 offset:11680
    v_mfma_f32_16x16x32_bf16 v[204:207], v[132:135], v[48:51], v[204:207]
    v_mfma_f32_16x16x32_bf16 v[240:243], v[132:135], v[52:55], v[240:243]
    s_add_u32 s56, s58, 8
    s_cmp_ge_u32 s56, 18
    s_cselect_b32 s59, 18, 0
    s_sub_u32 s56, s56, s59
    s_lshl_b32 s56, s56, 11
    s_add_u32 s56, s56, s41
    s_add_u32 s50, s56, 1024
    buffer_load_dwordx4 v[88:91], v8, s[8:11], s50 offen
    ds_read_b64_tr_b16 v[172:173], v2 offset:9408
    ds_read_b64_tr_b16 v[174:175], v2 offset:11712
    s_waitcnt lgkmcnt(15)
    v_mfma_f32_16x16x32_bf16 v[208:211], v[136:139], v[48:51], v[208:211]
    v_mfma_f32_16x16x32_bf16 v[244:247], v[136:139], v[52:55], v[244:247]
    s_add_u32 s50, s56, 148480
    buffer_load_dwordx4 v[92:95], v8, s[8:11], s50 offen
    ds_read_b64_tr_b16 v[176:177], v2 offset:9440
    ds_read_b64_tr_b16 v[178:179], v2 offset:11744
    v_mfma_f32_16x16x32_bf16 v[212:215], v[140:143], v[48:51], v[212:215]
    v_mfma_f32_16x16x32_bf16 v[248:251], v[140:143], v[52:55], v[248:251]
    ds_read_b64_tr_b16 v[180:181], v2 offset:9472
    ds_read_b64_tr_b16 v[182:183], v2 offset:11776
    s_waitcnt lgkmcnt(15)
    v_mfma_f32_16x16x32_bf16 v[216:219], v[144:147], v[48:51], v[216:219]
    v_mfma_f32_16x16x32_bf16 v[252:255], v[144:147], v[52:55], v[252:255]
    s_waitcnt vmcnt(18)
    ds_read_b64_tr_b16 v[112:113], v2 offset:18432
    ds_read_b64_tr_b16 v[114:115], v2 offset:20736
    v_mfma_f32_16x16x32_bf16 v[184:187], v[148:151], v[56:59], v[184:187]
    s_add_u32 s56, s58, 9
    s_cmp_ge_u32 s56, 18
    s_cselect_b32 s59, 18, 0
    s_sub_u32 s56, s56, s59
    s_lshl_b32 s56, s56, 11
    s_add_u32 s56, s56, s41
    s_add_u32 s50, s56, 0
    buffer_load_dwordx4 v[48:51], v8, s[8:11], s50 offen
    v_mfma_f32_16x16x32_bf16 v[220:223], v[148:151], v[60:63], v[220:223]
    ds_read_b64_tr_b16 v[116:117], v2 offset:18464
    ds_read_b64_tr_b16 v[118:119], v2 offset:20768
    s_waitcnt lgkmcnt(15)
    v_mfma_f32_16x16x32_bf16 v[188:191], v[152:155], v[56:59], v[188:191]
    v_mfma_f32_16x16x32_bf16 v[224:227], v[152:155], v[60:63], v[224:227]
    ds_read_b64_tr_b16 v[120:121], v2 offset:18496
    ds_read_b64_tr_b16 v[122:123], v2 offset:20800
    v_mfma_f32_16x16x32_bf16 v[192:195], v[156:159], v[56:59], v[192:195]
    v_mfma_f32_16x16x32_bf16 v[228:231], v[156:159], v[60:63], v[228:231]
    ds_read_b64_tr_b16 v[124:125], v2 offset:18528
    ds_read_b64_tr_b16 v[126:127], v2 offset:20832
    s_waitcnt lgkmcnt(15)
    v_mfma_f32_16x16x32_bf16 v[196:199], v[160:163], v[56:59], v[196:199]
    v_mfma_f32_16x16x32_bf16 v[232:235], v[160:163], v[60:63], v[232:235]
    ds_read_b64_tr_b16 v[128:129], v2 offset:18560
    ds_read_b64_tr_b16 v[130:131], v2 offset:20864
    v_mfma_f32_16x16x32_bf16 v[200:203], v[164:167], v[56:59], v[200:203]
    s_add_u32 s50, s56, 147456
    buffer_load_dwordx4 v[52:55], v8, s[8:11], s50 offen
    v_mfma_f32_16x16x32_bf16 v[236:239], v[164:167], v[60:63], v[236:239]
    ds_read_b64_tr_b16 v[132:133], v2 offset:18592
    ds_read_b64_tr_b16 v[134:135], v2 offset:20896
    s_waitcnt lgkmcnt(15)
    v_mfma_f32_16x16x32_bf16 v[204:207], v[168:171], v[56:59], v[204:207]
    v_mfma_f32_16x16x32_bf16 v[240:243], v[168:171], v[60:63], v[240:243]
    ds_read_b64_tr_b16 v[136:137], v2 offset:18624
    ds_read_b64_tr_b16 v[138:139], v2 offset:20928
    v_mfma_f32_16x16x32_bf16 v[208:211], v[172:175], v[56:59], v[208:211]
    v_mfma_f32_16x16x32_bf16 v[244:247], v[172:175], v[60:63], v[244:247]
    ds_read_b64_tr_b16 v[140:141], v2 offset:18656
    ds_read_b64_tr_b16 v[142:143], v2 offset:20960
    s_waitcnt lgkmcnt(15)
    v_mfma_f32_16x16x32_bf16 v[212:215], v[176:179], v[56:59], v[212:215]
    v_mfma_f32_16x16x32_bf16 v[248:251], v[176:179], v[60:63], v[248:251]
    ds_read_b64_tr_b16 v[144:145], v2 offset:18688
    ds_read_b64_tr_b16 v[146:147], v2 offset:20992
    v_mfma_f32_16x16x32_bf16 v[216:219], v[180:183], v[56:59], v[216:219]
    v_mfma_f32_16x16x32_bf16 v[252:255], v[180:183], v[60:63], v[252:255]
    s_waitcnt vmcnt(13)
    s_barrier
    ds_read_b64_tr_b16 v[148:149], v2 offset:27648
    ds_read_b64_tr_b16 v[150:151], v2 offset:29952
    s_waitcnt lgkmcnt(15)
    v_mfma_f32_16x16x32_bf16 v[184:187], v[112:115], v[64:67], v[184:187]
    s_add_u32 s57, s58, 10
    s_cmp_ge_u32 s57, 18
    s_cselect_b32 s59, 18, 0
    s_sub_u32 s57, s57, s59
    s_mul_i32 s57, s57, 73728
    s_add_u32 s49, s48, s57
    s_add_u32 m0, s47, 36864
    s_nop 0
    buffer_load_dwordx4 v3, s[12:15], s49 offen lds
    v_mfma_f32_16x16x32_bf16 v[220:223], v[112:115], v[68:71], v[220:223]
    ds_read_b64_tr_b16 v[152:153], v2 offset:27680
    ds_read_b64_tr_b16 v[154:155], v2 offset:29984
    v_mfma_f32_16x16x32_bf16 v[188:191], v[116:119], v[64:67], v[188:191]
    s_add_u32 m0, s47, 37888
    s_nop 0
    buffer_load_dwordx4 v4, s[12:15], s49 offen lds
    v_mfma_f32_16x16x32_bf16 v[224:227], v[116:119], v[68:71], v[224:227]
    ds_read_b64_tr_b16 v[156:157], v2 offset:27712
    ds_read_b64_tr_b16 v[158:159], v2 offset:30016
    s_waitcnt lgkmcnt(15)
    v_mfma_f32_16x16x32_bf16 v[192:195], v[120:123], v[64:67], v[192:195]
    s_add_u32 m0, s47, 38912
    s_nop 0
    buffer_load_dwordx4 v5, s[12:15], s49 offen lds
    v_mfma_f32_16x16x32_bf16 v[228:231], v[120:123], v[68:71], v[228:231]
    ds_read_b64_tr_b16 v[160:161], v2 offset:27744
    ds_read_b64_tr_b16 v[162:163], v2 offset:30048
    v_mfma_f32_16x16x32_bf16 v[196:199], v[124:127], v[64:67], v[196:199]
    s_add_u32 m0, s47, 39936
    s_nop 0
    buffer_load_dwordx4 v6, s[12:15], s49 offen lds
    v_mfma_f32_16x16x32_bf16 v[232:235], v[124:127], v[68:71], v[232:235]
    ds_read_b64_tr_b16 v[164:165], v2 offset:27776
    ds_read_b64_tr_b16 v[166:167], v2 offset:30080
    s_waitcnt lgkmcnt(15)
    v_mfma_f32_16x16x32_bf16 v[200:203], v[128:131], v[64:67], v[200:203]
    v_mfma_f32_16x16x32_bf16 v[236:239], v[128:131], v[68:71], v[236:239]
    s_mov_b32 exec_hi, 0
    s_add_u32 m0, s47, 40960
    s_nop 0
    buffer_load_dwordx4 v7, s[12:15], s49 offen lds
    s_mov_b32 exec_hi, -1
    ds_read_b64_tr_b16 v[168:169], v2 offset:27808
    ds_read_b64_tr_b16 v[170:171], v2 offset:30112
    v_mfma_f32_16x16x32_bf16 v[204:207], v[132:135], v[64:67], v[204:207]
    v_mfma_f32_16x16x32_bf16 v[240:243], v[132:135], v[68:71], v[240:243]
    s_add_u32 s56, s58, 9
    s_cmp_ge_u32 s56, 18
    s_cselect_b32 s59, 18, 0
    s_sub_u32 s56, s56, s59
    s_lshl_b32 s56, s56, 11
    s_add_u32 s56, s56, s41
    s_add_u32 s50, s56, 1024
    buffer_load_dwordx4 v[56:59], v8, s[8:11], s50 offen
    ds_read_b64_tr_b16 v[172:173], v2 offset:27840
    ds_read_b64_tr_b16 v[174:175], v2 offset:30144
    s_waitcnt lgkmcnt(15)
    v_mfma_f32_16x16x32_bf16 v[208:211], v[136:139], v[64:67], v[208:211]
    v_mfma_f32_16x16x32_bf16 v[244:247], v[136:139], v[68:71], v[244:247]
    s_add_u32 s50, s56, 148480
    buffer_load_dwordx4 v[60:63], v8, s[8:11], s50 offen
    ds_read_b64_tr_b16 v[176:177], v2 offset:27872
    ds_read_b64_tr_b16 v[178:179], v2 offset:30176
    v_mfma_f32_16x16x32_bf16 v[212:215], v[140:143], v[64:67], v[212:215]
    v_mfma_f32_16x16x32_bf16 v[248:251], v[140:143], v[68:71], v[248:251]
    ds_read_b64_tr_b16 v[180:181], v2 offset:27904
    ds_read_b64_tr_b16 v[182:183], v2 offset:30208
    s_waitcnt lgkmcnt(15)
    v_mfma_f32_16x16x32_bf16 v[216:219], v[144:147], v[64:67], v[216:219]
    v_mfma_f32_16x16x32_bf16 v[252:255], v[144:147], v[68:71], v[252:255]
    s_waitcnt vmcnt(18)
    ds_read_b64_tr_b16 v[112:113], v1 offset:0
    ds_read_b64_tr_b16 v[114:115], v1 offset:2304
    v_mfma_f32_16x16x32_bf16 v[184:187], v[148:151], v[72:75], v[184:187]
    s_add_u32 s56, s58, 10
    s_cmp_ge_u32 s56, 18
    s_cselect_b32 s59, 18, 0
    s_sub_u32 s56, s56, s59
    s_lshl_b32 s56, s56, 11
    s_add_u32 s56, s56, s41
    s_add_u32 s50, s56, 0
    buffer_load_dwordx4 v[64:67], v8, s[8:11], s50 offen
    v_mfma_f32_16x16x32_bf16 v[220:223], v[148:151], v[76:79], v[220:223]
    ds_read_b64_tr_b16 v[116:117], v1 offset:32
    ds_read_b64_tr_b16 v[118:119], v1 offset:2336
    s_waitcnt lgkmcnt(15)
    v_mfma_f32_16x16x32_bf16 v[188:191], v[152:155], v[72:75], v[188:191]
    v_mfma_f32_16x16x32_bf16 v[224:227], v[152:155], v[76:79], v[224:227]
    ds_read_b64_tr_b16 v[120:121], v1 offset:64
    ds_read_b64_tr_b16 v[122:123], v1 offset:2368
    v_mfma_f32_16x16x32_bf16 v[192:195], v[156:159], v[72:75], v[192:195]
    v_mfma_f32_16x16x32_bf16 v[228:231], v[156:159], v[76:79], v[228:231]
    ds_read_b64_tr_b16 v[124:125], v1 offset:96
    ds_read_b64_tr_b16 v[126:127], v1 offset:2400
    s_waitcnt lgkmcnt(15)
    v_mfma_f32_16x16x32_bf16 v[196:199], v[160:163], v[72:75], v[196:199]
    v_mfma_f32_16x16x32_bf16 v[232:235], v[160:163], v[76:79], v[232:235]
    ds_read_b64_tr_b16 v[128:129], v1 offset:128
    ds_read_b64_tr_b16 v[130:131], v1 offset:2432
    v_mfma_f32_16x16x32_bf16 v[200:203], v[164:167], v[72:75], v[200:203]
    s_add_u32 s50, s56, 147456
    buffer_load_dwordx4 v[68:71], v8, s[8:11], s50 offen
    v_mfma_f32_16x16x32_bf16 v[236:239], v[164:167], v[76:79], v[236:239]
    ds_read_b64_tr_b16 v[132:133], v1 offset:160
    ds_read_b64_tr_b16 v[134:135], v1 offset:2464
    s_waitcnt lgkmcnt(15)
    v_mfma_f32_16x16x32_bf16 v[204:207], v[168:171], v[72:75], v[204:207]
    v_mfma_f32_16x16x32_bf16 v[240:243], v[168:171], v[76:79], v[240:243]
    ds_read_b64_tr_b16 v[136:137], v1 offset:192
    ds_read_b64_tr_b16 v[138:139], v1 offset:2496
    v_mfma_f32_16x16x32_bf16 v[208:211], v[172:175], v[72:75], v[208:211]
    v_mfma_f32_16x16x32_bf16 v[244:247], v[172:175], v[76:79], v[244:247]
    ds_read_b64_tr_b16 v[140:141], v1 offset:224
    ds_read_b64_tr_b16 v[142:143], v1 offset:2528
    s_waitcnt lgkmcnt(15)
    v_mfma_f32_16x16x32_bf16 v[212:215], v[176:179], v[72:75], v[212:215]
    v_mfma_f32_16x16x32_bf16 v[248:251], v[176:179], v[76:79], v[248:251]
    ds_read_b64_tr_b16 v[144:145], v1 offset:256
    ds_read_b64_tr_b16 v[146:147], v1 offset:2560
    v_mfma_f32_16x16x32_bf16 v[216:219], v[180:183], v[72:75], v[216:219]
    v_mfma_f32_16x16x32_bf16 v[252:255], v[180:183], v[76:79], v[252:255]
    s_waitcnt vmcnt(13)
    s_barrier
    ds_read_b64_tr_b16 v[148:149], v1 offset:9216
    ds_read_b64_tr_b16 v[150:151], v1 offset:11520
    s_waitcnt lgkmcnt(15)
    v_mfma_f32_16x16x32_bf16 v[184:187], v[112:115], v[80:83], v[184:187]
    s_add_u32 s57, s58, 11
    s_cmp_ge_u32 s57, 18
    s_cselect_b32 s59, 18, 0
    s_sub_u32 s57, s57, s59
    s_mul_i32 s57, s57, 73728
    s_add_u32 s49, s48, s57
    s_add_u32 m0, s47, 55296
    s_nop 0
    buffer_load_dwordx4 v3, s[12:15], s49 offen lds
    v_mfma_f32_16x16x32_bf16 v[220:223], v[112:115], v[84:87], v[220:223]
    ds_read_b64_tr_b16 v[152:153], v1 offset:9248
    ds_read_b64_tr_b16 v[154:155], v1 offset:11552
    v_mfma_f32_16x16x32_bf16 v[188:191], v[116:119], v[80:83], v[188:191]
    s_add_u32 m0, s47, 56320
    s_nop 0
    buffer_load_dwordx4 v4, s[12:15], s49 offen lds
    v_mfma_f32_16x16x32_bf16 v[224:227], v[116:119], v[84:87], v[224:227]
    ds_read_b64_tr_b16 v[156:157], v1 offset:9280
    ds_read_b64_tr_b16 v[158:159], v1 offset:11584
    s_waitcnt lgkmcnt(15)
    v_mfma_f32_16x16x32_bf16 v[192:195], v[120:123], v[80:83], v[192:195]
    s_add_u32 m0, s47, 57344
    s_nop 0
    buffer_load_dwordx4 v5, s[12:15], s49 offen lds
    v_mfma_f32_16x16x32_bf16 v[228:231], v[120:123], v[84:87], v[228:231]
    ds_read_b64_tr_b16 v[160:161], v1 offset:9312
    ds_read_b64_tr_b16 v[162:163], v1 offset:11616
    v_mfma_f32_16x16x32_bf16 v[196:199], v[124:127], v[80:83], v[196:199]
    s_add_u32 m0, s47, 58368
    s_nop 0
    buffer_load_dwordx4 v6, s[12:15], s49 offen lds
    v_mfma_f32_16x16x32_bf16 v[232:235], v[124:127], v[84:87], v[232:235]
    ds_read_b64_tr_b16 v[164:165], v1 offset:9344
    ds_read_b64_tr_b16 v[166:167], v1 offset:11648
    s_waitcnt lgkmcnt(15)
    v_mfma_f32_16x16x32_bf16 v[200:203], v[128:131], v[80:83], v[200:203]
    v_mfma_f32_16x16x32_bf16 v[236:239], v[128:131], v[84:87], v[236:239]
    s_mov_b32 exec_hi, 0
    s_add_u32 m0, s47, 59392
    s_nop 0
    buffer_load_dwordx4 v7, s[12:15], s49 offen lds
    s_mov_b32 exec_hi, -1
    ds_read_b64_tr_b16 v[168:169], v1 offset:9376
    ds_read_b64_tr_b16 v[170:171], v1 offset:11680
    v_mfma_f32_16x16x32_bf16 v[204:207], v[132:135], v[80:83], v[204:207]
    v_mfma_f32_16x16x32_bf16 v[240:243], v[132:135], v[84:87], v[240:243]
    s_add_u32 s56, s58, 10
    s_cmp_ge_u32 s56, 18
    s_cselect_b32 s59, 18, 0
    s_sub_u32 s56, s56, s59
    s_lshl_b32 s56, s56, 11
    s_add_u32 s56, s56, s41
    s_add_u32 s50, s56, 1024
    buffer_load_dwordx4 v[72:75], v8, s[8:11], s50 offen
    ds_read_b64_tr_b16 v[172:173], v1 offset:9408
    ds_read_b64_tr_b16 v[174:175], v1 offset:11712
    s_waitcnt lgkmcnt(15)
    v_mfma_f32_16x16x32_bf16 v[208:211], v[136:139], v[80:83], v[208:211]
    v_mfma_f32_16x16x32_bf16 v[244:247], v[136:139], v[84:87], v[244:247]
    s_add_u32 s50, s56, 148480
    buffer_load_dwordx4 v[76:79], v8, s[8:11], s50 offen
    ds_read_b64_tr_b16 v[176:177], v1 offset:9440
    ds_read_b64_tr_b16 v[178:179], v1 offset:11744
    v_mfma_f32_16x16x32_bf16 v[212:215], v[140:143], v[80:83], v[212:215]
    v_mfma_f32_16x16x32_bf16 v[248:251], v[140:143], v[84:87], v[248:251]
    ds_read_b64_tr_b16 v[180:181], v1 offset:9472
    ds_read_b64_tr_b16 v[182:183], v1 offset:11776
    s_waitcnt lgkmcnt(15)
    v_mfma_f32_16x16x32_bf16 v[216:219], v[144:147], v[80:83], v[216:219]
    v_mfma_f32_16x16x32_bf16 v[252:255], v[144:147], v[84:87], v[252:255]
    s_waitcnt vmcnt(18)
    ds_read_b64_tr_b16 v[112:113], v1 offset:18432
    ds_read_b64_tr_b16 v[114:115], v1 offset:20736
    v_mfma_f32_16x16x32_bf16 v[184:187], v[148:151], v[88:91], v[184:187]
    s_add_u32 s56, s58, 11
    s_cmp_ge_u32 s56, 18
    s_cselect_b32 s59, 18, 0
    s_sub_u32 s56, s56, s59
    s_lshl_b32 s56, s56, 11
    s_add_u32 s56, s56, s41
    s_add_u32 s50, s56, 0
    buffer_load_dwordx4 v[80:83], v8, s[8:11], s50 offen
    v_mfma_f32_16x16x32_bf16 v[220:223], v[148:151], v[92:95], v[220:223]
    ds_read_b64_tr_b16 v[116:117], v1 offset:18464
    ds_read_b64_tr_b16 v[118:119], v1 offset:20768
    s_waitcnt lgkmcnt(15)
    v_mfma_f32_16x16x32_bf16 v[188:191], v[152:155], v[88:91], v[188:191]
    v_mfma_f32_16x16x32_bf16 v[224:227], v[152:155], v[92:95], v[224:227]
    ds_read_b64_tr_b16 v[120:121], v1 offset:18496
    ds_read_b64_tr_b16 v[122:123], v1 offset:20800
    v_mfma_f32_16x16x32_bf16 v[192:195], v[156:159], v[88:91], v[192:195]
    v_mfma_f32_16x16x32_bf16 v[228:231], v[156:159], v[92:95], v[228:231]
    ds_read_b64_tr_b16 v[124:125], v1 offset:18528
    ds_read_b64_tr_b16 v[126:127], v1 offset:20832
    s_waitcnt lgkmcnt(15)
    v_mfma_f32_16x16x32_bf16 v[196:199], v[160:163], v[88:91], v[196:199]
    v_mfma_f32_16x16x32_bf16 v[232:235], v[160:163], v[92:95], v[232:235]
    ds_read_b64_tr_b16 v[128:129], v1 offset:18560
    ds_read_b64_tr_b16 v[130:131], v1 offset:20864
    v_mfma_f32_16x16x32_bf16 v[200:203], v[164:167], v[88:91], v[200:203]
    s_add_u32 s50, s56, 147456
    buffer_load_dwordx4 v[84:87], v8, s[8:11], s50 offen
    v_mfma_f32_16x16x32_bf16 v[236:239], v[164:167], v[92:95], v[236:239]
    ds_read_b64_tr_b16 v[132:133], v1 offset:18592
    ds_read_b64_tr_b16 v[134:135], v1 offset:20896
    s_waitcnt lgkmcnt(15)
    v_mfma_f32_16x16x32_bf16 v[204:207], v[168:171], v[88:91], v[204:207]
    v_mfma_f32_16x16x32_bf16 v[240:243], v[168:171], v[92:95], v[240:243]
    ds_read_b64_tr_b16 v[136:137], v1 offset:18624
    ds_read_b64_tr_b16 v[138:139], v1 offset:20928
    v_mfma_f32_16x16x32_bf16 v[208:211], v[172:175], v[88:91], v[208:211]
    v_mfma_f32_16x16x32_bf16 v[244:247], v[172:175], v[92:95], v[244:247]
    ds_read_b64_tr_b16 v[140:141], v1 offset:18656
    ds_read_b64_tr_b16 v[142:143], v1 offset:20960
    s_waitcnt lgkmcnt(15)
    v_mfma_f32_16x16x32_bf16 v[212:215], v[176:179], v[88:91], v[212:215]
    v_mfma_f32_16x16x32_bf16 v[248:251], v[176:179], v[92:95], v[248:251]
    ds_read_b64_tr_b16 v[144:145], v1 offset:18688
    ds_read_b64_tr_b16 v[146:147], v1 offset:20992
    v_mfma_f32_16x16x32_bf16 v[216:219], v[180:183], v[88:91], v[216:219]
    v_mfma_f32_16x16x32_bf16 v[252:255], v[180:183], v[92:95], v[252:255]
    s_waitcnt vmcnt(13)
    s_barrier
    ds_read_b64_tr_b16 v[148:149], v1 offset:27648
    ds_read_b64_tr_b16 v[150:151], v1 offset:29952
    s_waitcnt lgkmcnt(15)
    v_mfma_f32_16x16x32_bf16 v[184:187], v[112:115], v[48:51], v[184:187]
    s_add_u32 s57, s58, 12
    s_cmp_ge_u32 s57, 18
    s_cselect_b32 s59, 18, 0
    s_sub_u32 s57, s57, s59
    s_mul_i32 s57, s57, 73728
    s_add_u32 s49, s48, s57
    s_add_u32 m0, s47, 0
    s_nop 0
    buffer_load_dwordx4 v3, s[12:15], s49 offen lds
    v_mfma_f32_16x16x32_bf16 v[220:223], v[112:115], v[52:55], v[220:223]
    ds_read_b64_tr_b16 v[152:153], v1 offset:27680
    ds_read_b64_tr_b16 v[154:155], v1 offset:29984
    v_mfma_f32_16x16x32_bf16 v[188:191], v[116:119], v[48:51], v[188:191]
    s_add_u32 m0, s47, 1024
    s_nop 0
    buffer_load_dwordx4 v4, s[12:15], s49 offen lds
    v_mfma_f32_16x16x32_bf16 v[224:227], v[116:119], v[52:55], v[224:227]
    ds_read_b64_tr_b16 v[156:157], v1 offset:27712
    ds_read_b64_tr_b16 v[158:159], v1 offset:30016
    s_waitcnt lgkmcnt(15)
    v_mfma_f32_16x16x32_bf16 v[192:195], v[120:123], v[48:51], v[192:195]
    s_add_u32 m0, s47, 2048
    s_nop 0
    buffer_load_dwordx4 v5, s[12:15], s49 offen lds
    v_mfma_f32_16x16x32_bf16 v[228:231], v[120:123], v[52:55], v[228:231]
    ds_read_b64_tr_b16 v[160:161], v1 offset:27744
    ds_read_b64_tr_b16 v[162:163], v1 offset:30048
    v_mfma_f32_16x16x32_bf16 v[196:199], v[124:127], v[48:51], v[196:199]
    s_add_u32 m0, s47, 3072
    s_nop 0
    buffer_load_dwordx4 v6, s[12:15], s49 offen lds
    v_mfma_f32_16x16x32_bf16 v[232:235], v[124:127], v[52:55], v[232:235]
    ds_read_b64_tr_b16 v[164:165], v1 offset:27776
    ds_read_b64_tr_b16 v[166:167], v1 offset:30080
    s_waitcnt lgkmcnt(15)
    v_mfma_f32_16x16x32_bf16 v[200:203], v[128:131], v[48:51], v[200:203]
    v_mfma_f32_16x16x32_bf16 v[236:239], v[128:131], v[52:55], v[236:239]
    s_mov_b32 exec_hi, 0
    s_add_u32 m0, s47, 4096
    s_nop 0
    buffer_load_dwordx4 v7, s[12:15], s49 offen lds
    s_mov_b32 exec_hi, -1
    ds_read_b64_tr_b16 v[168:169], v1 offset:27808
    ds_read_b64_tr_b16 v[170:171], v1 offset:30112
    v_mfma_f32_16x16x32_bf16 v[204:207], v[132:135], v[48:51], v[204:207]
    v_mfma_f32_16x16x32_bf16 v[240:243], v[132:135], v[52:55], v[240:243]
    s_add_u32 s56, s58, 11
    s_cmp_ge_u32 s56, 18
    s_cselect_b32 s59, 18, 0
    s_sub_u32 s56, s56, s59
    s_lshl_b32 s56, s56, 11
    s_add_u32 s56, s56, s41
    s_add_u32 s50, s56, 1024
    buffer_load_dwordx4 v[88:91], v8, s[8:11], s50 offen
    ds_read_b64_tr_b16 v[172:173], v1 offset:27840
    ds_read_b64_tr_b16 v[174:175], v1 offset:30144
    s_waitcnt lgkmcnt(15)
    v_mfma_f32_16x16x32_bf16 v[208:211], v[136:139], v[48:51], v[208:211]
    v_mfma_f32_16x16x32_bf16 v[244:247], v[136:139], v[52:55], v[244:247]
    s_add_u32 s50, s56, 148480
    buffer_load_dwordx4 v[92:95], v8, s[8:11], s50 offen
    ds_read_b64_tr_b16 v[176:177], v1 offset:27872
    ds_read_b64_tr_b16 v[178:179], v1 offset:30176
    v_mfma_f32_16x16x32_bf16 v[212:215], v[140:143], v[48:51], v[212:215]
    v_mfma_f32_16x16x32_bf16 v[248:251], v[140:143], v[52:55], v[248:251]
    ds_read_b64_tr_b16 v[180:181], v1 offset:27904
    ds_read_b64_tr_b16 v[182:183], v1 offset:30208
    s_waitcnt lgkmcnt(15)
    v_mfma_f32_16x16x32_bf16 v[216:219], v[144:147], v[48:51], v[216:219]
    v_mfma_f32_16x16x32_bf16 v[252:255], v[144:147], v[52:55], v[252:255]
    s_waitcnt vmcnt(18)
    ds_read_b64_tr_b16 v[112:113], v2 offset:0
    ds_read_b64_tr_b16 v[114:115], v2 offset:2304
    v_mfma_f32_16x16x32_bf16 v[184:187], v[148:151], v[56:59], v[184:187]
    s_add_u32 s56, s58, 12
    s_cmp_ge_u32 s56, 18
    s_cselect_b32 s59, 18, 0
    s_sub_u32 s56, s56, s59
    s_lshl_b32 s56, s56, 11
    s_add_u32 s56, s56, s41
    s_add_u32 s50, s56, 0
    buffer_load_dwordx4 v[48:51], v8, s[8:11], s50 offen
    v_mfma_f32_16x16x32_bf16 v[220:223], v[148:151], v[60:63], v[220:223]
    ds_read_b64_tr_b16 v[116:117], v2 offset:32
    ds_read_b64_tr_b16 v[118:119], v2 offset:2336
    s_waitcnt lgkmcnt(15)
    v_mfma_f32_16x16x32_bf16 v[188:191], v[152:155], v[56:59], v[188:191]
    v_mfma_f32_16x16x32_bf16 v[224:227], v[152:155], v[60:63], v[224:227]
    ds_read_b64_tr_b16 v[120:121], v2 offset:64
    ds_read_b64_tr_b16 v[122:123], v2 offset:2368
    v_mfma_f32_16x16x32_bf16 v[192:195], v[156:159], v[56:59], v[192:195]
    v_mfma_f32_16x16x32_bf16 v[228:231], v[156:159], v[60:63], v[228:231]
    ds_read_b64_tr_b16 v[124:125], v2 offset:96
    ds_read_b64_tr_b16 v[126:127], v2 offset:2400
    s_waitcnt lgkmcnt(15)
    v_mfma_f32_16x16x32_bf16 v[196:199], v[160:163], v[56:59], v[196:199]
    v_mfma_f32_16x16x32_bf16 v[232:235], v[160:163], v[60:63], v[232:235]
    ds_read_b64_tr_b16 v[128:129], v2 offset:128
    ds_read_b64_tr_b16 v[130:131], v2 offset:2432
    v_mfma_f32_16x16x32_bf16 v[200:203], v[164:167], v[56:59], v[200:203]
    s_add_u32 s50, s56, 147456
    buffer_load_dwordx4 v[52:55], v8, s[8:11], s50 offen
    v_mfma_f32_16x16x32_bf16 v[236:239], v[164:167], v[60:63], v[236:239]
    ds_read_b64_tr_b16 v[132:133], v2 offset:160
    ds_read_b64_tr_b16 v[134:135], v2 offset:2464
    s_waitcnt lgkmcnt(15)
    v_mfma_f32_16x16x32_bf16 v[204:207], v[168:171], v[56:59], v[204:207]
    v_mfma_f32_16x16x32_bf16 v[240:243], v[168:171], v[60:63], v[240:243]
    ds_read_b64_tr_b16 v[136:137], v2 offset:192
    ds_read_b64_tr_b16 v[138:139], v2 offset:2496
    v_mfma_f32_16x16x32_bf16 v[208:211], v[172:175], v[56:59], v[208:211]
    v_mfma_f32_16x16x32_bf16 v[244:247], v[172:175], v[60:63], v[244:247]
    ds_read_b64_tr_b16 v[140:141], v2 offset:224
    ds_read_b64_tr_b16 v[142:143], v2 offset:2528
    s_waitcnt lgkmcnt(15)
    v_mfma_f32_16x16x32_bf16 v[212:215], v[176:179], v[56:59], v[212:215]
    v_mfma_f32_16x16x32_bf16 v[248:251], v[176:179], v[60:63], v[248:251]
    ds_read_b64_tr_b16 v[144:145], v2 offset:256
    ds_read_b64_tr_b16 v[146:147], v2 offset:2560
    v_mfma_f32_16x16x32_bf16 v[216:219], v[180:183], v[56:59], v[216:219]
    v_mfma_f32_16x16x32_bf16 v[252:255], v[180:183], v[60:63], v[252:255]
    s_waitcnt vmcnt(13)
    s_barrier
    ds_read_b64_tr_b16 v[148:149], v2 offset:9216
    ds_read_b64_tr_b16 v[150:151], v2 offset:11520
    s_waitcnt lgkmcnt(15)
    v_mfma_f32_16x16x32_bf16 v[184:187], v[112:115], v[64:67], v[184:187]
    s_add_u32 s57, s58, 13
    s_cmp_ge_u32 s57, 18
    s_cselect_b32 s59, 18, 0
    s_sub_u32 s57, s57, s59
    s_mul_i32 s57, s57, 73728
    s_add_u32 s49, s48, s57
    s_add_u32 m0, s47, 18432
    s_nop 0
    buffer_load_dwordx4 v3, s[12:15], s49 offen lds
    v_mfma_f32_16x16x32_bf16 v[220:223], v[112:115], v[68:71], v[220:223]
    ds_read_b64_tr_b16 v[152:153], v2 offset:9248
    ds_read_b64_tr_b16 v[154:155], v2 offset:11552
    v_mfma_f32_16x16x32_bf16 v[188:191], v[116:119], v[64:67], v[188:191]
    s_add_u32 m0, s47, 19456
    s_nop 0
    buffer_load_dwordx4 v4, s[12:15], s49 offen lds
    v_mfma_f32_16x16x32_bf16 v[224:227], v[116:119], v[68:71], v[224:227]
    ds_read_b64_tr_b16 v[156:157], v2 offset:9280
    ds_read_b64_tr_b16 v[158:159], v2 offset:11584
    s_waitcnt lgkmcnt(15)
    v_mfma_f32_16x16x32_bf16 v[192:195], v[120:123], v[64:67], v[192:195]
    s_add_u32 m0, s47, 20480
    s_nop 0
    buffer_load_dwordx4 v5, s[12:15], s49 offen lds
    v_mfma_f32_16x16x32_bf16 v[228:231], v[120:123], v[68:71], v[228:231]
    ds_read_b64_tr_b16 v[160:161], v2 offset:9312
    ds_read_b64_tr_b16 v[162:163], v2 offset:11616
    v_mfma_f32_16x16x32_bf16 v[196:199], v[124:127], v[64:67], v[196:199]
    s_add_u32 m0, s47, 21504
    s_nop 0
    buffer_load_dwordx4 v6, s[12:15], s49 offen lds
    v_mfma_f32_16x16x32_bf16 v[232:235], v[124:127], v[68:71], v[232:235]
    ds_read_b64_tr_b16 v[164:165], v2 offset:9344
    ds_read_b64_tr_b16 v[166:167], v2 offset:11648
    s_waitcnt lgkmcnt(15)
    v_mfma_f32_16x16x32_bf16 v[200:203], v[128:131], v[64:67], v[200:203]
    v_mfma_f32_16x16x32_bf16 v[236:239], v[128:131], v[68:71], v[236:239]
    s_mov_b32 exec_hi, 0
    s_add_u32 m0, s47, 22528
    s_nop 0
    buffer_load_dwordx4 v7, s[12:15], s49 offen lds
    s_mov_b32 exec_hi, -1
    ds_read_b64_tr_b16 v[168:169], v2 offset:9376
    ds_read_b64_tr_b16 v[170:171], v2 offset:11680
    v_mfma_f32_16x16x32_bf16 v[204:207], v[132:135], v[64:67], v[204:207]
    v_mfma_f32_16x16x32_bf16 v[240:243], v[132:135], v[68:71], v[240:243]
    s_add_u32 s56, s58, 12
    s_cmp_ge_u32 s56, 18
    s_cselect_b32 s59, 18, 0
    s_sub_u32 s56, s56, s59
    s_lshl_b32 s56, s56, 11
    s_add_u32 s56, s56, s41
    s_add_u32 s50, s56, 1024
    buffer_load_dwordx4 v[56:59], v8, s[8:11], s50 offen
    ds_read_b64_tr_b16 v[172:173], v2 offset:9408
    ds_read_b64_tr_b16 v[174:175], v2 offset:11712
    s_waitcnt lgkmcnt(15)
    v_mfma_f32_16x16x32_bf16 v[208:211], v[136:139], v[64:67], v[208:211]
    v_mfma_f32_16x16x32_bf16 v[244:247], v[136:139], v[68:71], v[244:247]
    s_add_u32 s50, s56, 148480
    buffer_load_dwordx4 v[60:63], v8, s[8:11], s50 offen
    ds_read_b64_tr_b16 v[176:177], v2 offset:9440
    ds_read_b64_tr_b16 v[178:179], v2 offset:11744
    v_mfma_f32_16x16x32_bf16 v[212:215], v[140:143], v[64:67], v[212:215]
    v_mfma_f32_16x16x32_bf16 v[248:251], v[140:143], v[68:71], v[248:251]
    ds_read_b64_tr_b16 v[180:181], v2 offset:9472
    ds_read_b64_tr_b16 v[182:183], v2 offset:11776
    s_waitcnt lgkmcnt(15)
    v_mfma_f32_16x16x32_bf16 v[216:219], v[144:147], v[64:67], v[216:219]
    v_mfma_f32_16x16x32_bf16 v[252:255], v[144:147], v[68:71], v[252:255]
    s_waitcnt vmcnt(18)
    ds_read_b64_tr_b16 v[112:113], v2 offset:18432
    ds_read_b64_tr_b16 v[114:115], v2 offset:20736
    v_mfma_f32_16x16x32_bf16 v[184:187], v[148:151], v[72:75], v[184:187]
    s_add_u32 s56, s58, 13
    s_cmp_ge_u32 s56, 18
    s_cselect_b32 s59, 18, 0
    s_sub_u32 s56, s56, s59
    s_lshl_b32 s56, s56, 11
    s_add_u32 s56, s56, s41
    s_add_u32 s50, s56, 0
    buffer_load_dwordx4 v[64:67], v8, s[8:11], s50 offen
    v_mfma_f32_16x16x32_bf16 v[220:223], v[148:151], v[76:79], v[220:223]
    ds_read_b64_tr_b16 v[116:117], v2 offset:18464
    ds_read_b64_tr_b16 v[118:119], v2 offset:20768
    s_waitcnt lgkmcnt(15)
    v_mfma_f32_16x16x32_bf16 v[188:191], v[152:155], v[72:75], v[188:191]
    v_mfma_f32_16x16x32_bf16 v[224:227], v[152:155], v[76:79], v[224:227]
    ds_read_b64_tr_b16 v[120:121], v2 offset:18496
    ds_read_b64_tr_b16 v[122:123], v2 offset:20800
    v_mfma_f32_16x16x32_bf16 v[192:195], v[156:159], v[72:75], v[192:195]
    v_mfma_f32_16x16x32_bf16 v[228:231], v[156:159], v[76:79], v[228:231]
    ds_read_b64_tr_b16 v[124:125], v2 offset:18528
    ds_read_b64_tr_b16 v[126:127], v2 offset:20832
    s_waitcnt lgkmcnt(15)
    v_mfma_f32_16x16x32_bf16 v[196:199], v[160:163], v[72:75], v[196:199]
    v_mfma_f32_16x16x32_bf16 v[232:235], v[160:163], v[76:79], v[232:235]
    ds_read_b64_tr_b16 v[128:129], v2 offset:18560
    ds_read_b64_tr_b16 v[130:131], v2 offset:20864
    v_mfma_f32_16x16x32_bf16 v[200:203], v[164:167], v[72:75], v[200:203]
    s_add_u32 s50, s56, 147456
    buffer_load_dwordx4 v[68:71], v8, s[8:11], s50 offen
    v_mfma_f32_16x16x32_bf16 v[236:239], v[164:167], v[76:79], v[236:239]
    ds_read_b64_tr_b16 v[132:133], v2 offset:18592
    ds_read_b64_tr_b16 v[134:135], v2 offset:20896
    s_waitcnt lgkmcnt(15)
    v_mfma_f32_16x16x32_bf16 v[204:207], v[168:171], v[72:75], v[204:207]
    v_mfma_f32_16x16x32_bf16 v[240:243], v[168:171], v[76:79], v[240:243]
    ds_read_b64_tr_b16 v[136:137], v2 offset:18624
    ds_read_b64_tr_b16 v[138:139], v2 offset:20928
    v_mfma_f32_16x16x32_bf16 v[208:211], v[172:175], v[72:75], v[208:211]
    v_mfma_f32_16x16x32_bf16 v[244:247], v[172:175], v[76:79], v[244:247]
    ds_read_b64_tr_b16 v[140:141], v2 offset:18656
    ds_read_b64_tr_b16 v[142:143], v2 offset:20960
    s_waitcnt lgkmcnt(15)
    v_mfma_f32_16x16x32_bf16 v[212:215], v[176:179], v[72:75], v[212:215]
    v_mfma_f32_16x16x32_bf16 v[248:251], v[176:179], v[76:79], v[248:251]
    ds_read_b64_tr_b16 v[144:145], v2 offset:18688
    ds_read_b64_tr_b16 v[146:147], v2 offset:20992
    v_mfma_f32_16x16x32_bf16 v[216:219], v[180:183], v[72:75], v[216:219]
    v_mfma_f32_16x16x32_bf16 v[252:255], v[180:183], v[76:79], v[252:255]
    s_waitcnt vmcnt(13)
    s_barrier
    s_lshl_b32 s70, s35, 2
    v_mov_b32 v13, 0
    buffer_load_dword v14, v13, s[24:27], s70 offen sc1
    ds_read_b64_tr_b16 v[148:149], v2 offset:27648
    ds_read_b64_tr_b16 v[150:151], v2 offset:29952
    s_waitcnt lgkmcnt(15)
    v_mfma_f32_16x16x32_bf16 v[184:187], v[112:115], v[80:83], v[184:187]
    s_add_u32 s57, s58, 14
    s_cmp_ge_u32 s57, 18
    s_cselect_b32 s59, 18, 0
    s_sub_u32 s57, s57, s59
    s_mul_i32 s57, s57, 73728
    s_add_u32 s49, s48, s57
    s_add_u32 m0, s47, 36864
    s_nop 0
    buffer_load_dwordx4 v3, s[12:15], s49 offen lds
    v_mfma_f32_16x16x32_bf16 v[220:223], v[112:115], v[84:87], v[220:223]
    ds_read_b64_tr_b16 v[152:153], v2 offset:27680
    ds_read_b64_tr_b16 v[154:155], v2 offset:29984
    v_mfma_f32_16x16x32_bf16 v[188:191], v[116:119], v[80:83], v[188:191]
    s_add_u32 m0, s47, 37888
    s_nop 0
    buffer_load_dwordx4 v4, s[12:15], s49 offen lds
    v_mfma_f32_16x16x32_bf16 v[224:227], v[116:119], v[84:87], v[224:227]
    ds_read_b64_tr_b16 v[156:157], v2 offset:27712
    ds_read_b64_tr_b16 v[158:159], v2 offset:30016
    s_waitcnt lgkmcnt(15)
    v_mfma_f32_16x16x32_bf16 v[192:195], v[120:123], v[80:83], v[192:195]
    s_add_u32 m0, s47, 38912
    s_nop 0
    buffer_load_dwordx4 v5, s[12:15], s49 offen lds
    v_mfma_f32_16x16x32_bf16 v[228:231], v[120:123], v[84:87], v[228:231]
    ds_read_b64_tr_b16 v[160:161], v2 offset:27744
    ds_read_b64_tr_b16 v[162:163], v2 offset:30048
    v_mfma_f32_16x16x32_bf16 v[196:199], v[124:127], v[80:83], v[196:199]
    s_add_u32 m0, s47, 39936
    s_nop 0
    buffer_load_dwordx4 v6, s[12:15], s49 offen lds
    v_mfma_f32_16x16x32_bf16 v[232:235], v[124:127], v[84:87], v[232:235]
    ds_read_b64_tr_b16 v[164:165], v2 offset:27776
    ds_read_b64_tr_b16 v[166:167], v2 offset:30080
    s_waitcnt lgkmcnt(15)
    v_mfma_f32_16x16x32_bf16 v[200:203], v[128:131], v[80:83], v[200:203]
    v_mfma_f32_16x16x32_bf16 v[236:239], v[128:131], v[84:87], v[236:239]
    s_mov_b32 exec_hi, 0
    s_add_u32 m0, s47, 40960
    s_nop 0
    buffer_load_dwordx4 v7, s[12:15], s49 offen lds
    s_mov_b32 exec_hi, -1
    ds_read_b64_tr_b16 v[168:169], v2 offset:27808
    ds_read_b64_tr_b16 v[170:171], v2 offset:30112
    v_mfma_f32_16x16x32_bf16 v[204:207], v[132:135], v[80:83], v[204:207]
    v_mfma_f32_16x16x32_bf16 v[240:243], v[132:135], v[84:87], v[240:243]
    s_add_u32 s56, s58, 13
    s_cmp_ge_u32 s56, 18
    s_cselect_b32 s59, 18, 0
    s_sub_u32 s56, s56, s59
    s_lshl_b32 s56, s56, 11
    s_add_u32 s56, s56, s41
    s_add_u32 s50, s56, 1024
    buffer_load_dwordx4 v[72:75], v8, s[8:11], s50 offen
    ds_read_b64_tr_b16 v[172:173], v2 offset:27840
    ds_read_b64_tr_b16 v[174:175], v2 offset:30144
    s_waitcnt lgkmcnt(15)
    v_mfma_f32_16x16x32_bf16 v[208:211], v[136:139], v[80:83], v[208:211]
    v_mfma_f32_16x16x32_bf16 v[244:247], v[136:139], v[84:87], v[244:247]
    s_add_u32 s50, s56, 148480
    buffer_load_dwordx4 v[76:79], v8, s[8:11], s50 offen
    ds_read_b64_tr_b16 v[176:177], v2 offset:27872
    ds_read_b64_tr_b16 v[178:179], v2 offset:30176
    v_mfma_f32_16x16x32_bf16 v[212:215], v[140:143], v[80:83], v[212:215]
    v_mfma_f32_16x16x32_bf16 v[248:251], v[140:143], v[84:87], v[248:251]
    ds_read_b64_tr_b16 v[180:181], v2 offset:27904
    ds_read_b64_tr_b16 v[182:183], v2 offset:30208
    s_waitcnt lgkmcnt(15)
    v_mfma_f32_16x16x32_bf16 v[216:219], v[144:147], v[80:83], v[216:219]
    v_mfma_f32_16x16x32_bf16 v[252:255], v[144:147], v[84:87], v[252:255]
    s_waitcnt vmcnt(19)
    ds_read_b64_tr_b16 v[112:113], v1 offset:0
    ds_read_b64_tr_b16 v[114:115], v1 offset:2304
    v_mfma_f32_16x16x32_bf16 v[184:187], v[148:151], v[88:91], v[184:187]
    s_add_u32 s56, s58, 14
    s_cmp_ge_u32 s56, 18
    s_cselect_b32 s59, 18, 0
    s_sub_u32 s56, s56, s59
    s_lshl_b32 s56, s56, 11
    s_add_u32 s56, s56, s41
    s_add_u32 s50, s56, 0
    buffer_load_dwordx4 v[80:83], v8, s[8:11], s50 offen
    v_mfma_f32_16x16x32_bf16 v[220:223], v[148:151], v[92:95], v[220:223]
    ds_read_b64_tr_b16 v[116:117], v1 offset:32
    ds_read_b64_tr_b16 v[118:119], v1 offset:2336
    s_waitcnt lgkmcnt(15)
    v_mfma_f32_16x16x32_bf16 v[188:191], v[152:155], v[88:91], v[188:191]
    v_mfma_f32_16x16x32_bf16 v[224:227], v[152:155], v[92:95], v[224:227]
    ds_read_b64_tr_b16 v[120:121], v1 offset:64
    ds_read_b64_tr_b16 v[122:123], v1 offset:2368
    v_mfma_f32_16x16x32_bf16 v[192:195], v[156:159], v[88:91], v[192:195]
    v_mfma_f32_16x16x32_bf16 v[228:231], v[156:159], v[92:95], v[228:231]
    ds_read_b64_tr_b16 v[124:125], v1 offset:96
    ds_read_b64_tr_b16 v[126:127], v1 offset:2400
    s_waitcnt lgkmcnt(15)
    v_mfma_f32_16x16x32_bf16 v[196:199], v[160:163], v[88:91], v[196:199]
    v_mfma_f32_16x16x32_bf16 v[232:235], v[160:163], v[92:95], v[232:235]
    ds_read_b64_tr_b16 v[128:129], v1 offset:128
    ds_read_b64_tr_b16 v[130:131], v1 offset:2432
    v_mfma_f32_16x16x32_bf16 v[200:203], v[164:167], v[88:91], v[200:203]
    s_add_u32 s50, s56, 147456
    buffer_load_dwordx4 v[84:87], v8, s[8:11], s50 offen
    v_mfma_f32_16x16x32_bf16 v[236:239], v[164:167], v[92:95], v[236:239]
    ds_read_b64_tr_b16 v[132:133], v1 offset:160
    ds_read_b64_tr_b16 v[134:135], v1 offset:2464
    s_waitcnt lgkmcnt(15)
    v_mfma_f32_16x16x32_bf16 v[204:207], v[168:171], v[88:91], v[204:207]
    v_mfma_f32_16x16x32_bf16 v[240:243], v[168:171], v[92:95], v[240:243]
    ds_read_b64_tr_b16 v[136:137], v1 offset:192
    ds_read_b64_tr_b16 v[138:139], v1 offset:2496
    v_mfma_f32_16x16x32_bf16 v[208:211], v[172:175], v[88:91], v[208:211]
    v_mfma_f32_16x16x32_bf16 v[244:247], v[172:175], v[92:95], v[244:247]
    ds_read_b64_tr_b16 v[140:141], v1 offset:224
    ds_read_b64_tr_b16 v[142:143], v1 offset:2528
    s_waitcnt lgkmcnt(15)
    v_mfma_f32_16x16x32_bf16 v[212:215], v[176:179], v[88:91], v[212:215]
    v_mfma_f32_16x16x32_bf16 v[248:251], v[176:179], v[92:95], v[248:251]
    ds_read_b64_tr_b16 v[144:145], v1 offset:256
    ds_read_b64_tr_b16 v[146:147], v1 offset:2560
    v_mfma_f32_16x16x32_bf16 v[216:219], v[180:183], v[88:91], v[216:219]
    v_mfma_f32_16x16x32_bf16 v[252:255], v[180:183], v[92:95], v[252:255]
    s_waitcnt vmcnt(14)
    s_barrier
    ds_read_b64_tr_b16 v[148:149], v1 offset:9216
    ds_read_b64_tr_b16 v[150:151], v1 offset:11520
    s_waitcnt lgkmcnt(15)
    v_mfma_f32_16x16x32_bf16 v[184:187], v[112:115], v[48:51], v[184:187]
    s_add_u32 s57, s58, 15
    s_cmp_ge_u32 s57, 18
    s_cselect_b32 s59, 18, 0
    s_sub_u32 s57, s57, s59
    s_mul_i32 s57, s57, 73728
    s_add_u32 s49, s48, s57
    s_add_u32 m0, s47, 55296
    s_nop 0
    buffer_load_dwordx4 v3, s[12:15], s49 offen lds
    v_mfma_f32_16x16x32_bf16 v[220:223], v[112:115], v[52:55], v[220:223]
    ds_read_b64_tr_b16 v[152:153], v1 offset:9248
    ds_read_b64_tr_b16 v[154:155], v1 offset:11552
    v_mfma_f32_16x16x32_bf16 v[188:191], v[116:119], v[48:51], v[188:191]
    s_add_u32 m0, s47, 56320
    s_nop 0
    buffer_load_dwordx4 v4, s[12:15], s49 offen lds
    v_mfma_f32_16x16x32_bf16 v[224:227], v[116:119], v[52:55], v[224:227]
    ds_read_b64_tr_b16 v[156:157], v1 offset:9280
    ds_read_b64_tr_b16 v[158:159], v1 offset:11584
    s_waitcnt lgkmcnt(15)
    v_mfma_f32_16x16x32_bf16 v[192:195], v[120:123], v[48:51], v[192:195]
    s_add_u32 m0, s47, 57344
    s_nop 0
    buffer_load_dwordx4 v5, s[12:15], s49 offen lds
    v_mfma_f32_16x16x32_bf16 v[228:231], v[120:123], v[52:55], v[228:231]
    ds_read_b64_tr_b16 v[160:161], v1 offset:9312
    ds_read_b64_tr_b16 v[162:163], v1 offset:11616
    v_mfma_f32_16x16x32_bf16 v[196:199], v[124:127], v[48:51], v[196:199]
    s_add_u32 m0, s47, 58368
    s_nop 0
    buffer_load_dwordx4 v6, s[12:15], s49 offen lds
    v_mfma_f32_16x16x32_bf16 v[232:235], v[124:127], v[52:55], v[232:235]
    ds_read_b64_tr_b16 v[164:165], v1 offset:9344
    ds_read_b64_tr_b16 v[166:167], v1 offset:11648
    s_waitcnt lgkmcnt(15)
    v_mfma_f32_16x16x32_bf16 v[200:203], v[128:131], v[48:51], v[200:203]
    v_mfma_f32_16x16x32_bf16 v[236:239], v[128:131], v[52:55], v[236:239]
    s_mov_b32 exec_hi, 0
    s_add_u32 m0, s47, 59392
    s_nop 0
    buffer_load_dwordx4 v7, s[12:15], s49 offen lds
    s_mov_b32 exec_hi, -1
    ds_read_b64_tr_b16 v[168:169], v1 offset:9376
    ds_read_b64_tr_b16 v[170:171], v1 offset:11680
    v_mfma_f32_16x16x32_bf16 v[204:207], v[132:135], v[48:51], v[204:207]
    v_mfma_f32_16x16x32_bf16 v[240:243], v[132:135], v[52:55], v[240:243]
    s_add_u32 s56, s58, 14
    s_cmp_ge_u32 s56, 18
    s_cselect_b32 s59, 18, 0
    s_sub_u32 s56, s56, s59
    s_lshl_b32 s56, s56, 11
    s_add_u32 s56, s56, s41
    s_add_u32 s50, s56, 1024
    buffer_load_dwordx4 v[88:91], v8, s[8:11], s50 offen
    ds_read_b64_tr_b16 v[172:173], v1 offset:9408
    ds_read_b64_tr_b16 v[174:175], v1 offset:11712
    s_waitcnt lgkmcnt(15)
    v_mfma_f32_16x16x32_bf16 v[208:211], v[136:139], v[48:51], v[208:211]
    v_mfma_f32_16x16x32_bf16 v[244:247], v[136:139], v[52:55], v[244:247]
    s_add_u32 s50, s56, 148480
    buffer_load_dwordx4 v[92:95], v8, s[8:11], s50 offen
    ds_read_b64_tr_b16 v[176:177], v1 offset:9440
    ds_read_b64_tr_b16 v[178:179], v1 offset:11744
    v_mfma_f32_16x16x32_bf16 v[212:215], v[140:143], v[48:51], v[212:215]
    v_mfma_f32_16x16x32_bf16 v[248:251], v[140:143], v[52:55], v[248:251]
    ds_read_b64_tr_b16 v[180:181], v1 offset:9472
    ds_read_b64_tr_b16 v[182:183], v1 offset:11776
    s_waitcnt lgkmcnt(15)
    v_mfma_f32_16x16x32_bf16 v[216:219], v[144:147], v[48:51], v[216:219]
    v_mfma_f32_16x16x32_bf16 v[252:255], v[144:147], v[52:55], v[252:255]
    s_waitcnt vmcnt(19)
    ds_read_b64_tr_b16 v[112:113], v1 offset:18432
    ds_read_b64_tr_b16 v[114:115], v1 offset:20736
    v_mfma_f32_16x16x32_bf16 v[184:187], v[148:151], v[56:59], v[184:187]
    s_add_u32 s56, s58, 15
    s_cmp_ge_u32 s56, 18
    s_cselect_b32 s59, 18, 0
    s_sub_u32 s56, s56, s59
    s_lshl_b32 s56, s56, 11
    s_add_u32 s56, s56, s41
    s_add_u32 s50, s56, 0
    buffer_load_dwordx4 v[48:51], v8, s[8:11], s50 offen
    v_mfma_f32_16x16x32_bf16 v[220:223], v[148:151], v[60:63], v[220:223]
    ds_read_b64_tr_b16 v[116:117], v1 offset:18464
    ds_read_b64_tr_b16 v[118:119], v1 offset:20768
    s_waitcnt lgkmcnt(15)
    v_mfma_f32_16x16x32_bf16 v[188:191], v[152:155], v[56:59], v[188:191]
    v_mfma_f32_16x16x32_bf16 v[224:227], v[152:155], v[60:63], v[224:227]
    ds_read_b64_tr_b16 v[120:121], v1 offset:18496
    ds_read_b64_tr_b16 v[122:123], v1 offset:20800
    v_mfma_f32_16x16x32_bf16 v[192:195], v[156:159], v[56:59], v[192:195]
    v_mfma_f32_16x16x32_bf16 v[228:231], v[156:159], v[60:63], v[228:231]
    ds_read_b64_tr_b16 v[124:125], v1 offset:18528
    ds_read_b64_tr_b16 v[126:127], v1 offset:20832
    s_waitcnt lgkmcnt(15)
    v_mfma_f32_16x16x32_bf16 v[196:199], v[160:163], v[56:59], v[196:199]
    v_mfma_f32_16x16x32_bf16 v[232:235], v[160:163], v[60:63], v[232:235]
    ds_read_b64_tr_b16 v[128:129], v1 offset:18560
    ds_read_b64_tr_b16 v[130:131], v1 offset:20864
    v_mfma_f32_16x16x32_bf16 v[200:203], v[164:167], v[56:59], v[200:203]
    s_add_u32 s50, s56, 147456
    buffer_load_dwordx4 v[52:55], v8, s[8:11], s50 offen
    v_mfma_f32_16x16x32_bf16 v[236:239], v[164:167], v[60:63], v[236:239]
    ds_read_b64_tr_b16 v[132:133], v1 offset:18592
    ds_read_b64_tr_b16 v[134:135], v1 offset:20896
    s_waitcnt lgkmcnt(15)
    v_mfma_f32_16x16x32_bf16 v[204:207], v[168:171], v[56:59], v[204:207]
    v_mfma_f32_16x16x32_bf16 v[240:243], v[168:171], v[60:63], v[240:243]
    ds_read_b64_tr_b16 v[136:137], v1 offset:18624
    ds_read_b64_tr_b16 v[138:139], v1 offset:20928
    v_mfma_f32_16x16x32_bf16 v[208:211], v[172:175], v[56:59], v[208:211]
    v_mfma_f32_16x16x32_bf16 v[244:247], v[172:175], v[60:63], v[244:247]
    ds_read_b64_tr_b16 v[140:141], v1 offset:18656
    ds_read_b64_tr_b16 v[142:143], v1 offset:20960
    s_waitcnt lgkmcnt(15)
    v_mfma_f32_16x16x32_bf16 v[212:215], v[176:179], v[56:59], v[212:215]
    v_mfma_f32_16x16x32_bf16 v[248:251], v[176:179], v[60:63], v[248:251]
    ds_read_b64_tr_b16 v[144:145], v1 offset:18688
    ds_read_b64_tr_b16 v[146:147], v1 offset:20992
    v_mfma_f32_16x16x32_bf16 v[216:219], v[180:183], v[56:59], v[216:219]
    v_mfma_f32_16x16x32_bf16 v[252:255], v[180:183], v[60:63], v[252:255]
    s_waitcnt vmcnt(13)
    s_barrier
    ds_read_b64_tr_b16 v[148:149], v1 offset:27648
    ds_read_b64_tr_b16 v[150:151], v1 offset:29952
    s_waitcnt lgkmcnt(15)
    v_mfma_f32_16x16x32_bf16 v[184:187], v[112:115], v[64:67], v[184:187]
    s_add_u32 s57, s58, 16
    s_cmp_ge_u32 s57, 18
    s_cselect_b32 s59, 18, 0
    s_sub_u32 s57, s57, s59
    s_mul_i32 s57, s57, 73728
    s_add_u32 s49, s48, s57
    s_add_u32 m0, s47, 0
    s_nop 0
    buffer_load_dwordx4 v3, s[12:15], s49 offen lds
    v_mfma_f32_16x16x32_bf16 v[220:223], v[112:115], v[68:71], v[220:223]
    ds_read_b64_tr_b16 v[152:153], v1 offset:27680
    ds_read_b64_tr_b16 v[154:155], v1 offset:29984
    v_mfma_f32_16x16x32_bf16 v[188:191], v[116:119], v[64:67], v[188:191]
    s_add_u32 m0, s47, 1024
    s_nop 0
    buffer_load_dwordx4 v4, s[12:15], s49 offen lds
    v_mfma_f32_16x16x32_bf16 v[224:227], v[116:119], v[68:71], v[224:227]
    ds_read_b64_tr_b16 v[156:157], v1 offset:27712
    ds_read_b64_tr_b16 v[158:159], v1 offset:30016
    s_waitcnt lgkmcnt(15)
    v_mfma_f32_16x16x32_bf16 v[192:195], v[120:123], v[64:67], v[192:195]
    s_add_u32 m0, s47, 2048
    s_nop 0
    buffer_load_dwordx4 v5, s[12:15], s49 offen lds
    v_mfma_f32_16x16x32_bf16 v[228:231], v[120:123], v[68:71], v[228:231]
    ds_read_b64_tr_b16 v[160:161], v1 offset:27744
    ds_read_b64_tr_b16 v[162:163], v1 offset:30048
    v_mfma_f32_16x16x32_bf16 v[196:199], v[124:127], v[64:67], v[196:199]
    s_add_u32 m0, s47, 3072
    s_nop 0
    buffer_load_dwordx4 v6, s[12:15], s49 offen lds
    v_mfma_f32_16x16x32_bf16 v[232:235], v[124:127], v[68:71], v[232:235]
    ds_read_b64_tr_b16 v[164:165], v1 offset:27776
    ds_read_b64_tr_b16 v[166:167], v1 offset:30080
    s_waitcnt lgkmcnt(15)
    v_mfma_f32_16x16x32_bf16 v[200:203], v[128:131], v[64:67], v[200:203]
    v_mfma_f32_16x16x32_bf16 v[236:239], v[128:131], v[68:71], v[236:239]
    s_mov_b32 exec_hi, 0
    s_add_u32 m0, s47, 4096
    s_nop 0
    buffer_load_dwordx4 v7, s[12:15], s49 offen lds
    s_mov_b32 exec_hi, -1
    ds_read_b64_tr_b16 v[168:169], v1 offset:27808
    ds_read_b64_tr_b16 v[170:171], v1 offset:30112
    v_mfma_f32_16x16x32_bf16 v[204:207], v[132:135], v[64:67], v[204:207]
    v_mfma_f32_16x16x32_bf16 v[240:243], v[132:135], v[68:71], v[240:243]
    s_add_u32 s56, s58, 15
    s_cmp_ge_u32 s56, 18
    s_cselect_b32 s59, 18, 0
    s_sub_u32 s56, s56, s59
    s_lshl_b32 s56, s56, 11
    s_add_u32 s56, s56, s41
    s_add_u32 s50, s56, 1024
    buffer_load_dwordx4 v[56:59], v8, s[8:11], s50 offen
    ds_read_b64_tr_b16 v[172:173], v1 offset:27840
    ds_read_b64_tr_b16 v[174:175], v1 offset:30144
    s_waitcnt lgkmcnt(15)
    v_mfma_f32_16x16x32_bf16 v[208:211], v[136:139], v[64:67], v[208:211]
    v_mfma_f32_16x16x32_bf16 v[244:247], v[136:139], v[68:71], v[244:247]
    s_add_u32 s50, s56, 148480
    buffer_load_dwordx4 v[60:63], v8, s[8:11], s50 offen
    ds_read_b64_tr_b16 v[176:177], v1 offset:27872
    ds_read_b64_tr_b16 v[178:179], v1 offset:30176
    v_mfma_f32_16x16x32_bf16 v[212:215], v[140:143], v[64:67], v[212:215]
    v_mfma_f32_16x16x32_bf16 v[248:251], v[140:143], v[68:71], v[248:251]
    ds_read_b64_tr_b16 v[180:181], v1 offset:27904
    ds_read_b64_tr_b16 v[182:183], v1 offset:30208
    s_waitcnt lgkmcnt(15)
    v_mfma_f32_16x16x32_bf16 v[216:219], v[144:147], v[64:67], v[216:219]
    v_mfma_f32_16x16x32_bf16 v[252:255], v[144:147], v[68:71], v[252:255]
    s_waitcnt vmcnt(18)
    ds_read_b64_tr_b16 v[112:113], v2 offset:0
    ds_read_b64_tr_b16 v[114:115], v2 offset:2304
    v_mfma_f32_16x16x32_bf16 v[184:187], v[148:151], v[72:75], v[184:187]
    s_add_u32 s56, s58, 16
    s_cmp_ge_u32 s56, 18
    s_cselect_b32 s59, 18, 0
    s_sub_u32 s56, s56, s59
    s_lshl_b32 s56, s56, 11
    s_add_u32 s56, s56, s41
    s_add_u32 s50, s56, 0
    buffer_load_dwordx4 v[64:67], v8, s[8:11], s50 offen
    v_mfma_f32_16x16x32_bf16 v[220:223], v[148:151], v[76:79], v[220:223]
    ds_read_b64_tr_b16 v[116:117], v2 offset:32
    ds_read_b64_tr_b16 v[118:119], v2 offset:2336
    s_waitcnt lgkmcnt(15)
    v_mfma_f32_16x16x32_bf16 v[188:191], v[152:155], v[72:75], v[188:191]
    v_mfma_f32_16x16x32_bf16 v[224:227], v[152:155], v[76:79], v[224:227]
    ds_read_b64_tr_b16 v[120:121], v2 offset:64
    ds_read_b64_tr_b16 v[122:123], v2 offset:2368
    v_mfma_f32_16x16x32_bf16 v[192:195], v[156:159], v[72:75], v[192:195]
    v_mfma_f32_16x16x32_bf16 v[228:231], v[156:159], v[76:79], v[228:231]
    ds_read_b64_tr_b16 v[124:125], v2 offset:96
    ds_read_b64_tr_b16 v[126:127], v2 offset:2400
    s_waitcnt lgkmcnt(15)
    v_mfma_f32_16x16x32_bf16 v[196:199], v[160:163], v[72:75], v[196:199]
    v_mfma_f32_16x16x32_bf16 v[232:235], v[160:163], v[76:79], v[232:235]
    ds_read_b64_tr_b16 v[128:129], v2 offset:128
    ds_read_b64_tr_b16 v[130:131], v2 offset:2432
    v_mfma_f32_16x16x32_bf16 v[200:203], v[164:167], v[72:75], v[200:203]
    s_add_u32 s50, s56, 147456
    buffer_load_dwordx4 v[68:71], v8, s[8:11], s50 offen
    v_mfma_f32_16x16x32_bf16 v[236:239], v[164:167], v[76:79], v[236:239]
    ds_read_b64_tr_b16 v[132:133], v2 offset:160
    ds_read_b64_tr_b16 v[134:135], v2 offset:2464
    s_waitcnt lgkmcnt(15)
    v_mfma_f32_16x16x32_bf16 v[204:207], v[168:171], v[72:75], v[204:207]
    v_mfma_f32_16x16x32_bf16 v[240:243], v[168:171], v[76:79], v[240:243]
    ds_read_b64_tr_b16 v[136:137], v2 offset:192
    ds_read_b64_tr_b16 v[138:139], v2 offset:2496
    v_mfma_f32_16x16x32_bf16 v[208:211], v[172:175], v[72:75], v[208:211]
    v_mfma_f32_16x16x32_bf16 v[244:247], v[172:175], v[76:79], v[244:247]
    ds_read_b64_tr_b16 v[140:141], v2 offset:224
    ds_read_b64_tr_b16 v[142:143], v2 offset:2528
    s_waitcnt lgkmcnt(15)
    v_mfma_f32_16x16x32_bf16 v[212:215], v[176:179], v[72:75], v[212:215]
    v_mfma_f32_16x16x32_bf16 v[248:251], v[176:179], v[76:79], v[248:251]
    ds_read_b64_tr_b16 v[144:145], v2 offset:256
    ds_read_b64_tr_b16 v[146:147], v2 offset:2560
    v_mfma_f32_16x16x32_bf16 v[216:219], v[180:183], v[72:75], v[216:219]
    v_mfma_f32_16x16x32_bf16 v[252:255], v[180:183], v[76:79], v[252:255]
    s_waitcnt vmcnt(13)
    s_barrier
    ds_read_b64_tr_b16 v[148:149], v2 offset:9216
    ds_read_b64_tr_b16 v[150:151], v2 offset:11520
    s_waitcnt lgkmcnt(15)
    v_mfma_f32_16x16x32_bf16 v[184:187], v[112:115], v[80:83], v[184:187]
    s_add_u32 s57, s58, 17
    s_cmp_ge_u32 s57, 18
    s_cselect_b32 s59, 18, 0
    s_sub_u32 s57, s57, s59
    s_mul_i32 s57, s57, 73728
    s_add_u32 s49, s48, s57
    s_add_u32 m0, s47, 18432
    s_nop 0
    buffer_load_dwordx4 v3, s[12:15], s49 offen lds
    v_mfma_f32_16x16x32_bf16 v[220:223], v[112:115], v[84:87], v[220:223]
    ds_read_b64_tr_b16 v[152:153], v2 offset:9248
    ds_read_b64_tr_b16 v[154:155], v2 offset:11552
    v_mfma_f32_16x16x32_bf16 v[188:191], v[116:119], v[80:83], v[188:191]
    s_add_u32 m0, s47, 19456
    s_nop 0
    buffer_load_dwordx4 v4, s[12:15], s49 offen lds
    v_mfma_f32_16x16x32_bf16 v[224:227], v[116:119], v[84:87], v[224:227]
    ds_read_b64_tr_b16 v[156:157], v2 offset:9280
    ds_read_b64_tr_b16 v[158:159], v2 offset:11584
    s_waitcnt lgkmcnt(15)
    v_mfma_f32_16x16x32_bf16 v[192:195], v[120:123], v[80:83], v[192:195]
    s_add_u32 m0, s47, 20480
    s_nop 0
    buffer_load_dwordx4 v5, s[12:15], s49 offen lds
    v_mfma_f32_16x16x32_bf16 v[228:231], v[120:123], v[84:87], v[228:231]
    ds_read_b64_tr_b16 v[160:161], v2 offset:9312
    ds_read_b64_tr_b16 v[162:163], v2 offset:11616
    v_mfma_f32_16x16x32_bf16 v[196:199], v[124:127], v[80:83], v[196:199]
    s_add_u32 m0, s47, 21504
    s_nop 0
    buffer_load_dwordx4 v6, s[12:15], s49 offen lds
    v_mfma_f32_16x16x32_bf16 v[232:235], v[124:127], v[84:87], v[232:235]
    ds_read_b64_tr_b16 v[164:165], v2 offset:9344
    ds_read_b64_tr_b16 v[166:167], v2 offset:11648
    s_waitcnt lgkmcnt(15)
    v_mfma_f32_16x16x32_bf16 v[200:203], v[128:131], v[80:83], v[200:203]
    v_mfma_f32_16x16x32_bf16 v[236:239], v[128:131], v[84:87], v[236:239]
    s_mov_b32 exec_hi, 0
    s_add_u32 m0, s47, 22528
    s_nop 0
    buffer_load_dwordx4 v7, s[12:15], s49 offen lds
    s_mov_b32 exec_hi, -1
    ds_read_b64_tr_b16 v[168:169], v2 offset:9376
    ds_read_b64_tr_b16 v[170:171], v2 offset:11680
    v_mfma_f32_16x16x32_bf16 v[204:207], v[132:135], v[80:83], v[204:207]
    v_mfma_f32_16x16x32_bf16 v[240:243], v[132:135], v[84:87], v[240:243]
    s_add_u32 s56, s58, 16
    s_cmp_ge_u32 s56, 18
    s_cselect_b32 s59, 18, 0
    s_sub_u32 s56, s56, s59
    s_lshl_b32 s56, s56, 11
    s_add_u32 s56, s56, s41
    s_add_u32 s50, s56, 1024
    buffer_load_dwordx4 v[72:75], v8, s[8:11], s50 offen
    ds_read_b64_tr_b16 v[172:173], v2 offset:9408
    ds_read_b64_tr_b16 v[174:175], v2 offset:11712
    s_waitcnt lgkmcnt(15)
    v_mfma_f32_16x16x32_bf16 v[208:211], v[136:139], v[80:83], v[208:211]
    v_mfma_f32_16x16x32_bf16 v[244:247], v[136:139], v[84:87], v[244:247]
    s_add_u32 s50, s56, 148480
    buffer_load_dwordx4 v[76:79], v8, s[8:11], s50 offen
    ds_read_b64_tr_b16 v[176:177], v2 offset:9440
    ds_read_b64_tr_b16 v[178:179], v2 offset:11744
    v_mfma_f32_16x16x32_bf16 v[212:215], v[140:143], v[80:83], v[212:215]
    v_mfma_f32_16x16x32_bf16 v[248:251], v[140:143], v[84:87], v[248:251]
    ds_read_b64_tr_b16 v[180:181], v2 offset:9472
    ds_read_b64_tr_b16 v[182:183], v2 offset:11776
    s_waitcnt lgkmcnt(15)
    v_mfma_f32_16x16x32_bf16 v[216:219], v[144:147], v[80:83], v[216:219]
    v_mfma_f32_16x16x32_bf16 v[252:255], v[144:147], v[84:87], v[252:255]
    s_waitcnt vmcnt(18)
    ds_read_b64_tr_b16 v[112:113], v2 offset:18432
    ds_read_b64_tr_b16 v[114:115], v2 offset:20736
    v_mfma_f32_16x16x32_bf16 v[184:187], v[148:151], v[88:91], v[184:187]
    s_add_u32 s56, s58, 17
    s_cmp_ge_u32 s56, 18
    s_cselect_b32 s59, 18, 0
    s_sub_u32 s56, s56, s59
    s_lshl_b32 s56, s56, 11
    s_add_u32 s56, s56, s41
    s_add_u32 s50, s56, 0
    buffer_load_dwordx4 v[80:83], v8, s[8:11], s50 offen
    v_mfma_f32_16x16x32_bf16 v[220:223], v[148:151], v[92:95], v[220:223]
    ds_read_b64_tr_b16 v[116:117], v2 offset:18464
    ds_read_b64_tr_b16 v[118:119], v2 offset:20768
    s_waitcnt lgkmcnt(15)
    v_mfma_f32_16x16x32_bf16 v[188:191], v[152:155], v[88:91], v[188:191]
    v_mfma_f32_16x16x32_bf16 v[224:227], v[152:155], v[92:95], v[224:227]
    ds_read_b64_tr_b16 v[120:121], v2 offset:18496
    ds_read_b64_tr_b16 v[122:123], v2 offset:20800
    v_mfma_f32_16x16x32_bf16 v[192:195], v[156:159], v[88:91], v[192:195]
    v_mfma_f32_16x16x32_bf16 v[228:231], v[156:159], v[92:95], v[228:231]
    ds_read_b64_tr_b16 v[124:125], v2 offset:18528
    ds_read_b64_tr_b16 v[126:127], v2 offset:20832
    s_waitcnt lgkmcnt(15)
    v_mfma_f32_16x16x32_bf16 v[196:199], v[160:163], v[88:91], v[196:199]
    v_mfma_f32_16x16x32_bf16 v[232:235], v[160:163], v[92:95], v[232:235]
    ds_read_b64_tr_b16 v[128:129], v2 offset:18560
    ds_read_b64_tr_b16 v[130:131], v2 offset:20864
    v_mfma_f32_16x16x32_bf16 v[200:203], v[164:167], v[88:91], v[200:203]
    s_add_u32 s50, s56, 147456
    buffer_load_dwordx4 v[84:87], v8, s[8:11], s50 offen
    v_mfma_f32_16x16x32_bf16 v[236:239], v[164:167], v[92:95], v[236:239]
    ds_read_b64_tr_b16 v[132:133], v2 offset:18592
    ds_read_b64_tr_b16 v[134:135], v2 offset:20896
    s_waitcnt lgkmcnt(15)
    v_mfma_f32_16x16x32_bf16 v[204:207], v[168:171], v[88:91], v[204:207]
    v_mfma_f32_16x16x32_bf16 v[240:243], v[168:171], v[92:95], v[240:243]
    ds_read_b64_tr_b16 v[136:137], v2 offset:18624
    ds_read_b64_tr_b16 v[138:139], v2 offset:20928
    v_mfma_f32_16x16x32_bf16 v[208:211], v[172:175], v[88:91], v[208:211]
    v_mfma_f32_16x16x32_bf16 v[244:247], v[172:175], v[92:95], v[244:247]
    ds_read_b64_tr_b16 v[140:141], v2 offset:18656
    ds_read_b64_tr_b16 v[142:143], v2 offset:20960
    s_waitcnt lgkmcnt(15)
    v_mfma_f32_16x16x32_bf16 v[212:215], v[176:179], v[88:91], v[212:215]
    v_mfma_f32_16x16x32_bf16 v[248:251], v[176:179], v[92:95], v[248:251]
    ds_read_b64_tr_b16 v[144:145], v2 offset:18688
    ds_read_b64_tr_b16 v[146:147], v2 offset:20992
    v_mfma_f32_16x16x32_bf16 v[216:219], v[180:183], v[88:91], v[216:219]
    v_mfma_f32_16x16x32_bf16 v[252:255], v[180:183], v[92:95], v[252:255]
    s_waitcnt vmcnt(13)
    s_barrier
    ds_read_b64_tr_b16 v[148:149], v2 offset:27648
    ds_read_b64_tr_b16 v[150:151], v2 offset:29952
    s_waitcnt lgkmcnt(15)
    v_mfma_f32_16x16x32_bf16 v[184:187], v[112:115], v[48:51], v[184:187]
    s_mov_b32 s12, s64
    s_mov_b32 s13, s65
    s_mov_b32 s14, 1327104
    v_lshrrev_b32 v9, 4, v8
    v_add_u32 v9, s46, v9
    v_lshrrev_b32 v10, 6, v9
    v_and_b32 v9, 63, v9
    v_cmp_le_u32 vcc, 9, v10
    v_subrev_u32 v11, 9, v10
    s_nop 0
    v_cndmask_b32 v10, v10, v11, vcc
    v_cndmask_b32 v11, 0, 1, vcc
    v_mul_u32_u24 v10, 36, v10
    v_add_u32 v10, v10, v11
    v_lshlrev_b32 v10, 10, v10
    v_lshl_add_u32 v3, v9, 4, v10
    s_add_u32 s49, s66, 0
    s_add_u32 m0, s47, 36864
    s_nop 0
    buffer_load_dwordx4 v3, s[12:15], s49 offen lds
    v_mfma_f32_16x16x32_bf16 v[220:223], v[112:115], v[52:55], v[220:223]
    ds_read_b64_tr_b16 v[152:153], v2 offset:27680
    ds_read_b64_tr_b16 v[154:155], v2 offset:29984
    v_mfma_f32_16x16x32_bf16 v[188:191], v[116:119], v[48:51], v[188:191]
    v_lshrrev_b32 v9, 4, v8
    v_add_u32 v9, s46, v9
    v_add_u32 v9, 64, v9
    v_lshrrev_b32 v10, 6, v9
    v_and_b32 v9, 63, v9
    v_cmp_le_u32 vcc, 9, v10
    v_subrev_u32 v11, 9, v10
    s_nop 0
    v_cndmask_b32 v10, v10, v11, vcc
    v_cndmask_b32 v11, 0, 1, vcc
    v_mul_u32_u24 v10, 36, v10
    v_add_u32 v10, v10, v11
    v_lshlrev_b32 v10, 10, v10
    v_lshl_add_u32 v4, v9, 4, v10
    s_add_u32 m0, s47, 37888
    s_nop 0
    buffer_load_dwordx4 v4, s[12:15], s49 offen lds
    v_mfma_f32_16x16x32_bf16 v[224:227], v[116:119], v[52:55], v[224:227]
    ds_read_b64_tr_b16 v[156:157], v2 offset:27712
    ds_read_b64_tr_b16 v[158:159], v2 offset:30016
    s_waitcnt lgkmcnt(15)
    v_mfma_f32_16x16x32_bf16 v[192:195], v[120:123], v[48:51], v[192:195]
    v_lshrrev_b32 v9, 4, v8
    v_add_u32 v9, s46, v9
    v_add_u32 v9, 128, v9
    v_lshrrev_b32 v10, 6, v9
    v_and_b32 v9, 63, v9
    v_cmp_le_u32 vcc, 9, v10
    v_subrev_u32 v11, 9, v10
    s_nop 0
    v_cndmask_b32 v10, v10, v11, vcc
    v_cndmask_b32 v11, 0, 1, vcc
    v_mul_u32_u24 v10, 36, v10
    v_add_u32 v10, v10, v11
    v_lshlrev_b32 v10, 10, v10
    v_lshl_add_u32 v5, v9, 4, v10
    s_add_u32 m0, s47, 38912
    s_nop 0
    buffer_load_dwordx4 v5, s[12:15], s49 offen lds
    v_mfma_f32_16x16x32_bf16 v[228:231], v[120:123], v[52:55], v[228:231]
    ds_read_b64_tr_b16 v[160:161], v2 offset:27744
    ds_read_b64_tr_b16 v[162:163], v2 offset:30048
    v_mfma_f32_16x16x32_bf16 v[196:199], v[124:127], v[48:51], v[196:199]
    v_lshrrev_b32 v9, 4, v8
    v_add_u32 v9, s46, v9
    v_add_u32 v9, 192, v9
    v_lshrrev_b32 v10, 6, v9
    v_and_b32 v9, 63, v9
    v_cmp_le_u32 vcc, 9, v10
    v_subrev_u32 v11, 9, v10
    s_nop 0
    v_cndmask_b32 v10, v10, v11, vcc
    v_cndmask_b32 v11, 0, 1, vcc
    v_mul_u32_u24 v10, 36, v10
    v_add_u32 v10, v10, v11
    v_lshlrev_b32 v10, 10, v10
    v_lshl_add_u32 v6, v9, 4, v10
    s_add_u32 m0, s47, 39936
    s_nop 0
    buffer_load_dwordx4 v6, s[12:15], s49 offen lds
    v_mfma_f32_16x16x32_bf16 v[232:235], v[124:127], v[52:55], v[232:235]
    ds_read_b64_tr_b16 v[164:165], v2 offset:27776
    ds_read_b64_tr_b16 v[166:167], v2 offset:30080
    s_waitcnt lgkmcnt(15)
    v_mfma_f32_16x16x32_bf16 v[200:203], v[128:131], v[48:51], v[200:203]
    v_mfma_f32_16x16x32_bf16 v[236:239], v[128:131], v[52:55], v[236:239]
    v_lshrrev_b32 v9, 4, v8
    v_add_u32 v9, s46, v9
    v_add_u32 v9, 256, v9
    v_lshrrev_b32 v10, 6, v9
    v_and_b32 v9, 63, v9
    v_cmp_le_u32 vcc, 9, v10
    v_subrev_u32 v11, 9, v10
    s_nop 0
    v_cndmask_b32 v10, v10, v11, vcc
    v_cndmask_b32 v11, 0, 1, vcc
    v_mul_u32_u24 v10, 36, v10
    v_add_u32 v10, v10, v11
    v_lshlrev_b32 v10, 10, v10
    v_lshl_add_u32 v7, v9, 4, v10
    s_mov_b32 exec_hi, 0
    s_add_u32 m0, s47, 40960
    s_nop 0
    buffer_load_dwordx4 v7, s[12:15], s49 offen lds
    s_mov_b32 exec_hi, -1
    ds_read_b64_tr_b16 v[168:169], v2 offset:27808
    ds_read_b64_tr_b16 v[170:171], v2 offset:30112
    v_mfma_f32_16x16x32_bf16 v[204:207], v[132:135], v[48:51], v[204:207]
    v_mfma_f32_16x16x32_bf16 v[240:243], v[132:135], v[52:55], v[240:243]
    s_add_u32 s56, s58, 17
    s_cmp_ge_u32 s56, 18
    s_cselect_b32 s59, 18, 0
    s_sub_u32 s56, s56, s59
    s_lshl_b32 s56, s56, 11
    s_add_u32 s56, s56, s41
    s_add_u32 s50, s56, 1024
    buffer_load_dwordx4 v[88:91], v8, s[8:11], s50 offen
    ds_read_b64_tr_b16 v[172:173], v2 offset:27840
    ds_read_b64_tr_b16 v[174:175], v2 offset:30144
    s_waitcnt lgkmcnt(15)
    v_mfma_f32_16x16x32_bf16 v[208:211], v[136:139], v[48:51], v[208:211]
    v_mfma_f32_16x16x32_bf16 v[244:247], v[136:139], v[52:55], v[244:247]
    s_add_u32 s50, s56, 148480
    buffer_load_dwordx4 v[92:95], v8, s[8:11], s50 offen
    ds_read_b64_tr_b16 v[176:177], v2 offset:27872
    ds_read_b64_tr_b16 v[178:179], v2 offset:30176
    v_mfma_f32_16x16x32_bf16 v[212:215], v[140:143], v[48:51], v[212:215]
    v_mfma_f32_16x16x32_bf16 v[248:251], v[140:143], v[52:55], v[248:251]
    ds_read_b64_tr_b16 v[180:181], v2 offset:27904
    ds_read_b64_tr_b16 v[182:183], v2 offset:30208
    s_waitcnt lgkmcnt(15)
    v_mfma_f32_16x16x32_bf16 v[216:219], v[144:147], v[48:51], v[216:219]
    v_mfma_f32_16x16x32_bf16 v[252:255], v[144:147], v[52:55], v[252:255]
    v_cmp_gt_u32 vcc, 36, v14
    s_mov_b32 s71, 0
    s_nop 3
    s_cbranch_vccz K2_PD
K2_POLL:
    buffer_load_dword v14, v13, s[24:27], s70 offen sc1
    s_waitcnt vmcnt(0)
    v_cmp_gt_u32 vcc, 36, v14
    s_add_u32 s71, s71, 1
    s_cmp_ge_u32 s71, 1000000
    s_cbranch_scc1 K2_PD
    s_cbranch_vccnz K2_POLL
K2_PD:
    s_waitcnt vmcnt(18)
    ds_read_b64_tr_b16 v[112:113], v1 offset:0
    ds_read_b64_tr_b16 v[114:115], v1 offset:2304
    v_mfma_f32_16x16x32_bf16 v[184:187], v[148:151], v[56:59], v[184:187]
    s_add_u32 s50, s67, 0
    buffer_load_dwordx4 v[48:51], v8, s[20:23], s50 offen sc1
    v_mfma_f32_16x16x32_bf16 v[220:223], v[148:151], v[60:63], v[220:223]
    ds_read_b64_tr_b16 v[116:117], v1 offset:32
    ds_read_b64_tr_b16 v[118:119], v1 offset:2336
    s_waitcnt lgkmcnt(15)
    v_mfma_f32_16x16x32_bf16 v[188:191], v[152:155], v[56:59], v[188:191]
    v_mfma_f32_16x16x32_bf16 v[224:227], v[152:155], v[60:63], v[224:227]
    ds_read_b64_tr_b16 v[120:121], v1 offset:64
    ds_read_b64_tr_b16 v[122:123], v1 offset:2368
    v_mfma_f32_16x16x32_bf16 v[192:195], v[156:159], v[56:59], v[192:195]
    v_mfma_f32_16x16x32_bf16 v[228:231], v[156:159], v[60:63], v[228:231]
    ds_read_b64_tr_b16 v[124:125], v1 offset:96
    ds_read_b64_tr_b16 v[126:127], v1 offset:2400
    s_waitcnt lgkmcnt(15)
    v_mfma_f32_16x16x32_bf16 v[196:199], v[160:163], v[56:59], v[196:199]
    v_mfma_f32_16x16x32_bf16 v[232:235], v[160:163], v[60:63], v[232:235]
    ds_read_b64_tr_b16 v[128:129], v1 offset:128
    ds_read_b64_tr_b16 v[130:131], v1 offset:2432
    v_mfma_f32_16x16x32_bf16 v[200:203], v[164:167], v[56:59], v[200:203]
    s_add_u32 s50, s67, 36864
    buffer_load_dwordx4 v[52:55], v8, s[20:23], s50 offen sc1
    v_mfma_f32_16x16x32_bf16 v[236:239], v[164:167], v[60:63], v[236:239]
    ds_read_b64_tr_b16 v[132:133], v1 offset:160
    ds_read_b64_tr_b16 v[134:135], v1 offset:2464
    s_waitcnt lgkmcnt(15)
    v_mfma_f32_16x16x32_bf16 v[204:207], v[168:171], v[56:59], v[204:207]
    v_mfma_f32_16x16x32_bf16 v[240:243], v[168:171], v[60:63], v[240:243]
    ds_read_b64_tr_b16 v[136:137], v1 offset:192
    ds_read_b64_tr_b16 v[138:139], v1 offset:2496
    v_mfma_f32_16x16x32_bf16 v[208:211], v[172:175], v[56:59], v[208:211]
    v_mfma_f32_16x16x32_bf16 v[244:247], v[172:175], v[60:63], v[244:247]
    ds_read_b64_tr_b16 v[140:141], v1 offset:224
    ds_read_b64_tr_b16 v[142:143], v1 offset:2528
    s_waitcnt lgkmcnt(15)
    v_mfma_f32_16x16x32_bf16 v[212:215], v[176:179], v[56:59], v[212:215]
    v_mfma_f32_16x16x32_bf16 v[248:251], v[176:179], v[60:63], v[248:251]
    ds_read_b64_tr_b16 v[144:145], v1 offset:256
    ds_read_b64_tr_b16 v[146:147], v1 offset:2560
    v_mfma_f32_16x16x32_bf16 v[216:219], v[180:183], v[56:59], v[216:219]
    v_mfma_f32_16x16x32_bf16 v[252:255], v[180:183], v[60:63], v[252:255]
    s_waitcnt vmcnt(13)
    s_barrier
    ds_read_b64_tr_b16 v[148:149], v1 offset:9216
    ds_read_b64_tr_b16 v[150:151], v1 offset:11520
    s_waitcnt lgkmcnt(15)
    v_mfma_f32_16x16x32_bf16 v[184:187], v[112:115], v[64:67], v[184:187]
    s_add_u32 s49, s66, 2048
    s_add_u32 m0, s47, 55296
    s_nop 0
    buffer_load_dwordx4 v3, s[12:15], s49 offen lds
    v_mfma_f32_16x16x32_bf16 v[220:223], v[112:115], v[68:71], v[220:223]
    ds_read_b64_tr_b16 v[152:153], v1 offset:9248
    ds_read_b64_tr_b16 v[154:155], v1 offset:11552
    v_mfma_f32_16x16x32_bf16 v[188:191], v[116:119], v[64:67], v[188:191]
    s_add_u32 m0, s47, 56320
    s_nop 0
    buffer_load_dwordx4 v4, s[12:15], s49 offen lds
    v_mfma_f32_16x16x32_bf16 v[224:227], v[116:119], v[68:71], v[224:227]
    ds_read_b64_tr_b16 v[156:157], v1 offset:9280
    ds_read_b64_tr_b16 v[158:159], v1 offset:11584
    s_waitcnt lgkmcnt(15)
    v_mfma_f32_16x16x32_bf16 v[192:195], v[120:123], v[64:67], v[192:195]
    s_add_u32 m0, s47, 57344
    s_nop 0
    buffer_load_dwordx4 v5, s[12:15], s49 offen lds
    v_mfma_f32_16x16x32_bf16 v[228:231], v[120:123], v[68:71], v[228:231]
    ds_read_b64_tr_b16 v[160:161], v1 offset:9312
    ds_read_b64_tr_b16 v[162:163], v1 offset:11616
    v_mfma_f32_16x16x32_bf16 v[196:199], v[124:127], v[64:67], v[196:199]
    s_add_u32 m0, s47, 58368
    s_nop 0
    buffer_load_dwordx4 v6, s[12:15], s49 offen lds
    v_mfma_f32_16x16x32_bf16 v[232:235], v[124:127], v[68:71], v[232:235]
    ds_read_b64_tr_b16 v[164:165], v1 offset:9344
    ds_read_b64_tr_b16 v[166:167], v1 offset:11648
    s_waitcnt lgkmcnt(15)
    v_mfma_f32_16x16x32_bf16 v[200:203], v[128:131], v[64:67], v[200:203]
    v_mfma_f32_16x16x32_bf16 v[236:239], v[128:131], v[68:71], v[236:239]
    s_mov_b32 exec_hi, 0
    s_add_u32 m0, s47, 59392
    s_nop 0
    buffer_load_dwordx4 v7, s[12:15], s49 offen lds
    s_mov_b32 exec_hi, -1
    ds_read_b64_tr_b16 v[168:169], v1 offset:9376
    ds_read_b64_tr_b16 v[170:171], v1 offset:11680
    v_mfma_f32_16x16x32_bf16 v[204:207], v[132:135], v[64:67], v[204:207]
    v_mfma_f32_16x16x32_bf16 v[240:243], v[132:135], v[68:71], v[240:243]
    s_add_u32 s50, s67, 1024
    buffer_load_dwordx4 v[56:59], v8, s[20:23], s50 offen sc1
    ds_read_b64_tr_b16 v[172:173], v1 offset:9408
    ds_read_b64_tr_b16 v[174:175], v1 offset:11712
    s_waitcnt lgkmcnt(15)
    v_mfma_f32_16x16x32_bf16 v[208:211], v[136:139], v[64:67], v[208:211]
    v_mfma_f32_16x16x32_bf16 v[244:247], v[136:139], v[68:71], v[244:247]
    s_add_u32 s50, s67, 37888
    buffer_load_dwordx4 v[60:63], v8, s[20:23], s50 offen sc1
    ds_read_b64_tr_b16 v[176:177], v1 offset:9440
    ds_read_b64_tr_b16 v[178:179], v1 offset:11744
    v_mfma_f32_16x16x32_bf16 v[212:215], v[140:143], v[64:67], v[212:215]
    v_mfma_f32_16x16x32_bf16 v[248:251], v[140:143], v[68:71], v[248:251]
    ds_read_b64_tr_b16 v[180:181], v1 offset:9472
    ds_read_b64_tr_b16 v[182:183], v1 offset:11776
    s_waitcnt lgkmcnt(15)
    v_mfma_f32_16x16x32_bf16 v[216:219], v[144:147], v[64:67], v[216:219]
    v_mfma_f32_16x16x32_bf16 v[252:255], v[144:147], v[68:71], v[252:255]
    s_waitcnt vmcnt(18)
    ds_read_b64_tr_b16 v[112:113], v1 offset:18432
    ds_read_b64_tr_b16 v[114:115], v1 offset:20736
    v_mfma_f32_16x16x32_bf16 v[184:187], v[148:151], v[72:75], v[184:187]
    s_add_u32 s50, s67, 2048
    buffer_load_dwordx4 v[64:67], v8, s[20:23], s50 offen sc1
    v_mfma_f32_16x16x32_bf16 v[220:223], v[148:151], v[76:79], v[220:223]
    ds_read_b64_tr_b16 v[116:117], v1 offset:18464
    ds_read_b64_tr_b16 v[118:119], v1 offset:20768
    s_waitcnt lgkmcnt(15)
    v_mfma_f32_16x16x32_bf16 v[188:191], v[152:155], v[72:75], v[188:191]
    v_mfma_f32_16x16x32_bf16 v[224:227], v[152:155], v[76:79], v[224:227]
    ds_read_b64_tr_b16 v[120:121], v1 offset:18496
    ds_read_b64_tr_b16 v[122:123], v1 offset:20800
    v_mfma_f32_16x16x32_bf16 v[192:195], v[156:159], v[72:75], v[192:195]
    v_mfma_f32_16x16x32_bf16 v[228:231], v[156:159], v[76:79], v[228:231]
    ds_read_b64_tr_b16 v[124:125], v1 offset:18528
    ds_read_b64_tr_b16 v[126:127], v1 offset:20832
    s_waitcnt lgkmcnt(15)
    v_mfma_f32_16x16x32_bf16 v[196:199], v[160:163], v[72:75], v[196:199]
    v_mfma_f32_16x16x32_bf16 v[232:235], v[160:163], v[76:79], v[232:235]
    ds_read_b64_tr_b16 v[128:129], v1 offset:18560
    ds_read_b64_tr_b16 v[130:131], v1 offset:20864
    v_mfma_f32_16x16x32_bf16 v[200:203], v[164:167], v[72:75], v[200:203]
    s_add_u32 s50, s67, 38912
    buffer_load_dwordx4 v[68:71], v8, s[20:23], s50 offen sc1
    v_mfma_f32_16x16x32_bf16 v[236:239], v[164:167], v[76:79], v[236:239]
    ds_read_b64_tr_b16 v[132:133], v1 offset:18592
    ds_read_b64_tr_b16 v[134:135], v1 offset:20896
    s_waitcnt lgkmcnt(15)
    v_mfma_f32_16x16x32_bf16 v[204:207], v[168:171], v[72:75], v[204:207]
    v_mfma_f32_16x16x32_bf16 v[240:243], v[168:171], v[76:79], v[240:243]
    ds_read_b64_tr_b16 v[136:137], v1 offset:18624
    ds_read_b64_tr_b16 v[138:139], v1 offset:20928
    v_mfma_f32_16x16x32_bf16 v[208:211], v[172:175], v[72:75], v[208:211]
    v_mfma_f32_16x16x32_bf16 v[244:247], v[172:175], v[76:79], v[244:247]
    ds_read_b64_tr_b16 v[140:141], v1 offset:18656
    ds_read_b64_tr_b16 v[142:143], v1 offset:20960
    s_waitcnt lgkmcnt(15)
    v_mfma_f32_16x16x32_bf16 v[212:215], v[176:179], v[72:75], v[212:215]
    v_mfma_f32_16x16x32_bf16 v[248:251], v[176:179], v[76:79], v[248:251]
    ds_read_b64_tr_b16 v[144:145], v1 offset:18688
    ds_read_b64_tr_b16 v[146:147], v1 offset:20992
    v_mfma_f32_16x16x32_bf16 v[216:219], v[180:183], v[72:75], v[216:219]
    v_mfma_f32_16x16x32_bf16 v[252:255], v[180:183], v[76:79], v[252:255]
    s_waitcnt vmcnt(13)
    s_barrier
    ds_read_b64_tr_b16 v[148:149], v1 offset:27648
    ds_read_b64_tr_b16 v[150:151], v1 offset:29952
    s_waitcnt lgkmcnt(15)
    v_mfma_f32_16x16x32_bf16 v[184:187], v[112:115], v[80:83], v[184:187]
    s_add_u32 s49, s66, 4096
    s_add_u32 m0, s47, 0
    s_nop 0
    buffer_load_dwordx4 v3, s[12:15], s49 offen lds
    v_mfma_f32_16x16x32_bf16 v[220:223], v[112:115], v[84:87], v[220:223]
    ds_read_b64_tr_b16 v[152:153], v1 offset:27680
    ds_read_b64_tr_b16 v[154:155], v1 offset:29984
    v_mfma_f32_16x16x32_bf16 v[188:191], v[116:119], v[80:83], v[188:191]
    s_add_u32 m0, s47, 1024
    s_nop 0
    buffer_load_dwordx4 v4, s[12:15], s49 offen lds
    v_mfma_f32_16x16x32_bf16 v[224:227], v[116:119], v[84:87], v[224:227]
    ds_read_b64_tr_b16 v[156:157], v1 offset:27712
    ds_read_b64_tr_b16 v[158:159], v1 offset:30016
    s_waitcnt lgkmcnt(15)
    v_mfma_f32_16x16x32_bf16 v[192:195], v[120:123], v[80:83], v[192:195]
    s_add_u32 m0, s47, 2048
    s_nop 0
    buffer_load_dwordx4 v5, s[12:15], s49 offen lds
    v_mfma_f32_16x16x32_bf16 v[228:231], v[120:123], v[84:87], v[228:231]
    ds_read_b64_tr_b16 v[160:161], v1 offset:27744
    ds_read_b64_tr_b16 v[162:163], v1 offset:30048
    v_mfma_f32_16x16x32_bf16 v[196:199], v[124:127], v[80:83], v[196:199]
    s_add_u32 m0, s47, 3072
    s_nop 0
    buffer_load_dwordx4 v6, s[12:15], s49 offen lds
    v_mfma_f32_16x16x32_bf16 v[232:235], v[124:127], v[84:87], v[232:235]
    ds_read_b64_tr_b16 v[164:165], v1 offset:27776
    ds_read_b64_tr_b16 v[166:167], v1 offset:30080
    s_waitcnt lgkmcnt(15)
    v_mfma_f32_16x16x32_bf16 v[200:203], v[128:131], v[80:83], v[200:203]
    v_mfma_f32_16x16x32_bf16 v[236:239], v[128:131], v[84:87], v[236:239]
    s_mov_b32 exec_hi, 0
    s_add_u32 m0, s47, 4096
    s_nop 0
    buffer_load_dwordx4 v7, s[12:15], s49 offen lds
    s_mov_b32 exec_hi, -1
    ds_read_b64_tr_b16 v[168:169], v1 offset:27808
    ds_read_b64_tr_b16 v[170:171], v1 offset:30112
    v_mfma_f32_16x16x32_bf16 v[204:207], v[132:135], v[80:83], v[204:207]
    v_mfma_f32_16x16x32_bf16 v[240:243], v[132:135], v[84:87], v[240:243]
    s_add_u32 s50, s67, 3072
    buffer_load_dwordx4 v[72:75], v8, s[20:23], s50 offen sc1
    ds_read_b64_tr_b16 v[172:173], v1 offset:27840
    ds_read_b64_tr_b16 v[174:175], v1 offset:30144
    s_waitcnt lgkmcnt(15)
    v_mfma_f32_16x16x32_bf16 v[208:211], v[136:139], v[80:83], v[208:211]
    v_mfma_f32_16x16x32_bf16 v[244:247], v[136:139], v[84:87], v[244:247]
    s_add_u32 s50, s67, 39936
    buffer_load_dwordx4 v[76:79], v8, s[20:23], s50 offen sc1
    ds_read_b64_tr_b16 v[176:177], v1 offset:27872
    ds_read_b64_tr_b16 v[178:179], v1 offset:30176
    v_mfma_f32_16x16x32_bf16 v[212:215], v[140:143], v[80:83], v[212:215]
    v_mfma_f32_16x16x32_bf16 v[248:251], v[140:143], v[84:87], v[248:251]
    ds_read_b64_tr_b16 v[180:181], v1 offset:27904
    ds_read_b64_tr_b16 v[182:183], v1 offset:30208
    s_waitcnt lgkmcnt(15)
    v_mfma_f32_16x16x32_bf16 v[216:219], v[144:147], v[80:83], v[216:219]
    v_mfma_f32_16x16x32_bf16 v[252:255], v[144:147], v[84:87], v[252:255]
    s_waitcnt vmcnt(18)
    ds_read_b128 v[112:115], v12 offset:0
    v_mfma_f32_16x16x32_bf16 v[184:187], v[148:151], v[88:91], v[184:187]
    s_add_u32 s50, s67, 4096
    buffer_load_dwordx4 v[80:83], v8, s[20:23], s50 offen sc1
    v_mfma_f32_16x16x32_bf16 v[220:223], v[148:151], v[92:95], v[220:223]
    ds_read_b128 v[116:119], v12 offset:1024
    s_waitcnt lgkmcnt(15)
    v_mfma_f32_16x16x32_bf16 v[188:191], v[152:155], v[88:91], v[188:191]
    v_mfma_f32_16x16x32_bf16 v[224:227], v[152:155], v[92:95], v[224:227]
    ds_read_b128 v[120:123], v12 offset:2048
    s_waitcnt lgkmcnt(15)
    v_mfma_f32_16x16x32_bf16 v[192:195], v[156:159], v[88:91], v[192:195]
    v_mfma_f32_16x16x32_bf16 v[228:231], v[156:159], v[92:95], v[228:231]
    ds_read_b128 v[124:127], v12 offset:3072
    s_waitcnt lgkmcnt(14)
    v_mfma_f32_16x16x32_bf16 v[196:199], v[160:163], v[88:91], v[196:199]
    v_mfma_f32_16x16x32_bf16 v[232:235], v[160:163], v[92:95], v[232:235]
    ds_read_b128 v[128:131], v12 offset:4096
    s_waitcnt lgkmcnt(13)
    v_mfma_f32_16x16x32_bf16 v[200:203], v[164:167], v[88:91], v[200:203]
    s_add_u32 s50, s67, 40960
    buffer_load_dwordx4 v[84:87], v8, s[20:23], s50 offen sc1
    v_mfma_f32_16x16x32_bf16 v[236:239], v[164:167], v[92:95], v[236:239]
    ds_read_b128 v[132:135], v12 offset:5120
    s_waitcnt lgkmcnt(12)
    v_mfma_f32_16x16x32_bf16 v[204:207], v[168:171], v[88:91], v[204:207]
    v_mfma_f32_16x16x32_bf16 v[240:243], v[168:171], v[92:95], v[240:243]
    ds_read_b128 v[136:139], v12 offset:6144
    s_waitcnt lgkmcnt(11)
    v_mfma_f32_16x16x32_bf16 v[208:211], v[172:175], v[88:91], v[208:211]
    v_mfma_f32_16x16x32_bf16 v[244:247], v[172:175], v[92:95], v[244:247]
    ds_read_b128 v[140:143], v12 offset:7168
    s_waitcnt lgkmcnt(10)
    v_mfma_f32_16x16x32_bf16 v[212:215], v[176:179], v[88:91], v[212:215]
    v_mfma_f32_16x16x32_bf16 v[248:251], v[176:179], v[92:95], v[248:251]
    ds_read_b128 v[144:147], v12 offset:8192
    s_waitcnt lgkmcnt(9)
    v_mfma_f32_16x16x32_bf16 v[216:219], v[180:183], v[88:91], v[216:219]
    v_mfma_f32_16x16x32_bf16 v[252:255], v[180:183], v[92:95], v[252:255]
    s_waitcnt vmcnt(13)
    s_barrier
    ds_read_b128 v[148:151], v12 offset:9216
    s_waitcnt lgkmcnt(9)
    v_mfma_f32_16x16x32_bf16 v[184:187], v[112:115], v[48:51], v[184:187]
    s_add_u32 s49, s66, 6144
    s_add_u32 m0, s47, 18432
    s_nop 0
    buffer_load_dwordx4 v3, s[12:15], s49 offen lds
    v_mfma_f32_16x16x32_bf16 v[220:223], v[112:115], v[52:55], v[220:223]
    ds_read_b128 v[152:155], v12 offset:10240
    s_waitcnt lgkmcnt(9)
    v_mfma_f32_16x16x32_bf16 v[188:191], v[116:119], v[48:51], v[188:191]
    s_add_u32 m0, s47, 19456
    s_nop 0
    buffer_load_dwordx4 v4, s[12:15], s49 offen lds
    v_mfma_f32_16x16x32_bf16 v[224:227], v[116:119], v[52:55], v[224:227]
    ds_read_b128 v[156:159], v12 offset:11264
    s_waitcnt lgkmcnt(9)
    v_mfma_f32_16x16x32_bf16 v[192:195], v[120:123], v[48:51], v[192:195]
    s_add_u32 m0, s47, 20480
    s_nop 0
    buffer_load_dwordx4 v5, s[12:15], s49 offen lds
    v_mfma_f32_16x16x32_bf16 v[228:231], v[120:123], v[52:55], v[228:231]
    ds_read_b128 v[160:163], v12 offset:12288
    s_waitcnt lgkmcnt(9)
    v_mfma_f32_16x16x32_bf16 v[196:199], v[124:127], v[48:51], v[196:199]
    s_add_u32 m0, s47, 21504
    s_nop 0
    buffer_load_dwordx4 v6, s[12:15], s49 offen lds
    v_mfma_f32_16x16x32_bf16 v[232:235], v[124:127], v[52:55], v[232:235]
    ds_read_b128 v[164:167], v12 offset:13312
    s_waitcnt lgkmcnt(9)
    v_mfma_f32_16x16x32_bf16 v[200:203], v[128:131], v[48:51], v[200:203]
    v_mfma_f32_16x16x32_bf16 v[236:239], v[128:131], v[52:55], v[236:239]
    s_mov_b32 exec_hi, 0
    s_add_u32 m0, s47, 22528
    s_nop 0
    buffer_load_dwordx4 v7, s[12:15], s49 offen lds
    s_mov_b32 exec_hi, -1
    ds_read_b128 v[168:171], v12 offset:14336
    s_waitcnt lgkmcnt(9)
    v_mfma_f32_16x16x32_bf16 v[204:207], v[132:135], v[48:51], v[204:207]
    v_mfma_f32_16x16x32_bf16 v[240:243], v[132:135], v[52:55], v[240:243]
    s_add_u32 s50, s67, 5120
    buffer_load_dwordx4 v[88:91], v8, s[20:23], s50 offen sc1
    ds_read_b128 v[172:175], v12 offset:15360
    s_waitcnt lgkmcnt(9)
    v_mfma_f32_16x16x32_bf16 v[208:211], v[136:139], v[48:51], v[208:211]
    v_mfma_f32_16x16x32_bf16 v[244:247], v[136:139], v[52:55], v[244:247]
    s_add_u32 s50, s67, 41984
    buffer_load_dwordx4 v[92:95], v8, s[20:23], s50 offen sc1
    ds_read_b128 v[176:179], v12 offset:16384
    s_waitcnt lgkmcnt(9)
    v_mfma_f32_16x16x32_bf16 v[212:215], v[140:143], v[48:51], v[212:215]
    v_mfma_f32_16x16x32_bf16 v[248:251], v[140:143], v[52:55], v[248:251]
    ds_read_b128 v[180:183], v12 offset:17408
    s_waitcnt lgkmcnt(9)
    v_mfma_f32_16x16x32_bf16 v[216:219], v[144:147], v[48:51], v[216:219]
    v_mfma_f32_16x16x32_bf16 v[252:255], v[144:147], v[52:55], v[252:255]
    s_waitcnt vmcnt(18)
    ds_read_b128 v[112:115], v12 offset:18432
    s_waitcnt lgkmcnt(9)
    v_mfma_f32_16x16x32_bf16 v[184:187], v[148:151], v[56:59], v[184:187]
    s_add_u32 s50, s67, 6144
    buffer_load_dwordx4 v[48:51], v8, s[20:23], s50 offen sc1
    v_mfma_f32_16x16x32_bf16 v[220:223], v[148:151], v[60:63], v[220:223]
    ds_read_b128 v[116:119], v12 offset:19456
    s_waitcnt lgkmcnt(9)
    v_mfma_f32_16x16x32_bf16 v[188:191], v[152:155], v[56:59], v[188:191]
    v_mfma_f32_16x16x32_bf16 v[224:227], v[152:155], v[60:63], v[224:227]
    ds_read_b128 v[120:123], v12 offset:20480
    s_waitcnt lgkmcnt(9)
    v_mfma_f32_16x16x32_bf16 v[192:195], v[156:159], v[56:59], v[192:195]
    v_mfma_f32_16x16x32_bf16 v[228:231], v[156:159], v[60:63], v[228:231]
    ds_read_b128 v[124:127], v12 offset:21504
    s_waitcnt lgkmcnt(9)
    v_mfma_f32_16x16x32_bf16 v[196:199], v[160:163], v[56:59], v[196:199]
    v_mfma_f32_16x16x32_bf16 v[232:235], v[160:163], v[60:63], v[232:235]
    ds_read_b128 v[128:131], v12 offset:22528
    s_waitcnt lgkmcnt(9)
    v_mfma_f32_16x16x32_bf16 v[200:203], v[164:167], v[56:59], v[200:203]
    s_add_u32 s50, s67, 43008
    buffer_load_dwordx4 v[52:55], v8, s[20:23], s50 offen sc1
    v_mfma_f32_16x16x32_bf16 v[236:239], v[164:167], v[60:63], v[236:239]
    ds_read_b128 v[132:135], v12 offset:23552
    s_waitcnt lgkmcnt(9)
    v_mfma_f32_16x16x32_bf16 v[204:207], v[168:171], v[56:59], v[204:207]
    v_mfma_f32_16x16x32_bf16 v[240:243], v[168:171], v[60:63], v[240:243]
    ds_read_b128 v[136:139], v12 offset:24576
    s_waitcnt lgkmcnt(9)
    v_mfma_f32_16x16x32_bf16 v[208:211], v[172:175], v[56:59], v[208:211]
    v_mfma_f32_16x16x32_bf16 v[244:247], v[172:175], v[60:63], v[244:247]
    ds_read_b128 v[140:143], v12 offset:25600
    s_waitcnt lgkmcnt(9)
    v_mfma_f32_16x16x32_bf16 v[212:215], v[176:179], v[56:59], v[212:215]
    v_mfma_f32_16x16x32_bf16 v[248:251], v[176:179], v[60:63], v[248:251]
    ds_read_b128 v[144:147], v12 offset:26624
    s_waitcnt lgkmcnt(9)
    v_mfma_f32_16x16x32_bf16 v[216:219], v[180:183], v[56:59], v[216:219]
    v_mfma_f32_16x16x32_bf16 v[252:255], v[180:183], v[60:63], v[252:255]
    s_waitcnt vmcnt(13)
    s_barrier
    ds_read_b128 v[148:151], v12 offset:27648
    s_waitcnt lgkmcnt(9)
    v_mfma_f32_16x16x32_bf16 v[184:187], v[112:115], v[64:67], v[184:187]
    s_add_u32 s49, s66, 8192
    s_add_u32 m0, s47, 36864
    s_nop 0
    buffer_load_dwordx4 v3, s[12:15], s49 offen lds
    v_mfma_f32_16x16x32_bf16 v[220:223], v[112:115], v[68:71], v[220:223]
    ds_read_b128 v[152:155], v12 offset:28672
    s_waitcnt lgkmcnt(9)
    v_mfma_f32_16x16x32_bf16 v[188:191], v[116:119], v[64:67], v[188:191]
    s_add_u32 m0, s47, 37888
    s_nop 0
    buffer_load_dwordx4 v4, s[12:15], s49 offen lds
    v_mfma_f32_16x16x32_bf16 v[224:227], v[116:119], v[68:71], v[224:227]
    ds_read_b128 v[156:159], v12 offset:29696
    s_waitcnt lgkmcnt(9)
    v_mfma_f32_16x16x32_bf16 v[192:195], v[120:123], v[64:67], v[192:195]
    s_add_u32 m0, s47, 38912
    s_nop 0
    buffer_load_dwordx4 v5, s[12:15], s49 offen lds
    v_mfma_f32_16x16x32_bf16 v[228:231], v[120:123], v[68:71], v[228:231]
    ds_read_b128 v[160:163], v12 offset:30720
    s_waitcnt lgkmcnt(9)
    v_mfma_f32_16x16x32_bf16 v[196:199], v[124:127], v[64:67], v[196:199]
    s_add_u32 m0, s47, 39936
    s_nop 0
    buffer_load_dwordx4 v6, s[12:15], s49 offen lds
    v_mfma_f32_16x16x32_bf16 v[232:235], v[124:127], v[68:71], v[232:235]
    ds_read_b128 v[164:167], v12 offset:31744
    s_waitcnt lgkmcnt(9)
    v_mfma_f32_16x16x32_bf16 v[200:203], v[128:131], v[64:67], v[200:203]
    v_mfma_f32_16x16x32_bf16 v[236:239], v[128:131], v[68:71], v[236:239]
    s_mov_b32 exec_hi, 0
    s_add_u32 m0, s47, 40960
    s_nop 0
    buffer_load_dwordx4 v7, s[12:15], s49 offen lds
    s_mov_b32 exec_hi, -1
    ds_read_b128 v[168:171], v12 offset:32768
    s_waitcnt lgkmcnt(9)
    v_mfma_f32_16x16x32_bf16 v[204:207], v[132:135], v[64:67], v[204:207]
    v_mfma_f32_16x16x32_bf16 v[240:243], v[132:135], v[68:71], v[240:243]
    s_add_u32 s50, s67, 7168
    buffer_load_dwordx4 v[56:59], v8, s[20:23], s50 offen sc1
    ds_read_b128 v[172:175], v12 offset:33792
    s_waitcnt lgkmcnt(9)
    v_mfma_f32_16x16x32_bf16 v[208:211], v[136:139], v[64:67], v[208:211]
    v_mfma_f32_16x16x32_bf16 v[244:247], v[136:139], v[68:71], v[244:247]
    s_add_u32 s50, s67, 44032
    buffer_load_dwordx4 v[60:63], v8, s[20:23], s50 offen sc1
    ds_read_b128 v[176:179], v12 offset:34816
    s_waitcnt lgkmcnt(9)
    v_mfma_f32_16x16x32_bf16 v[212:215], v[140:143], v[64:67], v[212:215]
    v_mfma_f32_16x16x32_bf16 v[248:251], v[140:143], v[68:71], v[248:251]
    ds_read_b128 v[180:183], v12 offset:35840
    s_waitcnt lgkmcnt(9)
    v_mfma_f32_16x16x32_bf16 v[216:219], v[144:147], v[64:67], v[216:219]
    v_mfma_f32_16x16x32_bf16 v[252:255], v[144:147], v[68:71], v[252:255]
    s_waitcnt vmcnt(18)
    ds_read_b128 v[112:115], v8 offset:0
    s_waitcnt lgkmcnt(9)
    v_mfma_f32_16x16x32_bf16 v[184:187], v[148:151], v[72:75], v[184:187]
    s_add_u32 s50, s67, 8192
    buffer_load_dwordx4 v[64:67], v8, s[20:23], s50 offen sc1
    v_mfma_f32_16x16x32_bf16 v[220:223], v[148:151], v[76:79], v[220:223]
    ds_read_b128 v[116:119], v8 offset:1024
    s_waitcnt lgkmcnt(9)
    v_mfma_f32_16x16x32_bf16 v[188:191], v[152:155], v[72:75], v[188:191]
    v_mfma_f32_16x16x32_bf16 v[224:227], v[152:155], v[76:79], v[224:227]
    ds_read_b128 v[120:123], v8 offset:2048
    s_waitcnt lgkmcnt(9)
    v_mfma_f32_16x16x32_bf16 v[192:195], v[156:159], v[72:75], v[192:195]
    v_mfma_f32_16x16x32_bf16 v[228:231], v[156:159], v[76:79], v[228:231]
    ds_read_b128 v[124:127], v8 offset:3072
    s_waitcnt lgkmcnt(9)
    v_mfma_f32_16x16x32_bf16 v[196:199], v[160:163], v[72:75], v[196:199]
    v_mfma_f32_16x16x32_bf16 v[232:235], v[160:163], v[76:79], v[232:235]
    ds_read_b128 v[128:131], v8 offset:4096
    s_waitcnt lgkmcnt(9)
    v_mfma_f32_16x16x32_bf16 v[200:203], v[164:167], v[72:75], v[200:203]
    s_add_u32 s50, s67, 45056
    buffer_load_dwordx4 v[68:71], v8, s[20:23], s50 offen sc1
    v_mfma_f32_16x16x32_bf16 v[236:239], v[164:167], v[76:79], v[236:239]
    ds_read_b128 v[132:135], v8 offset:5120
    s_waitcnt lgkmcnt(9)
    v_mfma_f32_16x16x32_bf16 v[204:207], v[168:171], v[72:75], v[204:207]
    v_mfma_f32_16x16x32_bf16 v[240:243], v[168:171], v[76:79], v[240:243]
    ds_read_b128 v[136:139], v8 offset:6144
    s_waitcnt lgkmcnt(9)
    v_mfma_f32_16x16x32_bf16 v[208:211], v[172:175], v[72:75], v[208:211]
    v_mfma_f32_16x16x32_bf16 v[244:247], v[172:175], v[76:79], v[244:247]
    ds_read_b128 v[140:143], v8 offset:7168
    s_waitcnt lgkmcnt(9)
    v_mfma_f32_16x16x32_bf16 v[212:215], v[176:179], v[72:75], v[212:215]
    v_mfma_f32_16x16x32_bf16 v[248:251], v[176:179], v[76:79], v[248:251]
    ds_read_b128 v[144:147], v8 offset:8192
    s_waitcnt lgkmcnt(9)
    v_mfma_f32_16x16x32_bf16 v[216:219], v[180:183], v[72:75], v[216:219]
    v_mfma_f32_16x16x32_bf16 v[252:255], v[180:183], v[76:79], v[252:255]
    s_waitcnt vmcnt(13)
    s_barrier
    ds_read_b128 v[148:151], v8 offset:9216
    s_waitcnt lgkmcnt(9)
    v_mfma_f32_16x16x32_bf16 v[184:187], v[112:115], v[80:83], v[184:187]
    v_mfma_f32_16x16x32_bf16 v[220:223], v[112:115], v[84:87], v[220:223]
    ds_read_b128 v[152:155], v8 offset:10240
    s_waitcnt lgkmcnt(9)
    v_mfma_f32_16x16x32_bf16 v[188:191], v[116:119], v[80:83], v[188:191]
    v_mfma_f32_16x16x32_bf16 v[224:227], v[116:119], v[84:87], v[224:227]
    ds_read_b128 v[156:159], v8 offset:11264
    s_waitcnt lgkmcnt(9)
    v_mfma_f32_16x16x32_bf16 v[192:195], v[120:123], v[80:83], v[192:195]
    v_mfma_f32_16x16x32_bf16 v[228:231], v[120:123], v[84:87], v[228:231]
    ds_read_b128 v[160:163], v8 offset:12288
    s_waitcnt lgkmcnt(9)
    v_mfma_f32_16x16x32_bf16 v[196:199], v[124:127], v[80:83], v[196:199]
    v_mfma_f32_16x16x32_bf16 v[232:235], v[124:127], v[84:87], v[232:235]
    ds_read_b128 v[164:167], v8 offset:13312
    s_waitcnt lgkmcnt(9)
    v_mfma_f32_16x16x32_bf16 v[200:203], v[128:131], v[80:83], v[200:203]
    v_mfma_f32_16x16x32_bf16 v[236:239], v[128:131], v[84:87], v[236:239]
    ds_read_b128 v[168:171], v8 offset:14336
    s_waitcnt lgkmcnt(9)
    v_mfma_f32_16x16x32_bf16 v[204:207], v[132:135], v[80:83], v[204:207]
    v_mfma_f32_16x16x32_bf16 v[240:243], v[132:135], v[84:87], v[240:243]
    ds_read_b128 v[172:175], v8 offset:15360
    s_waitcnt lgkmcnt(9)
    v_mfma_f32_16x16x32_bf16 v[208:211], v[136:139], v[80:83], v[208:211]
    v_mfma_f32_16x16x32_bf16 v[244:247], v[136:139], v[84:87], v[244:247]
    ds_read_b128 v[176:179], v8 offset:16384
    s_waitcnt lgkmcnt(9)
    v_mfma_f32_16x16x32_bf16 v[212:215], v[140:143], v[80:83], v[212:215]
    v_mfma_f32_16x16x32_bf16 v[248:251], v[140:143], v[84:87], v[248:251]
    ds_read_b128 v[180:183], v8 offset:17408
    s_waitcnt lgkmcnt(9)
    v_mfma_f32_16x16x32_bf16 v[216:219], v[144:147], v[80:83], v[216:219]
    v_mfma_f32_16x16x32_bf16 v[252:255], v[144:147], v[84:87], v[252:255]
    s_waitcnt vmcnt(11)
    ds_read_b128 v[112:115], v8 offset:18432
    s_waitcnt lgkmcnt(9)
    v_mfma_f32_16x16x32_bf16 v[184:187], v[148:151], v[88:91], v[184:187]
    v_mfma_f32_16x16x32_bf16 v[220:223], v[148:151], v[92:95], v[220:223]
    ds_read_b128 v[116:119], v8 offset:19456
    s_waitcnt lgkmcnt(9)
    v_mfma_f32_16x16x32_bf16 v[188:191], v[152:155], v[88:91], v[188:191]
    v_mfma_f32_16x16x32_bf16 v[224:227], v[152:155], v[92:95], v[224:227]
    ds_read_b128 v[120:123], v8 offset:20480
    s_waitcnt lgkmcnt(9)
    v_mfma_f32_16x16x32_bf16 v[192:195], v[156:159], v[88:91], v[192:195]
    v_mfma_f32_16x16x32_bf16 v[228:231], v[156:159], v[92:95], v[228:231]
    ds_read_b128 v[124:127], v8 offset:21504
    s_waitcnt lgkmcnt(9)
    v_mfma_f32_16x16x32_bf16 v[196:199], v[160:163], v[88:91], v[196:199]
    v_mfma_f32_16x16x32_bf16 v[232:235], v[160:163], v[92:95], v[232:235]
    ds_read_b128 v[128:131], v8 offset:22528
    s_waitcnt lgkmcnt(9)
    v_mfma_f32_16x16x32_bf16 v[200:203], v[164:167], v[88:91], v[200:203]
    v_mfma_f32_16x16x32_bf16 v[236:239], v[164:167], v[92:95], v[236:239]
    ds_read_b128 v[132:135], v8 offset:23552
    s_waitcnt lgkmcnt(9)
    v_mfma_f32_16x16x32_bf16 v[204:207], v[168:171], v[88:91], v[204:207]
    v_mfma_f32_16x16x32_bf16 v[240:243], v[168:171], v[92:95], v[240:243]
    ds_read_b128 v[136:139], v8 offset:24576
    s_waitcnt lgkmcnt(9)
    v_mfma_f32_16x16x32_bf16 v[208:211], v[172:175], v[88:91], v[208:211]
    v_mfma_f32_16x16x32_bf16 v[244:247], v[172:175], v[92:95], v[244:247]
    ds_read_b128 v[140:143], v8 offset:25600
    s_waitcnt lgkmcnt(9)
    v_mfma_f32_16x16x32_bf16 v[212:215], v[176:179], v[88:91], v[212:215]
    v_mfma_f32_16x16x32_bf16 v[248:251], v[176:179], v[92:95], v[248:251]
    ds_read_b128 v[144:147], v8 offset:26624
    s_waitcnt lgkmcnt(9)
    v_mfma_f32_16x16x32_bf16 v[216:219], v[180:183], v[88:91], v[216:219]
    v_mfma_f32_16x16x32_bf16 v[252:255], v[180:183], v[92:95], v[252:255]
    s_waitcnt vmcnt(4)
    s_barrier
    ds_read_b128 v[148:151], v8 offset:27648
    s_waitcnt lgkmcnt(9)
    v_mfma_f32_16x16x32_bf16 v[184:187], v[112:115], v[48:51], v[184:187]
    v_mfma_f32_16x16x32_bf16 v[220:223], v[112:115], v[52:55], v[220:223]
    ds_read_b128 v[152:155], v8 offset:28672
    s_waitcnt lgkmcnt(9)
    v_mfma_f32_16x16x32_bf16 v[188:191], v[116:119], v[48:51], v[188:191]
    v_mfma_f32_16x16x32_bf16 v[224:227], v[116:119], v[52:55], v[224:227]
    ds_read_b128 v[156:159], v8 offset:29696
    s_waitcnt lgkmcnt(9)
    v_mfma_f32_16x16x32_bf16 v[192:195], v[120:123], v[48:51], v[192:195]
    v_mfma_f32_16x16x32_bf16 v[228:231], v[120:123], v[52:55], v[228:231]
    ds_read_b128 v[160:163], v8 offset:30720
    s_waitcnt lgkmcnt(9)
    v_mfma_f32_16x16x32_bf16 v[196:199], v[124:127], v[48:51], v[196:199]
    v_mfma_f32_16x16x32_bf16 v[232:235], v[124:127], v[52:55], v[232:235]
    ds_read_b128 v[164:167], v8 offset:31744
    s_waitcnt lgkmcnt(9)
    v_mfma_f32_16x16x32_bf16 v[200:203], v[128:131], v[48:51], v[200:203]
    v_mfma_f32_16x16x32_bf16 v[236:239], v[128:131], v[52:55], v[236:239]
    ds_read_b128 v[168:171], v8 offset:32768
    s_waitcnt lgkmcnt(9)
    v_mfma_f32_16x16x32_bf16 v[204:207], v[132:135], v[48:51], v[204:207]
    v_mfma_f32_16x16x32_bf16 v[240:243], v[132:135], v[52:55], v[240:243]
    ds_read_b128 v[172:175], v8 offset:33792
    s_waitcnt lgkmcnt(9)
    v_mfma_f32_16x16x32_bf16 v[208:211], v[136:139], v[48:51], v[208:211]
    v_mfma_f32_16x16x32_bf16 v[244:247], v[136:139], v[52:55], v[244:247]
    ds_read_b128 v[176:179], v8 offset:34816
    s_waitcnt lgkmcnt(9)
    v_mfma_f32_16x16x32_bf16 v[212:215], v[140:143], v[48:51], v[212:215]
    v_mfma_f32_16x16x32_bf16 v[248:251], v[140:143], v[52:55], v[248:251]
    ds_read_b128 v[180:183], v8 offset:35840
    s_waitcnt lgkmcnt(9)
    v_mfma_f32_16x16x32_bf16 v[216:219], v[144:147], v[48:51], v[216:219]
    v_mfma_f32_16x16x32_bf16 v[252:255], v[144:147], v[52:55], v[252:255]
    s_waitcnt vmcnt(2)
    ds_read_b128 v[112:115], v12 offset:0
    s_waitcnt lgkmcnt(9)
    v_mfma_f32_16x16x32_bf16 v[184:187], v[148:151], v[56:59], v[184:187]
    v_mfma_f32_16x16x32_bf16 v[220:223], v[148:151], v[60:63], v[220:223]
    ds_read_b128 v[116:119], v12 offset:1024
    s_waitcnt lgkmcnt(9)
    v_mfma_f32_16x16x32_bf16 v[188:191], v[152:155], v[56:59], v[188:191]
    v_mfma_f32_16x16x32_bf16 v[224:227], v[152:155], v[60:63], v[224:227]
    ds_read_b128 v[120:123], v12 offset:2048
    s_waitcnt lgkmcnt(9)
    v_mfma_f32_16x16x32_bf16 v[192:195], v[156:159], v[56:59], v[192:195]
    v_mfma_f32_16x16x32_bf16 v[228:231], v[156:159], v[60:63], v[228:231]
    ds_read_b128 v[124:127], v12 offset:3072
    s_waitcnt lgkmcnt(9)
    v_mfma_f32_16x16x32_bf16 v[196:199], v[160:163], v[56:59], v[196:199]
    v_mfma_f32_16x16x32_bf16 v[232:235], v[160:163], v[60:63], v[232:235]
    ds_read_b128 v[128:131], v12 offset:4096
    s_waitcnt lgkmcnt(9)
    v_mfma_f32_16x16x32_bf16 v[200:203], v[164:167], v[56:59], v[200:203]
    v_mfma_f32_16x16x32_bf16 v[236:239], v[164:167], v[60:63], v[236:239]
    ds_read_b128 v[132:135], v12 offset:5120
    s_waitcnt lgkmcnt(9)
    v_mfma_f32_16x16x32_bf16 v[204:207], v[168:171], v[56:59], v[204:207]
    v_mfma_f32_16x16x32_bf16 v[240:243], v[168:171], v[60:63], v[240:243]
    ds_read_b128 v[136:139], v12 offset:6144
    s_waitcnt lgkmcnt(9)
    v_mfma_f32_16x16x32_bf16 v[208:211], v[172:175], v[56:59], v[208:211]
    v_mfma_f32_16x16x32_bf16 v[244:247], v[172:175], v[60:63], v[244:247]
    ds_read_b128 v[140:143], v12 offset:7168
    s_waitcnt lgkmcnt(9)
    v_mfma_f32_16x16x32_bf16 v[212:215], v[176:179], v[56:59], v[212:215]
    v_mfma_f32_16x16x32_bf16 v[248:251], v[176:179], v[60:63], v[248:251]
    ds_read_b128 v[144:147], v12 offset:8192
    s_waitcnt lgkmcnt(9)
    v_mfma_f32_16x16x32_bf16 v[216:219], v[180:183], v[56:59], v[216:219]
    v_mfma_f32_16x16x32_bf16 v[252:255], v[180:183], v[60:63], v[252:255]
    s_barrier
    s_waitcnt vmcnt(0)
    s_waitcnt lgkmcnt(8)
    v_mfma_f32_16x16x32_bf16 v[184:187], v[112:115], v[64:67], v[184:187]
    v_mfma_f32_16x16x32_bf16 v[220:223], v[112:115], v[68:71], v[220:223]
    s_waitcnt lgkmcnt(7)
    v_mfma_f32_16x16x32_bf16 v[188:191], v[116:119], v[64:67], v[188:191]
    v_mfma_f32_16x16x32_bf16 v[224:227], v[116:119], v[68:71], v[224:227]
    s_waitcnt lgkmcnt(6)
    v_mfma_f32_16x16x32_bf16 v[192:195], v[120:123], v[64:67], v[192:195]
    v_mfma_f32_16x16x32_bf16 v[228:231], v[120:123], v[68:71], v[228:231]
    s_waitcnt lgkmcnt(5)
    v_mfma_f32_16x16x32_bf16 v[196:199], v[124:127], v[64:67], v[196:199]
    v_mfma_f32_16x16x32_bf16 v[232:235], v[124:127], v[68:71], v[232:235]
    s_waitcnt lgkmcnt(4)
    v_mfma_f32_16x16x32_bf16 v[200:203], v[128:131], v[64:67], v[200:203]
    v_mfma_f32_16x16x32_bf16 v[236:239], v[128:131], v[68:71], v[236:239]
    s_waitcnt lgkmcnt(3)
    v_mfma_f32_16x16x32_bf16 v[204:207], v[132:135], v[64:67], v[204:207]
    v_mfma_f32_16x16x32_bf16 v[240:243], v[132:135], v[68:71], v[240:243]
    s_waitcnt lgkmcnt(2)
    v_mfma_f32_16x16x32_bf16 v[208:211], v[136:139], v[64:67], v[208:211]
    v_mfma_f32_16x16x32_bf16 v[244:247], v[136:139], v[68:71], v[244:247]
    s_waitcnt lgkmcnt(1)
    v_mfma_f32_16x16x32_bf16 v[212:215], v[140:143], v[64:67], v[212:215]
    v_mfma_f32_16x16x32_bf16 v[248:251], v[140:143], v[68:71], v[248:251]
    s_waitcnt lgkmcnt(0)
    v_mfma_f32_16x16x32_bf16 v[216:219], v[144:147], v[64:67], v[216:219]
    v_mfma_f32_16x16x32_bf16 v[252:255], v[144:147], v[68:71], v[252:255]
    s_nop 7
    s_nop 1
    s_barrier
    s_cmp_eq_u32 s32, s35
    s_cbranch_scc1 K2_OWN
    s_add_u32 s50, s43, 0
    buffer_store_dwordx4 v[184:187], v8, s[16:19], s50 offen sc1
    s_add_u32 s50, s43, 1024
    buffer_store_dwordx4 v[188:191], v8, s[16:19], s50 offen sc1
    s_add_u32 s50, s43, 2048
    buffer_store_dwordx4 v[192:195], v8, s[16:19], s50 offen sc1
    s_add_u32 s50, s43, 3072
    buffer_store_dwordx4 v[196:199], v8, s[16:19], s50 offen sc1
    s_add_u32 s50, s43, 4096
    buffer_store_dwordx4 v[200:203], v8, s[16:19], s50 offen sc1
    s_add_u32 s50, s43, 5120
    buffer_store_dwordx4 v[204:207], v8, s[16:19], s50 offen sc1
    s_add_u32 s50, s43, 6144
    buffer_store_dwordx4 v[208:211], v8, s[16:19], s50 offen sc1
    s_add_u32 s50, s43, 7168
    buffer_store_dwordx4 v[212:215], v8, s[16:19], s50 offen sc1
    s_add_u32 s50, s43, 8192
    buffer_store_dwordx4 v[216:219], v8, s[16:19], s50 offen sc1
    s_add_u32 s50, s43, 36864
    buffer_store_dwordx4 v[220:223], v8, s[16:19], s50 offen sc1
    s_add_u32 s50, s43, 37888
    buffer_store_dwordx4 v[224:227], v8, s[16:19], s50 offen sc1
    s_add_u32 s50, s43, 38912
    buffer_store_dwordx4 v[228:231], v8, s[16:19], s50 offen sc1
    s_add_u32 s50, s43, 39936
    buffer_store_dwordx4 v[232:235], v8, s[16:19], s50 offen sc1
    s_add_u32 s50, s43, 40960
    buffer_store_dwordx4 v[236:239], v8, s[16:19], s50 offen sc1
    s_add_u32 s50, s43, 41984
    buffer_store_dwordx4 v[240:243], v8, s[16:19], s50 offen sc1
    s_add_u32 s50, s43, 43008
    buffer_store_dwordx4 v[244:247], v8, s[16:19], s50 offen sc1
    s_add_u32 s50, s43, 44032
    buffer_store_dwordx4 v[248:251], v8, s[16:19], s50 offen sc1
    s_add_u32 s50, s43, 45056
    buffer_store_dwordx4 v[252:255], v8, s[16:19], s50 offen sc1
    s_branch K2_OWN2
K2_OWN:
    ds_write_b128 v8, v[184:187] offset:0
    ds_write_b128 v8, v[188:191] offset:1024
    ds_write_b128 v8, v[192:195] offset:2048
    ds_write_b128 v8, v[196:199] offset:3072
    ds_write_b128 v8, v[200:203] offset:4096
    ds_write_b128 v8, v[204:207] offset:5120
    ds_write_b128 v8, v[208:211] offset:6144
    ds_write_b128 v8, v[212:215] offset:7168
    ds_write_b128 v8, v[216:219] offset:8192
    ds_write_b128 v8, v[220:223] offset:9216
    ds_write_b128 v8, v[224:227] offset:10240
    ds_write_b128 v8, v[228:231] offset:11264
    ds_write_b128 v8, v[232:235] offset:12288
    ds_write_b128 v8, v[236:239] offset:13312
    ds_write_b128 v8, v[240:243] offset:14336
    ds_write_b128 v8, v[244:247] offset:15360
    ds_write_b128 v8, v[248:251] offset:16384
    ds_write_b128 v8, v[252:255] offset:17408
K2_OWN2:
    s_load_dwordx2 s[4:5], s[0:1], 0
    s_load_dwordx2 s[6:7], s[0:1], 64
    s_load_dwordx2 s[28:29], s[0:1], 104
    s_add_u32 s24, s30, 66060288
    s_addc_u32 s25, s31, 0
    s_mov_b32 s26, 32768
    s_mov_b32 s27, 0x00020000
    s_lshl_b32 s60, s36, 2
    s_add_u32 s60, s60, s37
    s_lshl_b32 s60, s60, 9
    s_lshl_b32 s61, s35, 7
    s_add_u32 s61, s61, s60
    v_lshrrev_b32 v12, 4, v8
    v_lshrrev_b32 v13, 4, v12
    v_and_b32 v14, 15, v12
    v_lshlrev_b32 v9, 7, v12
    v_mov_b32 v10, 1
    v_mov_b32 v11, 0
    s_waitcnt vmcnt(0) lgkmcnt(0)
    s_barrier
    s_cmp_lg_u32 s32, 0
    s_cbranch_scc1 K2_NOSIG
    s_mov_b64 exec, 1
    buffer_store_dword v10, v11, s[24:27], s61 offen sc1
    s_mov_b64 exec, -1
K2_NOSIG:
    s_mov_b32 s20, s4
    s_mov_b32 s21, s5
    s_mov_b32 s22, 2359296
    s_mov_b32 s23, 0x00020000
    s_add_u32 s8, s30, 0
    s_addc_u32 s9, s31, 0
    s_mov_b32 s10, 2359296
    s_mov_b32 s11, 0x00020000
    s_mov_b32 s44, s6
    s_mov_b32 s45, s7
    s_mov_b32 s46, 1152
    s_mov_b32 s47, 0x00020000
    s_mov_b32 s48, s28
    s_mov_b32 s49, s29
    s_mov_b32 s50, 4718592
    s_mov_b32 s51, 0x00020000
    s_mov_b32 s53, 0xffff0000
    v_mul_u32_u24 v6, 0x12000, v14
    v_lshl_add_u32 v6, v13, 4, v6
    v_lshrrev_b32 v7, 1, v6
    v_lshlrev_b32 v15, 3, v13
    v_lshrrev_b32 v16, 1, v13
    v_lshlrev_b32 v16, 8, v16
    v_lshl_add_u32 v16, v14, 4, v16
    v_and_b32 v17, 1, v13
    v_lshl_add_u32 v16, v17, 3, v16
    s_mov_b32 s71, 0
    s_mov_b64 exec, 0xf
K2_POLL2:
    buffer_load_dword v10, v9, s[24:27], s60 offen sc1
    s_waitcnt vmcnt(0)
    v_cmp_ne_u32 vcc, 1, v10
    s_add_u32 s71, s71, 1
    s_cmp_ge_u32 s71, 1000000
    s_cbranch_scc1 K2_PD2
    s_cbranch_vccnz K2_POLL2
K2_PD2:
    s_mov_b64 exec, -1
    s_add_u32 s62, s32, 0
    s_min_u32 s62, s62, 17
    s_mul_i32 s63, s35, 18
    s_add_u32 s62, s62, s63
    s_mul_i32 s63, s62, 57
    s_lshr_b32 s63, s63, 9
    s_mul_i32 s64, s63, 9
    s_sub_u32 s64, s62, s64
    s_lshl_b32 s65, s36, 3
    s_add_u32 s65, s65, s63
    s_mul_i32 s66, s37, 9
    s_add_u32 s66, s66, s64
    s_mul_i32 s67, s65, 36
    s_add_u32 s67, s67, s66
    s_lshl_b32 s67, s67, 10
    s_lshr_b32 s68, s65, 5
    s_lshl_b32 s68, s68, 9
    s_and_b32 s69, s65, 31
    s_add_u32 s68, s68, s69
    s_mul_i32 s68, s68, 2304
    s_lshl_b32 s69, s66, 6
    s_add_u32 s72, s68, s69
    s_lshr_b32 s68, s72, 1
    s_lshl_b32 s69, s66, 5
    s_mul_i32 s70, s65, 18432
    s_lshl_b32 s71, s66, 9
    s_add_u32 s70, s70, s71
    s_add_u32 s43, s35, 1
    s_and_b32 s43, s43, 3
    s_mul_i32 s43, s43, 4718592
    s_add_u32 s43, s43, s67
    buffer_load_dwordx4 v[52:55], v8, s[16:19], s43 offen sc1
    s_add_u32 s43, s35, 2
    s_and_b32 s43, s43, 3
    s_mul_i32 s43, s43, 4718592
    s_add_u32 s43, s43, s67
    buffer_load_dwordx4 v[56:59], v8, s[16:19], s43 offen sc1
    s_add_u32 s43, s35, 3
    s_and_b32 s43, s43, 3
    s_mul_i32 s43, s43, 4718592
    s_add_u32 s43, s43, s67
    buffer_load_dwordx4 v[60:63], v8, s[16:19], s43 offen sc1
    s_add_u32 s43, s32, 0
    s_min_u32 s43, s43, 17
    s_lshl_b32 s43, s43, 10
    v_add_u32 v18, s43, v8
    ds_read_b128 v[48:51], v18
    buffer_load_dwordx2 v[64:65], v7, s[20:23], s68 offen
    buffer_load_dwordx2 v[66:67], v16, s[8:11], s70 offen
    buffer_load_dwordx2 v[68:69], v15, s[44:47], s69 offen
    s_add_u32 s62, s32, 4
    s_min_u32 s62, s62, 17
    s_mul_i32 s63, s35, 18
    s_add_u32 s62, s62, s63
    s_mul_i32 s63, s62, 57
    s_lshr_b32 s63, s63, 9
    s_mul_i32 s64, s63, 9
    s_sub_u32 s64, s62, s64
    s_lshl_b32 s65, s36, 3
    s_add_u32 s65, s65, s63
    s_mul_i32 s66, s37, 9
    s_add_u32 s66, s66, s64
    s_mul_i32 s67, s65, 36
    s_add_u32 s67, s67, s66
    s_lshl_b32 s67, s67, 10
    s_lshr_b32 s68, s65, 5
    s_lshl_b32 s68, s68, 9
    s_and_b32 s69, s65, 31
    s_add_u32 s68, s68, s69
    s_mul_i32 s68, s68, 2304
    s_lshl_b32 s69, s66, 6
    s_add_u32 s73, s68, s69
    s_lshr_b32 s68, s73, 1
    s_lshl_b32 s69, s66, 5
    s_mul_i32 s70, s65, 18432
    s_lshl_b32 s71, s66, 9
    s_add_u32 s70, s70, s71
    s_add_u32 s43, s35, 1
    s_and_b32 s43, s43, 3
    s_mul_i32 s43, s43, 4718592
    s_add_u32 s43, s43, s67
    buffer_load_dwordx4 v[76:79], v8, s[16:19], s43 offen sc1
    s_add_u32 s43, s35, 2
    s_and_b32 s43, s43, 3
    s_mul_i32 s43, s43, 4718592
    s_add_u32 s43, s43, s67
    buffer_load_dwordx4 v[80:83], v8, s[16:19], s43 offen sc1
    s_add_u32 s43, s35, 3
    s_and_b32 s43, s43, 3
    s_mul_i32 s43, s43, 4718592
    s_add_u32 s43, s43, s67
    buffer_load_dwordx4 v[84:87], v8, s[16:19], s43 offen sc1
    s_add_u32 s43, s32, 4
    s_min_u32 s43, s43, 17
    s_lshl_b32 s43, s43, 10
    v_add_u32 v18, s43, v8
    ds_read_b128 v[72:75], v18
    buffer_load_dwordx2 v[88:89], v7, s[20:23], s68 offen
    buffer_load_dwordx2 v[90:91], v16, s[8:11], s70 offen
    buffer_load_dwordx2 v[92:93], v15, s[44:47], s69 offen
    s_add_u32 s62, s32, 8
    s_min_u32 s62, s62, 17
    s_mul_i32 s63, s35, 18
    s_add_u32 s62, s62, s63
    s_mul_i32 s63, s62, 57
    s_lshr_b32 s63, s63, 9
    s_mul_i32 s64, s63, 9
    s_sub_u32 s64, s62, s64
    s_lshl_b32 s65, s36, 3
    s_add_u32 s65, s65, s63
    s_mul_i32 s66, s37, 9
    s_add_u32 s66, s66, s64
    s_mul_i32 s67, s65, 36
    s_add_u32 s67, s67, s66
    s_lshl_b32 s67, s67, 10
    s_lshr_b32 s68, s65, 5
    s_lshl_b32 s68, s68, 9
    s_and_b32 s69, s65, 31
    s_add_u32 s68, s68, s69
    s_mul_i32 s68, s68, 2304
    s_lshl_b32 s69, s66, 6
    s_add_u32 s74, s68, s69
    s_lshr_b32 s68, s74, 1
    s_lshl_b32 s69, s66, 5
    s_mul_i32 s70, s65, 18432
    s_lshl_b32 s71, s66, 9
    s_add_u32 s70, s70, s71
    s_add_u32 s43, s35, 1
    s_and_b32 s43, s43, 3
    s_mul_i32 s43, s43, 4718592
    s_add_u32 s43, s43, s67
    buffer_load_dwordx4 v[100:103], v8, s[16:19], s43 offen sc1
    s_add_u32 s43, s35, 2
    s_and_b32 s43, s43, 3
    s_mul_i32 s43, s43, 4718592
    s_add_u32 s43, s43, s67
    buffer_load_dwordx4 v[104:107], v8, s[16:19], s43 offen sc1
    s_add_u32 s43, s35, 3
    s_and_b32 s43, s43, 3
    s_mul_i32 s43, s43, 4718592
    s_add_u32 s43, s43, s67
    buffer_load_dwordx4 v[108:111], v8, s[16:19], s43 offen sc1
    s_add_u32 s43, s32, 8
    s_min_u32 s43, s43, 17
    s_lshl_b32 s43, s43, 10
    v_add_u32 v18, s43, v8
    ds_read_b128 v[96:99], v18
    buffer_load_dwordx2 v[112:113], v7, s[20:23], s68 offen
    buffer_load_dwordx2 v[114:115], v16, s[8:11], s70 offen
    buffer_load_dwordx2 v[116:117], v15, s[44:47], s69 offen
    s_add_u32 s62, s32, 12
    s_min_u32 s62, s62, 17
    s_mul_i32 s63, s35, 18
    s_add_u32 s62, s62, s63
    s_mul_i32 s63, s62, 57
    s_lshr_b32 s63, s63, 9
    s_mul_i32 s64, s63, 9
    s_sub_u32 s64, s62, s64
    s_lshl_b32 s65, s36, 3
    s_add_u32 s65, s65, s63
    s_mul_i32 s66, s37, 9
    s_add_u32 s66, s66, s64
    s_mul_i32 s67, s65, 36
    s_add_u32 s67, s67, s66
    s_lshl_b32 s67, s67, 10
    s_lshr_b32 s68, s65, 5
    s_lshl_b32 s68, s68, 9
    s_and_b32 s69, s65, 31
    s_add_u32 s68, s68, s69
    s_mul_i32 s68, s68, 2304
    s_lshl_b32 s69, s66, 6
    s_add_u32 s75, s68, s69
    s_lshr_b32 s68, s75, 1
    s_lshl_b32 s69, s66, 5
    s_mul_i32 s70, s65, 18432
    s_lshl_b32 s71, s66, 9
    s_add_u32 s70, s70, s71
    s_add_u32 s43, s35, 1
    s_and_b32 s43, s43, 3
    s_mul_i32 s43, s43, 4718592
    s_add_u32 s43, s43, s67
    buffer_load_dwordx4 v[124:127], v8, s[16:19], s43 offen sc1
    s_add_u32 s43, s35, 2
    s_and_b32 s43, s43, 3
    s_mul_i32 s43, s43, 4718592
    s_add_u32 s43, s43, s67
    buffer_load_dwordx4 v[128:131], v8, s[16:19], s43 offen sc1
    s_add_u32 s43, s35, 3
    s_and_b32 s43, s43, 3
    s_mul_i32 s43, s43, 4718592
    s_add_u32 s43, s43, s67
    buffer_load_dwordx4 v[132:135], v8, s[16:19], s43 offen sc1
    s_add_u32 s43, s32, 12
    s_min_u32 s43, s43, 17
    s_lshl_b32 s43, s43, 10
    v_add_u32 v18, s43, v8
    ds_read_b128 v[120:123], v18
    buffer_load_dwordx2 v[136:137], v7, s[20:23], s68 offen
    buffer_load_dwordx2 v[138:139], v16, s[8:11], s70 offen
    buffer_load_dwordx2 v[140:141], v15, s[44:47], s69 offen
    s_add_u32 s62, s32, 16
    s_min_u32 s62, s62, 17
    s_mul_i32 s63, s35, 18
    s_add_u32 s62, s62, s63
    s_mul_i32 s63, s62, 57
    s_lshr_b32 s63, s63, 9
    s_mul_i32 s64, s63, 9
    s_sub_u32 s64, s62, s64
    s_lshl_b32 s65, s36, 3
    s_add_u32 s65, s65, s63
    s_mul_i32 s66, s37, 9
    s_add_u32 s66, s66, s64
    s_mul_i32 s67, s65, 36
    s_add_u32 s67, s67, s66
    s_lshl_b32 s67, s67, 10
    s_lshr_b32 s68, s65, 5
    s_lshl_b32 s68, s68, 9
    s_and_b32 s69, s65, 31
    s_add_u32 s68, s68, s69
    s_mul_i32 s68, s68, 2304
    s_lshl_b32 s69, s66, 6
    s_add_u32 s76, s68, s69
    s_lshr_b32 s68, s76, 1
    s_lshl_b32 s69, s66, 5
    s_mul_i32 s70, s65, 18432
    s_lshl_b32 s71, s66, 9
    s_add_u32 s70, s70, s71
    s_add_u32 s43, s35, 1
    s_and_b32 s43, s43, 3
    s_mul_i32 s43, s43, 4718592
    s_add_u32 s43, s43, s67
    buffer_load_dwordx4 v[148:151], v8, s[16:19], s43 offen sc1
    s_add_u32 s43, s35, 2
    s_and_b32 s43, s43, 3
    s_mul_i32 s43, s43, 4718592
    s_add_u32 s43, s43, s67
    buffer_load_dwordx4 v[152:155], v8, s[16:19], s43 offen sc1
    s_add_u32 s43, s35, 3
    s_and_b32 s43, s43, 3
    s_mul_i32 s43, s43, 4718592
    s_add_u32 s43, s43, s67
    buffer_load_dwordx4 v[156:159], v8, s[16:19], s43 offen sc1
    s_add_u32 s43, s32, 16
    s_min_u32 s43, s43, 17
    s_lshl_b32 s43, s43, 10
    v_add_u32 v18, s43, v8
    ds_read_b128 v[144:147], v18
    buffer_load_dwordx2 v[160:161], v7, s[20:23], s68 offen
    buffer_load_dwordx2 v[162:163], v16, s[8:11], s70 offen
    buffer_load_dwordx2 v[164:165], v15, s[44:47], s69 offen
    s_waitcnt vmcnt(24) lgkmcnt(0)
    v_add_f32 v48, v48, v52
    v_add_f32 v56, v56, v60
    v_add_f32 v48, v48, v56
    v_add_f32 v49, v49, v53
    v_add_f32 v57, v57, v61
    v_add_f32 v49, v49, v57
    v_add_f32 v50, v50, v54
    v_add_f32 v58, v58, v62
    v_add_f32 v50, v50, v58
    v_add_f32 v51, v51, v55
    v_add_f32 v59, v59, v63
    v_add_f32 v51, v51, v59
    v_lshlrev_b32 v20, 16, v64
    v_and_b32 v21, s53, v64
    v_lshlrev_b32 v24, 16, v66
    v_and_b32 v25, s53, v66
    v_lshlrev_b32 v28, 16, v68
    v_and_b32 v29, s53, v68
    v_lshlrev_b32 v22, 16, v65
    v_and_b32 v23, s53, v65
    v_lshlrev_b32 v26, 16, v67
    v_and_b32 v27, s53, v67
    v_lshlrev_b32 v30, 16, v69
    v_and_b32 v31, s53, v69
    v_mul_f32 v24, v24, v28
    v_mul_f32 v25, v25, v29
    v_mul_f32 v26, v26, v30
    v_mul_f32 v27, v27, v31
    v_cvt_pk_bf16_f32 v32, v24, v25
    v_cvt_pk_bf16_f32 v33, v26, v27
    v_lshlrev_b32 v24, 16, v32
    v_and_b32 v25, s53, v32
    v_lshlrev_b32 v26, 16, v33
    v_and_b32 v27, s53, v33
    v_add_f32 v20, v20, v24
    v_add_f32 v56, v20, v48
    v_add_f32 v21, v21, v25
    v_add_f32 v57, v21, v49
    v_add_f32 v22, v22, v26
    v_add_f32 v58, v22, v50
    v_add_f32 v23, v23, v27
    v_add_f32 v59, v23, v51
    buffer_store_dwordx4 v[56:59], v6, s[48:51], s72 offen sc1
    s_waitcnt vmcnt(19) lgkmcnt(0)
    v_add_f32 v72, v72, v76
    v_add_f32 v80, v80, v84
    v_add_f32 v72, v72, v80
    v_add_f32 v73, v73, v77
    v_add_f32 v81, v81, v85
    v_add_f32 v73, v73, v81
    v_add_f32 v74, v74, v78
    v_add_f32 v82, v82, v86
    v_add_f32 v74, v74, v82
    v_add_f32 v75, v75, v79
    v_add_f32 v83, v83, v87
    v_add_f32 v75, v75, v83
    v_lshlrev_b32 v20, 16, v88
    v_and_b32 v21, s53, v88
    v_lshlrev_b32 v24, 16, v90
    v_and_b32 v25, s53, v90
    v_lshlrev_b32 v28, 16, v92
    v_and_b32 v29, s53, v92
    v_lshlrev_b32 v22, 16, v89
    v_and_b32 v23, s53, v89
    v_lshlrev_b32 v26, 16, v91
    v_and_b32 v27, s53, v91
    v_lshlrev_b32 v30, 16, v93
    v_and_b32 v31, s53, v93
    v_mul_f32 v24, v24, v28
    v_mul_f32 v25, v25, v29
    v_mul_f32 v26, v26, v30
    v_mul_f32 v27, v27, v31
    v_cvt_pk_bf16_f32 v32, v24, v25
    v_cvt_pk_bf16_f32 v33, v26, v27
    v_lshlrev_b32 v24, 16, v32
    v_and_b32 v25, s53, v32
    v_lshlrev_b32 v26, 16, v33
    v_and_b32 v27, s53, v33
    v_add_f32 v20, v20, v24
    v_add_f32 v80, v20, v72
    v_add_f32 v21, v21, v25
    v_add_f32 v81, v21, v73
    v_add_f32 v22, v22, v26
    v_add_f32 v82, v22, v74
    v_add_f32 v23, v23, v27
    v_add_f32 v83, v23, v75
    buffer_store_dwordx4 v[80:83], v6, s[48:51], s73 offen sc1
    s_waitcnt vmcnt(14) lgkmcnt(0)
    v_add_f32 v96, v96, v100
    v_add_f32 v104, v104, v108
    v_add_f32 v96, v96, v104
    v_add_f32 v97, v97, v101
    v_add_f32 v105, v105, v109
    v_add_f32 v97, v97, v105
    v_add_f32 v98, v98, v102
    v_add_f32 v106, v106, v110
    v_add_f32 v98, v98, v106
    v_add_f32 v99, v99, v103
    v_add_f32 v107, v107, v111
    v_add_f32 v99, v99, v107
    v_lshlrev_b32 v20, 16, v112
    v_and_b32 v21, s53, v112
    v_lshlrev_b32 v24, 16, v114
    v_and_b32 v25, s53, v114
    v_lshlrev_b32 v28, 16, v116
    v_and_b32 v29, s53, v116
    v_lshlrev_b32 v22, 16, v113
    v_and_b32 v23, s53, v113
    v_lshlrev_b32 v26, 16, v115
    v_and_b32 v27, s53, v115
    v_lshlrev_b32 v30, 16, v117
    v_and_b32 v31, s53, v117
    v_mul_f32 v24, v24, v28
    v_mul_f32 v25, v25, v29
    v_mul_f32 v26, v26, v30
    v_mul_f32 v27, v27, v31
    v_cvt_pk_bf16_f32 v32, v24, v25
    v_cvt_pk_bf16_f32 v33, v26, v27
    v_lshlrev_b32 v24, 16, v32
    v_and_b32 v25, s53, v32
    v_lshlrev_b32 v26, 16, v33
    v_and_b32 v27, s53, v33
    v_add_f32 v20, v20, v24
    v_add_f32 v104, v20, v96
    v_add_f32 v21, v21, v25
    v_add_f32 v105, v21, v97
    v_add_f32 v22, v22, v26
    v_add_f32 v106, v22, v98
    v_add_f32 v23, v23, v27
    v_add_f32 v107, v23, v99
    buffer_store_dwordx4 v[104:107], v6, s[48:51], s74 offen sc1
    s_waitcnt vmcnt(9) lgkmcnt(0)
    v_add_f32 v120, v120, v124
    v_add_f32 v128, v128, v132
    v_add_f32 v120, v120, v128
    v_add_f32 v121, v121, v125
    v_add_f32 v129, v129, v133
    v_add_f32 v121, v121, v129
    v_add_f32 v122, v122, v126
    v_add_f32 v130, v130, v134
    v_add_f32 v122, v122, v130
    v_add_f32 v123, v123, v127
    v_add_f32 v131, v131, v135
    v_add_f32 v123, v123, v131
    v_lshlrev_b32 v20, 16, v136
    v_and_b32 v21, s53, v136
    v_lshlrev_b32 v24, 16, v138
    v_and_b32 v25, s53, v138
    v_lshlrev_b32 v28, 16, v140
    v_and_b32 v29, s53, v140
    v_lshlrev_b32 v22, 16, v137
    v_and_b32 v23, s53, v137
    v_lshlrev_b32 v26, 16, v139
    v_and_b32 v27, s53, v139
    v_lshlrev_b32 v30, 16, v141
    v_and_b32 v31, s53, v141
    v_mul_f32 v24, v24, v28
    v_mul_f32 v25, v25, v29
    v_mul_f32 v26, v26, v30
    v_mul_f32 v27, v27, v31
    v_cvt_pk_bf16_f32 v32, v24, v25
    v_cvt_pk_bf16_f32 v33, v26, v27
    v_lshlrev_b32 v24, 16, v32
    v_and_b32 v25, s53, v32
    v_lshlrev_b32 v26, 16, v33
    v_and_b32 v27, s53, v33
    v_add_f32 v20, v20, v24
    v_add_f32 v128, v20, v120
    v_add_f32 v21, v21, v25
    v_add_f32 v129, v21, v121
    v_add_f32 v22, v22, v26
    v_add_f32 v130, v22, v122
    v_add_f32 v23, v23, v27
    v_add_f32 v131, v23, v123
    buffer_store_dwordx4 v[128:131], v6, s[48:51], s75 offen sc1
    s_cmp_ge_u32 s32, 2
    s_cbranch_scc1 K2_END
    s_waitcnt vmcnt(4) lgkmcnt(0)
    v_add_f32 v144, v144, v148
    v_add_f32 v152, v152, v156
    v_add_f32 v144, v144, v152
    v_add_f32 v145, v145, v149
    v_add_f32 v153, v153, v157
    v_add_f32 v145, v145, v153
    v_add_f32 v146, v146, v150
    v_add_f32 v154, v154, v158
    v_add_f32 v146, v146, v154
    v_add_f32 v147, v147, v151
    v_add_f32 v155, v155, v159
    v_add_f32 v147, v147, v155
    v_lshlrev_b32 v20, 16, v160
    v_and_b32 v21, s53, v160
    v_lshlrev_b32 v24, 16, v162
    v_and_b32 v25, s53, v162
    v_lshlrev_b32 v28, 16, v164
    v_and_b32 v29, s53, v164
    v_lshlrev_b32 v22, 16, v161
    v_and_b32 v23, s53, v161
    v_lshlrev_b32 v26, 16, v163
    v_and_b32 v27, s53, v163
    v_lshlrev_b32 v30, 16, v165
    v_and_b32 v31, s53, v165
    v_mul_f32 v24, v24, v28
    v_mul_f32 v25, v25, v29
    v_mul_f32 v26, v26, v30
    v_mul_f32 v27, v27, v31
    v_cvt_pk_bf16_f32 v32, v24, v25
    v_cvt_pk_bf16_f32 v33, v26, v27
    v_lshlrev_b32 v24, 16, v32
    v_and_b32 v25, s53, v32
    v_lshlrev_b32 v26, 16, v33
    v_and_b32 v27, s53, v33
    v_add_f32 v20, v20, v24
    v_add_f32 v152, v20, v144
    v_add_f32 v21, v21, v25
    v_add_f32 v153, v21, v145
    v_add_f32 v22, v22, v26
    v_add_f32 v154, v22, v146
    v_add_f32 v23, v23, v27
    v_add_f32 v155, v23, v147
    buffer_store_dwordx4 v[152:155], v6, s[48:51], s76 offen sc1
    s_endpgm
K2_SCAN:
    s_waitcnt lgkmcnt(0)
    s_add_u32 s8, s30, 29360128
    s_addc_u32 s9, s31, 0
    s_mov_b32 s10, 9437184
    s_mov_b32 s11, 0x00020000
    s_add_u32 s12, s30, 39845888
    s_addc_u32 s13, s31, 0
    s_mov_b32 s14, 4718592
    s_mov_b32 s15, 0x00020000
    s_mov_b32 s16, s52
    s_mov_b32 s17, s53
    s_mov_b32 s18, 1152
    s_mov_b32 s19, 0x00020000
    s_mov_b32 s20, s54
    s_mov_b32 s21, s55
    s_mov_b32 s22, 1152
    s_mov_b32 s23, 0x00020000
    s_mov_b32 s24, s56
    s_mov_b32 s25, s57
    s_mov_b32 s26, 1152
    s_mov_b32 s27, 0x00020000
    s_lshr_b32 s33, s2, 1
    s_and_b32 s39, s2, 1
    v_and_b32 v1, 63, v0
    v_bfe_u32 v2, v1, 4, 1
    v_and_b32 v3, 15, v1
    v_lshrrev_b32 v19, 5, v1
    s_lshl_b32 s34, s2, 3
    v_lshl_add_u32 v4, v2, 2, s34
    buffer_load_dword v5, v4, s[16:19], 0 offen
    buffer_load_dword v6, v4, s[20:23], 0 offen
    buffer_load_dword v7, v4, s[24:27], 0 offen
    s_lshl_b32 s35, s39, 9
    s_mov_b32 s36, 1179648
    v_mul_lo_u32 v8, v19, s36
    v_lshl_add_u32 v8, v3, 4, v8
    v_lshl_add_u32 v8, v2, 8, v8
    v_add_u32 v8, s35, v8
    s_mul_i32 s34, s32, 32*72
    s_add_u32 s34, s34, s33
    s_lshl_b32 s34, s34, 10
    buffer_load_dwordx4 v[128:131], v8, s[8:11], s34 offen
    s_add_u32 s34, s34, 73728
    buffer_load_dwordx4 v[132:135], v8, s[8:11], s34 offen
    s_add_u32 s34, s34, 73728
    buffer_load_dwordx4 v[136:139], v8, s[8:11], s34 offen
    s_add_u32 s34, s34, 73728
    buffer_load_dwordx4 v[140:143], v8, s[8:11], s34 offen
    s_add_u32 s34, s34, 73728
    buffer_load_dwordx4 v[144:147], v8, s[8:11], s34 offen
    s_add_u32 s34, s34, 73728
    buffer_load_dwordx4 v[148:151], v8, s[8:11], s34 offen
    s_add_u32 s34, s34, 73728
    buffer_load_dwordx4 v[152:155], v8, s[8:11], s34 offen
    s_add_u32 s34, s34, 73728
    buffer_load_dwordx4 v[156:159], v8, s[8:11], s34 offen
    s_add_u32 s34, s34, 73728
    buffer_load_dwordx4 v[160:163], v8, s[8:11], s34 offen
    s_add_u32 s34, s34, 73728
    buffer_load_dwordx4 v[164:167], v8, s[8:11], s34 offen
    s_add_u32 s34, s34, 73728
    buffer_load_dwordx4 v[168:171], v8, s[8:11], s34 offen
    s_add_u32 s34, s34, 73728
    buffer_load_dwordx4 v[172:175], v8, s[8:11], s34 offen
    s_add_u32 s34, s34, 73728
    buffer_load_dwordx4 v[176:179], v8, s[8:11], s34 offen
    s_add_u32 s34, s34, 73728
    buffer_load_dwordx4 v[180:183], v8, s[8:11], s34 offen
    s_add_u32 s34, s34, 73728
    buffer_load_dwordx4 v[184:187], v8, s[8:11], s34 offen
    s_add_u32 s34, s34, 73728
    buffer_load_dwordx4 v[188:191], v8, s[8:11], s34 offen
    s_add_u32 s34, s34, 73728
    s_and_b32 s35, s2, 3
    s_lshl_b32 s35, s35, 8
    s_mov_b32 s36, 589824
    v_mul_lo_u32 v9, v19, s36
    v_lshl_add_u32 v9, v3, 4, v9
    v_lshl_add_u32 v9, v2, 3, v9
    v_add_u32 v9, s35, v9
    s_mul_i32 s35, s32, 32*36
    s_lshr_b32 s36, s33, 1
    s_add_u32 s35, s35, s36
    s_lshl_b32 s35, s35, 10
    s_mov_b32 s37, 0xffff0000
    s_waitcnt vmcnt(16)
    v_lshlrev_b32 v11, 16, v5
    v_lshlrev_b32 v12, 16, v6
    v_lshlrev_b32 v13, 16, v7
    v_mul_f32 v13, 0x3fb8aa3b, v13
    v_exp_f32 v13, v13
    s_nop 0
    v_cvt_pk_bf16_f32 v13, v13, v13
    v_lshlrev_b32 v13, 16, v13
    v_mul_f32 v14, v13, v11
    v_mul_f32 v15, v13, v12
    v_mul_f32 v14, 0x3fb8aa3b, v14
    v_exp_f32 v14, v14
    v_mul_f32 v15, 0.15915494, v15
    v_fract_f32 v15, v15
    v_sin_f32 v16, v15
    v_cos_f32 v17, v15
    s_nop 0
    v_mul_f32 v20, v14, v17
    v_mul_f32 v21, v14, v16
    v_add_f32 v16, -1.0, v20
    v_mul_f32 v17, v11, v11
    v_fma_f32 v17, v12, v12, v17
    v_rcp_f32 v18, v17
    v_mul_f32 v22, v16, v11
    v_fma_f32 v22, v21, v12, v22
    v_mul_f32 v23, v21, v11
    v_fma_f32 v23, -v16, v12, v23
    v_add_f32 v18, v18, v18
    v_mul_f32 v22, v22, v18
    v_mul_f32 v23, v23, v18
    v_mov_b32 v24, v20
    v_mov_b32 v25, v21
    v_mul_f32 v16, v25, v25
    v_mul_f32 v17, v24, v25
    v_fma_f32 v16, v24, v24, -v16
    v_fma_f32 v25, v25, v24, v17
    v_mov_b32 v24, v16
    v_mul_f32 v16, v25, v25
    v_mul_f32 v17, v24, v25
    v_fma_f32 v16, v24, v24, -v16
    v_fma_f32 v25, v25, v24, v17
    v_mov_b32 v24, v16
    v_mul_f32 v16, v25, v25
    v_mul_f32 v17, v24, v25
    v_fma_f32 v16, v24, v24, -v16
    v_fma_f32 v25, v25, v24, v17
    v_mov_b32 v24, v16
    v_mul_f32 v16, v25, v25
    v_mul_f32 v17, v24, v25
    v_fma_f32 v16, v24, v24, -v16
    v_fma_f32 v25, v25, v24, v17
    v_mov_b32 v24, v16
    v_and_b32 v11, s37, v5
    v_and_b32 v12, s37, v6
    v_and_b32 v13, s37, v7
    v_mul_f32 v13, 0x3fb8aa3b, v13
    v_exp_f32 v13, v13
    s_nop 0
    v_cvt_pk_bf16_f32 v13, v13, v13
    v_lshlrev_b32 v13, 16, v13
    v_mul_f32 v14, v13, v11
    v_mul_f32 v15, v13, v12
    v_mul_f32 v14, 0x3fb8aa3b, v14
    v_exp_f32 v14, v14
    v_mul_f32 v15, 0.15915494, v15
    v_fract_f32 v15, v15
    v_sin_f32 v16, v15
    v_cos_f32 v17, v15
    s_nop 0
    v_mul_f32 v28, v14, v17
    v_mul_f32 v29, v14, v16
    v_add_f32 v16, -1.0, v28
    v_mul_f32 v17, v11, v11
    v_fma_f32 v17, v12, v12, v17
    v_rcp_f32 v18, v17
    v_mul_f32 v30, v16, v11
    v_fma_f32 v30, v29, v12, v30
    v_mul_f32 v31, v29, v11
    v_fma_f32 v31, -v16, v12, v31
    v_add_f32 v18, v18, v18
    v_mul_f32 v30, v30, v18
    v_mul_f32 v31, v31, v18
    v_mov_b32 v32, v28
    v_mov_b32 v33, v29
    v_mul_f32 v16, v33, v33
    v_mul_f32 v17, v32, v33
    v_fma_f32 v16, v32, v32, -v16
    v_fma_f32 v33, v33, v32, v17
    v_mov_b32 v32, v16
    v_mul_f32 v16, v33, v33
    v_mul_f32 v17, v32, v33
    v_fma_f32 v16, v32, v32, -v16
    v_fma_f32 v33, v33, v32, v17
    v_mov_b32 v32, v16
    v_mul_f32 v16, v33, v33
    v_mul_f32 v17, v32, v33
    v_fma_f32 v16, v32, v32, -v16
    v_fma_f32 v33, v33, v32, v17
    v_mov_b32 v32, v16
    v_mul_f32 v16, v33, v33
    v_mul_f32 v17, v32, v33
    v_fma_f32 v16, v32, v32, -v16
    v_fma_f32 v33, v33, v32, v17
    v_mov_b32 v32, v16
    v_mov_b32 v36, 0
    v_mov_b32 v37, 0
    v_mov_b32 v38, 0
    v_mov_b32 v39, 0
    s_waitcnt vmcnt(15)
    v_pk_fma_f32 v[40:41], v[20:21], v[36:37], v[128:129] op_sel:[0,0,0] op_sel_hi:[0,1,1]
    v_pk_fma_f32 v[36:37], v[20:21], v[36:37], v[40:41] op_sel:[1,1,0] op_sel_hi:[1,0,1] neg_lo:[1,0,0]
    v_pk_fma_f32 v[42:43], v[28:29], v[38:39], v[130:131] op_sel:[0,0,0] op_sel_hi:[0,1,1]
    v_pk_fma_f32 v[38:39], v[28:29], v[38:39], v[42:43] op_sel:[1,1,0] op_sel_hi:[1,0,1] neg_lo:[1,0,0]
    s_waitcnt vmcnt(14)
    v_pk_fma_f32 v[40:41], v[20:21], v[36:37], v[132:133] op_sel:[0,0,0] op_sel_hi:[0,1,1]
    v_pk_fma_f32 v[36:37], v[20:21], v[36:37], v[40:41] op_sel:[1,1,0] op_sel_hi:[1,0,1] neg_lo:[1,0,0]
    v_pk_fma_f32 v[42:43], v[28:29], v[38:39], v[134:135] op_sel:[0,0,0] op_sel_hi:[0,1,1]
    v_pk_fma_f32 v[38:39], v[28:29], v[38:39], v[42:43] op_sel:[1,1,0] op_sel_hi:[1,0,1] neg_lo:[1,0,0]
    s_waitcnt vmcnt(13)
    v_pk_fma_f32 v[40:41], v[20:21], v[36:37], v[136:137] op_sel:[0,0,0] op_sel_hi:[0,1,1]
    v_pk_fma_f32 v[36:37], v[20:21], v[36:37], v[40:41] op_sel:[1,1,0] op_sel_hi:[1,0,1] neg_lo:[1,0,0]
    v_pk_fma_f32 v[42:43], v[28:29], v[38:39], v[138:139] op_sel:[0,0,0] op_sel_hi:[0,1,1]
    v_pk_fma_f32 v[38:39], v[28:29], v[38:39], v[42:43] op_sel:[1,1,0] op_sel_hi:[1,0,1] neg_lo:[1,0,0]
    s_waitcnt vmcnt(12)
    v_pk_fma_f32 v[40:41], v[20:21], v[36:37], v[140:141] op_sel:[0,0,0] op_sel_hi:[0,1,1]
    v_pk_fma_f32 v[36:37], v[20:21], v[36:37], v[40:41] op_sel:[1,1,0] op_sel_hi:[1,0,1] neg_lo:[1,0,0]
    v_pk_fma_f32 v[42:43], v[28:29], v[38:39], v[142:143] op_sel:[0,0,0] op_sel_hi:[0,1,1]
    v_pk_fma_f32 v[38:39], v[28:29], v[38:39], v[42:43] op_sel:[1,1,0] op_sel_hi:[1,0,1] neg_lo:[1,0,0]
    s_waitcnt vmcnt(11)
    v_pk_fma_f32 v[40:41], v[20:21], v[36:37], v[144:145] op_sel:[0,0,0] op_sel_hi:[0,1,1]
    v_pk_fma_f32 v[36:37], v[20:21], v[36:37], v[40:41] op_sel:[1,1,0] op_sel_hi:[1,0,1] neg_lo:[1,0,0]
    v_pk_fma_f32 v[42:43], v[28:29], v[38:39], v[146:147] op_sel:[0,0,0] op_sel_hi:[0,1,1]
    v_pk_fma_f32 v[38:39], v[28:29], v[38:39], v[42:43] op_sel:[1,1,0] op_sel_hi:[1,0,1] neg_lo:[1,0,0]
    s_waitcnt vmcnt(10)
    v_pk_fma_f32 v[40:41], v[20:21], v[36:37], v[148:149] op_sel:[0,0,0] op_sel_hi:[0,1,1]
    v_pk_fma_f32 v[36:37], v[20:21], v[36:37], v[40:41] op_sel:[1,1,0] op_sel_hi:[1,0,1] neg_lo:[1,0,0]
    v_pk_fma_f32 v[42:43], v[28:29], v[38:39], v[150:151] op_sel:[0,0,0] op_sel_hi:[0,1,1]
    v_pk_fma_f32 v[38:39], v[28:29], v[38:39], v[42:43] op_sel:[1,1,0] op_sel_hi:[1,0,1] neg_lo:[1,0,0]
    s_waitcnt vmcnt(9)
    v_pk_fma_f32 v[40:41], v[20:21], v[36:37], v[152:153] op_sel:[0,0,0] op_sel_hi:[0,1,1]
    v_pk_fma_f32 v[36:37], v[20:21], v[36:37], v[40:41] op_sel:[1,1,0] op_sel_hi:[1,0,1] neg_lo:[1,0,0]
    v_pk_fma_f32 v[42:43], v[28:29], v[38:39], v[154:155] op_sel:[0,0,0] op_sel_hi:[0,1,1]
    v_pk_fma_f32 v[38:39], v[28:29], v[38:39], v[42:43] op_sel:[1,1,0] op_sel_hi:[1,0,1] neg_lo:[1,0,0]
    s_waitcnt vmcnt(8)
    v_pk_fma_f32 v[40:41], v[20:21], v[36:37], v[156:157] op_sel:[0,0,0] op_sel_hi:[0,1,1]
    v_pk_fma_f32 v[36:37], v[20:21], v[36:37], v[40:41] op_sel:[1,1,0] op_sel_hi:[1,0,1] neg_lo:[1,0,0]
    v_pk_fma_f32 v[42:43], v[28:29], v[38:39], v[158:159] op_sel:[0,0,0] op_sel_hi:[0,1,1]
    v_pk_fma_f32 v[38:39], v[28:29], v[38:39], v[42:43] op_sel:[1,1,0] op_sel_hi:[1,0,1] neg_lo:[1,0,0]
    s_waitcnt vmcnt(7)
    v_pk_fma_f32 v[40:41], v[20:21], v[36:37], v[160:161] op_sel:[0,0,0] op_sel_hi:[0,1,1]
    v_pk_fma_f32 v[36:37], v[20:21], v[36:37], v[40:41] op_sel:[1,1,0] op_sel_hi:[1,0,1] neg_lo:[1,0,0]
    v_pk_fma_f32 v[42:43], v[28:29], v[38:39], v[162:163] op_sel:[0,0,0] op_sel_hi:[0,1,1]
    v_pk_fma_f32 v[38:39], v[28:29], v[38:39], v[42:43] op_sel:[1,1,0] op_sel_hi:[1,0,1] neg_lo:[1,0,0]
    s_waitcnt vmcnt(6)
    v_pk_fma_f32 v[40:41], v[20:21], v[36:37], v[164:165] op_sel:[0,0,0] op_sel_hi:[0,1,1]
    v_pk_fma_f32 v[36:37], v[20:21], v[36:37], v[40:41] op_sel:[1,1,0] op_sel_hi:[1,0,1] neg_lo:[1,0,0]
    v_pk_fma_f32 v[42:43], v[28:29], v[38:39], v[166:167] op_sel:[0,0,0] op_sel_hi:[0,1,1]
    v_pk_fma_f32 v[38:39], v[28:29], v[38:39], v[42:43] op_sel:[1,1,0] op_sel_hi:[1,0,1] neg_lo:[1,0,0]
    s_waitcnt vmcnt(5)
    v_pk_fma_f32 v[40:41], v[20:21], v[36:37], v[168:169] op_sel:[0,0,0] op_sel_hi:[0,1,1]
    v_pk_fma_f32 v[36:37], v[20:21], v[36:37], v[40:41] op_sel:[1,1,0] op_sel_hi:[1,0,1] neg_lo:[1,0,0]
    v_pk_fma_f32 v[42:43], v[28:29], v[38:39], v[170:171] op_sel:[0,0,0] op_sel_hi:[0,1,1]
    v_pk_fma_f32 v[38:39], v[28:29], v[38:39], v[42:43] op_sel:[1,1,0] op_sel_hi:[1,0,1] neg_lo:[1,0,0]
    s_waitcnt vmcnt(4)
    v_pk_fma_f32 v[40:41], v[20:21], v[36:37], v[172:173] op_sel:[0,0,0] op_sel_hi:[0,1,1]
    v_pk_fma_f32 v[36:37], v[20:21], v[36:37], v[40:41] op_sel:[1,1,0] op_sel_hi:[1,0,1] neg_lo:[1,0,0]
    v_pk_fma_f32 v[42:43], v[28:29], v[38:39], v[174:175] op_sel:[0,0,0] op_sel_hi:[0,1,1]
    v_pk_fma_f32 v[38:39], v[28:29], v[38:39], v[42:43] op_sel:[1,1,0] op_sel_hi:[1,0,1] neg_lo:[1,0,0]
    s_waitcnt vmcnt(3)
    v_pk_fma_f32 v[40:41], v[20:21], v[36:37], v[176:177] op_sel:[0,0,0] op_sel_hi:[0,1,1]
    v_pk_fma_f32 v[36:37], v[20:21], v[36:37], v[40:41] op_sel:[1,1,0] op_sel_hi:[1,0,1] neg_lo:[1,0,0]
    v_pk_fma_f32 v[42:43], v[28:29], v[38:39], v[178:179] op_sel:[0,0,0] op_sel_hi:[0,1,1]
    v_pk_fma_f32 v[38:39], v[28:29], v[38:39], v[42:43] op_sel:[1,1,0] op_sel_hi:[1,0,1] neg_lo:[1,0,0]
    s_waitcnt vmcnt(2)
    v_pk_fma_f32 v[40:41], v[20:21], v[36:37], v[180:181] op_sel:[0,0,0] op_sel_hi:[0,1,1]
    v_pk_fma_f32 v[36:37], v[20:21], v[36:37], v[40:41] op_sel:[1,1,0] op_sel_hi:[1,0,1] neg_lo:[1,0,0]
    v_pk_fma_f32 v[42:43], v[28:29], v[38:39], v[182:183] op_sel:[0,0,0] op_sel_hi:[0,1,1]
    v_pk_fma_f32 v[38:39], v[28:29], v[38:39], v[42:43] op_sel:[1,1,0] op_sel_hi:[1,0,1] neg_lo:[1,0,0]
    s_waitcnt vmcnt(1)
    v_pk_fma_f32 v[40:41], v[20:21], v[36:37], v[184:185] op_sel:[0,0,0] op_sel_hi:[0,1,1]
    v_pk_fma_f32 v[36:37], v[20:21], v[36:37], v[40:41] op_sel:[1,1,0] op_sel_hi:[1,0,1] neg_lo:[1,0,0]
    v_pk_fma_f32 v[42:43], v[28:29], v[38:39], v[186:187] op_sel:[0,0,0] op_sel_hi:[0,1,1]
    v_pk_fma_f32 v[38:39], v[28:29], v[38:39], v[42:43] op_sel:[1,1,0] op_sel_hi:[1,0,1] neg_lo:[1,0,0]
    s_waitcnt vmcnt(0)
    v_pk_fma_f32 v[40:41], v[20:21], v[36:37], v[188:189] op_sel:[0,0,0] op_sel_hi:[0,1,1]
    v_pk_fma_f32 v[36:37], v[20:21], v[36:37], v[40:41] op_sel:[1,1,0] op_sel_hi:[1,0,1] neg_lo:[1,0,0]
    v_pk_fma_f32 v[42:43], v[28:29], v[38:39], v[190:191] op_sel:[0,0,0] op_sel_hi:[0,1,1]
    v_pk_fma_f32 v[38:39], v[28:29], v[38:39], v[42:43] op_sel:[1,1,0] op_sel_hi:[1,0,1] neg_lo:[1,0,0]
    v_xor_b32 v62, 32, v1
    v_lshlrev_b32 v62, 2, v62
    ds_bpermute_b32 v88, v62, v36
    ds_bpermute_b32 v89, v62, v37
    ds_bpermute_b32 v90, v62, v38
    ds_bpermute_b32 v91, v62, v39
    v_cmp_ne_u32 vcc, 0, v19
    s_waitcnt lgkmcnt(0)
    v_cndmask_b32 v92, v36, v88, vcc
    v_cndmask_b32 v96, v88, v36, vcc
    v_cndmask_b32 v93, v37, v89, vcc
    v_cndmask_b32 v97, v89, v37, vcc
    v_cndmask_b32 v94, v38, v90, vcc
    v_cndmask_b32 v98, v90, v38, vcc
    v_cndmask_b32 v95, v39, v91, vcc
    v_cndmask_b32 v99, v91, v39, vcc
    v_pk_fma_f32 v[58:59], v[24:25], v[92:93], v[96:97] op_sel:[0,0,0] op_sel_hi:[0,1,1]
    v_pk_fma_f32 v[36:37], v[24:25], v[92:93], v[58:59] op_sel:[1,1,0] op_sel_hi:[1,0,1] neg_lo:[1,0,0]
    v_pk_fma_f32 v[58:59], v[32:33], v[94:95], v[98:99] op_sel:[0,0,0] op_sel_hi:[0,1,1]
    v_pk_fma_f32 v[38:39], v[32:33], v[94:95], v[58:59] op_sel:[1,1,0] op_sel_hi:[1,0,1] neg_lo:[1,0,0]
    v_mov_b32 v46, v24
    v_mov_b32 v47, v25
    v_mul_f32 v60, v47, v47
    v_mul_f32 v61, v46, v47
    v_fma_f32 v60, v46, v46, -v60
    v_fma_f32 v47, v47, v46, v61
    v_mov_b32 v46, v60
    v_mov_b32 v50, 1.0
    v_mov_b32 v51, 0
    v_mov_b32 v48, v32
    v_mov_b32 v49, v33
    v_mul_f32 v60, v49, v49
    v_mul_f32 v61, v48, v49
    v_fma_f32 v60, v48, v48, -v60
    v_fma_f32 v49, v49, v48, v61
    v_mov_b32 v48, v60
    v_mov_b32 v52, 1.0
    v_mov_b32 v53, 0
    v_mov_b32 v100, 0
    v_mov_b32 v101, 0
    v_mov_b32 v54, 0
    v_mov_b32 v55, 0
    v_mov_b32 v56, 0
    v_mov_b32 v57, 0
    s_nop 1
    v_mov_b32_dpp v54, v36 row_shr:1 row_mask:0xf bank_mask:0xf
    v_mov_b32_dpp v55, v37 row_shr:1 row_mask:0xf bank_mask:0xf
    v_mov_b32_dpp v56, v38 row_shr:1 row_mask:0xf bank_mask:0xf
    v_mov_b32_dpp v57, v39 row_shr:1 row_mask:0xf bank_mask:0xf
    v_and_b32 v62, 1, v3
    v_cmp_ne_u32 s[42:43], 0, v62
    v_pk_fma_f32 v[58:59], v[46:47], v[54:55], v[36:37] op_sel:[0,0,0] op_sel_hi:[0,1,1]
    v_pk_fma_f32 v[36:37], v[46:47], v[54:55], v[58:59] op_sel:[1,1,0] op_sel_hi:[1,0,1] neg_lo:[1,0,0]
    v_pk_fma_f32 v[58:59], v[46:47], v[50:51], v[100:101] op_sel:[0,0,0] op_sel_hi:[0,1,1]
    v_pk_fma_f32 v[60:61], v[46:47], v[50:51], v[58:59] op_sel:[1,1,0] op_sel_hi:[1,0,1] neg_lo:[1,0,0]
    v_cndmask_b32 v50, v50, v60, s[42:43]
    v_cndmask_b32 v51, v51, v61, s[42:43]
    v_pk_fma_f32 v[58:59], v[46:47], v[46:47], v[100:101] op_sel:[0,0,0] op_sel_hi:[0,1,1]
    v_pk_fma_f32 v[46:47], v[46:47], v[46:47], v[58:59] op_sel:[1,1,0] op_sel_hi:[1,0,1] neg_lo:[1,0,0]
    v_pk_fma_f32 v[58:59], v[48:49], v[56:57], v[38:39] op_sel:[0,0,0] op_sel_hi:[0,1,1]
    v_pk_fma_f32 v[38:39], v[48:49], v[56:57], v[58:59] op_sel:[1,1,0] op_sel_hi:[1,0,1] neg_lo:[1,0,0]
    v_pk_fma_f32 v[58:59], v[48:49], v[52:53], v[100:101] op_sel:[0,0,0] op_sel_hi:[0,1,1]
    v_pk_fma_f32 v[60:61], v[48:49], v[52:53], v[58:59] op_sel:[1,1,0] op_sel_hi:[1,0,1] neg_lo:[1,0,0]
    v_cndmask_b32 v52, v52, v60, s[42:43]
    v_cndmask_b32 v53, v53, v61, s[42:43]
    v_pk_fma_f32 v[58:59], v[48:49], v[48:49], v[100:101] op_sel:[0,0,0] op_sel_hi:[0,1,1]
    v_pk_fma_f32 v[48:49], v[48:49], v[48:49], v[58:59] op_sel:[1,1,0] op_sel_hi:[1,0,1] neg_lo:[1,0,0]
    v_mov_b32 v54, 0
    v_mov_b32 v55, 0
    v_mov_b32 v56, 0
    v_mov_b32 v57, 0
    s_nop 1
    v_mov_b32_dpp v54, v36 row_shr:2 row_mask:0xf bank_mask:0xf
    v_mov_b32_dpp v55, v37 row_shr:2 row_mask:0xf bank_mask:0xf
    v_mov_b32_dpp v56, v38 row_shr:2 row_mask:0xf bank_mask:0xf
    v_mov_b32_dpp v57, v39 row_shr:2 row_mask:0xf bank_mask:0xf
    v_and_b32 v62, 2, v3
    v_cmp_ne_u32 s[42:43], 0, v62
    v_pk_fma_f32 v[58:59], v[46:47], v[54:55], v[36:37] op_sel:[0,0,0] op_sel_hi:[0,1,1]
    v_pk_fma_f32 v[36:37], v[46:47], v[54:55], v[58:59] op_sel:[1,1,0] op_sel_hi:[1,0,1] neg_lo:[1,0,0]
    v_pk_fma_f32 v[58:59], v[46:47], v[50:51], v[100:101] op_sel:[0,0,0] op_sel_hi:[0,1,1]
    v_pk_fma_f32 v[60:61], v[46:47], v[50:51], v[58:59] op_sel:[1,1,0] op_sel_hi:[1,0,1] neg_lo:[1,0,0]
    v_cndmask_b32 v50, v50, v60, s[42:43]
    v_cndmask_b32 v51, v51, v61, s[42:43]
    v_pk_fma_f32 v[58:59], v[46:47], v[46:47], v[100:101] op_sel:[0,0,0] op_sel_hi:[0,1,1]
    v_pk_fma_f32 v[46:47], v[46:47], v[46:47], v[58:59] op_sel:[1,1,0] op_sel_hi:[1,0,1] neg_lo:[1,0,0]
    v_pk_fma_f32 v[58:59], v[48:49], v[56:57], v[38:39] op_sel:[0,0,0] op_sel_hi:[0,1,1]
    v_pk_fma_f32 v[38:39], v[48:49], v[56:57], v[58:59] op_sel:[1,1,0] op_sel_hi:[1,0,1] neg_lo:[1,0,0]
    v_pk_fma_f32 v[58:59], v[48:49], v[52:53], v[100:101] op_sel:[0,0,0] op_sel_hi:[0,1,1]
    v_pk_fma_f32 v[60:61], v[48:49], v[52:53], v[58:59] op_sel:[1,1,0] op_sel_hi:[1,0,1] neg_lo:[1,0,0]
    v_cndmask_b32 v52, v52, v60, s[42:43]
    v_cndmask_b32 v53, v53, v61, s[42:43]
    v_pk_fma_f32 v[58:59], v[48:49], v[48:49], v[100:101] op_sel:[0,0,0] op_sel_hi:[0,1,1]
    v_pk_fma_f32 v[48:49], v[48:49], v[48:49], v[58:59] op_sel:[1,1,0] op_sel_hi:[1,0,1] neg_lo:[1,0,0]
    v_mov_b32 v54, 0
    v_mov_b32 v55, 0
    v_mov_b32 v56, 0
    v_mov_b32 v57, 0
    s_nop 1
    v_mov_b32_dpp v54, v36 row_shr:4 row_mask:0xf bank_mask:0xf
    v_mov_b32_dpp v55, v37 row_shr:4 row_mask:0xf bank_mask:0xf
    v_mov_b32_dpp v56, v38 row_shr:4 row_mask:0xf bank_mask:0xf
    v_mov_b32_dpp v57, v39 row_shr:4 row_mask:0xf bank_mask:0xf
    v_and_b32 v62, 4, v3
    v_cmp_ne_u32 s[42:43], 0, v62
    v_pk_fma_f32 v[58:59], v[46:47], v[54:55], v[36:37] op_sel:[0,0,0] op_sel_hi:[0,1,1]
    v_pk_fma_f32 v[36:37], v[46:47], v[54:55], v[58:59] op_sel:[1,1,0] op_sel_hi:[1,0,1] neg_lo:[1,0,0]
    v_pk_fma_f32 v[58:59], v[46:47], v[50:51], v[100:101] op_sel:[0,0,0] op_sel_hi:[0,1,1]
    v_pk_fma_f32 v[60:61], v[46:47], v[50:51], v[58:59] op_sel:[1,1,0] op_sel_hi:[1,0,1] neg_lo:[1,0,0]
    v_cndmask_b32 v50, v50, v60, s[42:43]
    v_cndmask_b32 v51, v51, v61, s[42:43]
    v_pk_fma_f32 v[58:59], v[46:47], v[46:47], v[100:101] op_sel:[0,0,0] op_sel_hi:[0,1,1]
    v_pk_fma_f32 v[46:47], v[46:47], v[46:47], v[58:59] op_sel:[1,1,0] op_sel_hi:[1,0,1] neg_lo:[1,0,0]
    v_pk_fma_f32 v[58:59], v[48:49], v[56:57], v[38:39] op_sel:[0,0,0] op_sel_hi:[0,1,1]
    v_pk_fma_f32 v[38:39], v[48:49], v[56:57], v[58:59] op_sel:[1,1,0] op_sel_hi:[1,0,1] neg_lo:[1,0,0]
    v_pk_fma_f32 v[58:59], v[48:49], v[52:53], v[100:101] op_sel:[0,0,0] op_sel_hi:[0,1,1]
    v_pk_fma_f32 v[60:61], v[48:49], v[52:53], v[58:59] op_sel:[1,1,0] op_sel_hi:[1,0,1] neg_lo:[1,0,0]
    v_cndmask_b32 v52, v52, v60, s[42:43]
    v_cndmask_b32 v53, v53, v61, s[42:43]
    v_pk_fma_f32 v[58:59], v[48:49], v[48:49], v[100:101] op_sel:[0,0,0] op_sel_hi:[0,1,1]
    v_pk_fma_f32 v[48:49], v[48:49], v[48:49], v[58:59] op_sel:[1,1,0] op_sel_hi:[1,0,1] neg_lo:[1,0,0]
    v_mov_b32 v54, 0
    v_mov_b32 v55, 0
    v_mov_b32 v56, 0
    v_mov_b32 v57, 0
    s_nop 1
    v_mov_b32_dpp v54, v36 row_shr:8 row_mask:0xf bank_mask:0xf
    v_mov_b32_dpp v55, v37 row_shr:8 row_mask:0xf bank_mask:0xf
    v_mov_b32_dpp v56, v38 row_shr:8 row_mask:0xf bank_mask:0xf
    v_mov_b32_dpp v57, v39 row_shr:8 row_mask:0xf bank_mask:0xf
    v_and_b32 v62, 8, v3
    v_cmp_ne_u32 s[42:43], 0, v62
    v_pk_fma_f32 v[58:59], v[46:47], v[54:55], v[36:37] op_sel:[0,0,0] op_sel_hi:[0,1,1]
    v_pk_fma_f32 v[36:37], v[46:47], v[54:55], v[58:59] op_sel:[1,1,0] op_sel_hi:[1,0,1] neg_lo:[1,0,0]
    v_pk_fma_f32 v[58:59], v[46:47], v[50:51], v[100:101] op_sel:[0,0,0] op_sel_hi:[0,1,1]
    v_pk_fma_f32 v[60:61], v[46:47], v[50:51], v[58:59] op_sel:[1,1,0] op_sel_hi:[1,0,1] neg_lo:[1,0,0]
    v_cndmask_b32 v50, v50, v60, s[42:43]
    v_cndmask_b32 v51, v51, v61, s[42:43]
    v_pk_fma_f32 v[58:59], v[46:47], v[46:47], v[100:101] op_sel:[0,0,0] op_sel_hi:[0,1,1]
    v_pk_fma_f32 v[46:47], v[46:47], v[46:47], v[58:59] op_sel:[1,1,0] op_sel_hi:[1,0,1] neg_lo:[1,0,0]
    v_pk_fma_f32 v[58:59], v[48:49], v[56:57], v[38:39] op_sel:[0,0,0] op_sel_hi:[0,1,1]
    v_pk_fma_f32 v[38:39], v[48:49], v[56:57], v[58:59] op_sel:[1,1,0] op_sel_hi:[1,0,1] neg_lo:[1,0,0]
    v_pk_fma_f32 v[58:59], v[48:49], v[52:53], v[100:101] op_sel:[0,0,0] op_sel_hi:[0,1,1]
    v_pk_fma_f32 v[60:61], v[48:49], v[52:53], v[58:59] op_sel:[1,1,0] op_sel_hi:[1,0,1] neg_lo:[1,0,0]
    v_cndmask_b32 v52, v52, v60, s[42:43]
    v_cndmask_b32 v53, v53, v61, s[42:43]
    v_pk_fma_f32 v[58:59], v[48:49], v[48:49], v[100:101] op_sel:[0,0,0] op_sel_hi:[0,1,1]
    v_pk_fma_f32 v[48:49], v[48:49], v[48:49], v[58:59] op_sel:[1,1,0] op_sel_hi:[1,0,1] neg_lo:[1,0,0]
    v_cmp_eq_u32 s[40:41], 15, v3
    s_nop 3
    s_mov_b32 s41, 0
    s_lshl_b32 s38, s32, 5
    v_lshl_add_u32 v62, v2, 4, s38
    s_and_saveexec_b64 s[44:45], s[40:41]
    ds_write_b128 v62, v[36:39]
    s_mov_b64 exec, s[44:45]
    v_mov_b32 v54, 0
    v_mov_b32 v55, 0
    v_mov_b32 v56, 0
    v_mov_b32 v57, 0
    s_nop 1
    v_mov_b32_dpp v54, v36 row_shr:1 row_mask:0xf bank_mask:0xf
    v_mov_b32_dpp v55, v37 row_shr:1 row_mask:0xf bank_mask:0xf
    v_mov_b32_dpp v56, v38 row_shr:1 row_mask:0xf bank_mask:0xf
    v_mov_b32_dpp v57, v39 row_shr:1 row_mask:0xf bank_mask:0xf
    s_waitcnt lgkmcnt(0)
    s_barrier
    v_lshlrev_b32 v62, 4, v2
    ds_read_b128 v[64:67], v62 offset:0
    ds_read_b128 v[68:71], v62 offset:32
    ds_read_b128 v[72:75], v62 offset:64
    v_mov_b32 v36, 0
    v_mov_b32 v37, 0
    v_mov_b32 v38, 0
    v_mov_b32 v39, 0
    s_waitcnt lgkmcnt(0)
    s_cmp_le_u32 s32, 0
    s_cbranch_scc1 K2_CDONE
    v_pk_fma_f32 v[58:59], v[46:47], v[36:37], v[64:65] op_sel:[0,0,0] op_sel_hi:[0,1,1]
    v_pk_fma_f32 v[36:37], v[46:47], v[36:37], v[58:59] op_sel:[1,1,0] op_sel_hi:[1,0,1] neg_lo:[1,0,0]
    v_pk_fma_f32 v[58:59], v[48:49], v[38:39], v[66:67] op_sel:[0,0,0] op_sel_hi:[0,1,1]
    v_pk_fma_f32 v[38:39], v[48:49], v[38:39], v[58:59] op_sel:[1,1,0] op_sel_hi:[1,0,1] neg_lo:[1,0,0]
    s_cmp_le_u32 s32, 1
    s_cbranch_scc1 K2_CDONE
    v_pk_fma_f32 v[58:59], v[46:47], v[36:37], v[68:69] op_sel:[0,0,0] op_sel_hi:[0,1,1]
    v_pk_fma_f32 v[36:37], v[46:47], v[36:37], v[58:59] op_sel:[1,1,0] op_sel_hi:[1,0,1] neg_lo:[1,0,0]
    v_pk_fma_f32 v[58:59], v[48:49], v[38:39], v[70:71] op_sel:[0,0,0] op_sel_hi:[0,1,1]
    v_pk_fma_f32 v[38:39], v[48:49], v[38:39], v[58:59] op_sel:[1,1,0] op_sel_hi:[1,0,1] neg_lo:[1,0,0]
    s_cmp_le_u32 s32, 2
    s_cbranch_scc1 K2_CDONE
    v_pk_fma_f32 v[58:59], v[46:47], v[36:37], v[72:73] op_sel:[0,0,0] op_sel_hi:[0,1,1]
    v_pk_fma_f32 v[36:37], v[46:47], v[36:37], v[58:59] op_sel:[1,1,0] op_sel_hi:[1,0,1] neg_lo:[1,0,0]
    v_pk_fma_f32 v[58:59], v[48:49], v[38:39], v[74:75] op_sel:[0,0,0] op_sel_hi:[0,1,1]
    v_pk_fma_f32 v[38:39], v[48:49], v[38:39], v[58:59] op_sel:[1,1,0] op_sel_hi:[1,0,1] neg_lo:[1,0,0]
K2_CDONE:
    v_pk_fma_f32 v[58:59], v[50:51], v[36:37], v[54:55] op_sel:[0,0,0] op_sel_hi:[0,1,1]
    v_pk_fma_f32 v[36:37], v[50:51], v[36:37], v[58:59] op_sel:[1,1,0] op_sel_hi:[1,0,1] neg_lo:[1,0,0]
    v_pk_fma_f32 v[58:59], v[24:25], v[36:37], v[92:93] op_sel:[0,0,0] op_sel_hi:[0,1,1]
    v_pk_fma_f32 v[60:61], v[24:25], v[36:37], v[58:59] op_sel:[1,1,0] op_sel_hi:[1,0,1] neg_lo:[1,0,0]
    v_cndmask_b32 v36, v36, v60, vcc
    v_cndmask_b32 v37, v37, v61, vcc
    v_pk_fma_f32 v[58:59], v[52:53], v[38:39], v[56:57] op_sel:[0,0,0] op_sel_hi:[0,1,1]
    v_pk_fma_f32 v[38:39], v[52:53], v[38:39], v[58:59] op_sel:[1,1,0] op_sel_hi:[1,0,1] neg_lo:[1,0,0]
    v_pk_fma_f32 v[58:59], v[32:33], v[38:39], v[94:95] op_sel:[0,0,0] op_sel_hi:[0,1,1]
    v_pk_fma_f32 v[60:61], v[32:33], v[38:39], v[58:59] op_sel:[1,1,0] op_sel_hi:[1,0,1] neg_lo:[1,0,0]
    v_cndmask_b32 v38, v38, v60, vcc
    v_cndmask_b32 v39, v39, v61, vcc
    v_pk_fma_f32 v[40:41], v[20:21], v[36:37], v[128:129] op_sel:[0,0,0] op_sel_hi:[0,1,1]
    v_pk_fma_f32 v[36:37], v[20:21], v[36:37], v[40:41] op_sel:[1,1,0] op_sel_hi:[1,0,1] neg_lo:[1,0,0]
    v_pk_mul_f32 v[84:85], v[22:23], v[36:37] op_sel:[0,0] op_sel_hi:[0,1] neg_hi:[1,0]
    v_pk_fma_f32 v[84:85], v[22:23], v[36:37], v[84:85] op_sel:[1,1,0] op_sel_hi:[1,0,1] neg_lo:[1,0,0] neg_hi:[1,0,0]
    v_cvt_pk_bf16_f32 v76, v84, v85
    v_pk_fma_f32 v[42:43], v[28:29], v[38:39], v[130:131] op_sel:[0,0,0] op_sel_hi:[0,1,1]
    v_pk_fma_f32 v[38:39], v[28:29], v[38:39], v[42:43] op_sel:[1,1,0] op_sel_hi:[1,0,1] neg_lo:[1,0,0]
    v_pk_mul_f32 v[86:87], v[30:31], v[38:39] op_sel:[0,0] op_sel_hi:[0,1] neg_hi:[1,0]
    v_pk_fma_f32 v[86:87], v[30:31], v[38:39], v[86:87] op_sel:[1,1,0] op_sel_hi:[1,0,1] neg_lo:[1,0,0] neg_hi:[1,0,0]
    v_cvt_pk_bf16_f32 v77, v86, v87
    buffer_store_dwordx2 v[76:77], v9, s[12:15], s35 offen sc1
    s_add_u32 s35, s35, 36864
    v_pk_fma_f32 v[40:41], v[20:21], v[36:37], v[132:133] op_sel:[0,0,0] op_sel_hi:[0,1,1]
    v_pk_fma_f32 v[36:37], v[20:21], v[36:37], v[40:41] op_sel:[1,1,0] op_sel_hi:[1,0,1] neg_lo:[1,0,0]
    v_pk_mul_f32 v[84:85], v[22:23], v[36:37] op_sel:[0,0] op_sel_hi:[0,1] neg_hi:[1,0]
    v_pk_fma_f32 v[84:85], v[22:23], v[36:37], v[84:85] op_sel:[1,1,0] op_sel_hi:[1,0,1] neg_lo:[1,0,0] neg_hi:[1,0,0]
    v_cvt_pk_bf16_f32 v78, v84, v85
    v_pk_fma_f32 v[42:43], v[28:29], v[38:39], v[134:135] op_sel:[0,0,0] op_sel_hi:[0,1,1]
    v_pk_fma_f32 v[38:39], v[28:29], v[38:39], v[42:43] op_sel:[1,1,0] op_sel_hi:[1,0,1] neg_lo:[1,0,0]
    v_pk_mul_f32 v[86:87], v[30:31], v[38:39] op_sel:[0,0] op_sel_hi:[0,1] neg_hi:[1,0]
    v_pk_fma_f32 v[86:87], v[30:31], v[38:39], v[86:87] op_sel:[1,1,0] op_sel_hi:[1,0,1] neg_lo:[1,0,0] neg_hi:[1,0,0]
    v_cvt_pk_bf16_f32 v79, v86, v87
    buffer_store_dwordx2 v[78:79], v9, s[12:15], s35 offen sc1
    s_add_u32 s35, s35, 36864
    v_pk_fma_f32 v[40:41], v[20:21], v[36:37], v[136:137] op_sel:[0,0,0] op_sel_hi:[0,1,1]
    v_pk_fma_f32 v[36:37], v[20:21], v[36:37], v[40:41] op_sel:[1,1,0] op_sel_hi:[1,0,1] neg_lo:[1,0,0]
    v_pk_mul_f32 v[84:85], v[22:23], v[36:37] op_sel:[0,0] op_sel_hi:[0,1] neg_hi:[1,0]
    v_pk_fma_f32 v[84:85], v[22:23], v[36:37], v[84:85] op_sel:[1,1,0] op_sel_hi:[1,0,1] neg_lo:[1,0,0] neg_hi:[1,0,0]
    v_cvt_pk_bf16_f32 v80, v84, v85
    v_pk_fma_f32 v[42:43], v[28:29], v[38:39], v[138:139] op_sel:[0,0,0] op_sel_hi:[0,1,1]
    v_pk_fma_f32 v[38:39], v[28:29], v[38:39], v[42:43] op_sel:[1,1,0] op_sel_hi:[1,0,1] neg_lo:[1,0,0]
    v_pk_mul_f32 v[86:87], v[30:31], v[38:39] op_sel:[0,0] op_sel_hi:[0,1] neg_hi:[1,0]
    v_pk_fma_f32 v[86:87], v[30:31], v[38:39], v[86:87] op_sel:[1,1,0] op_sel_hi:[1,0,1] neg_lo:[1,0,0] neg_hi:[1,0,0]
    v_cvt_pk_bf16_f32 v81, v86, v87
    buffer_store_dwordx2 v[80:81], v9, s[12:15], s35 offen sc1
    s_add_u32 s35, s35, 36864
    v_pk_fma_f32 v[40:41], v[20:21], v[36:37], v[140:141] op_sel:[0,0,0] op_sel_hi:[0,1,1]
    v_pk_fma_f32 v[36:37], v[20:21], v[36:37], v[40:41] op_sel:[1,1,0] op_sel_hi:[1,0,1] neg_lo:[1,0,0]
    v_pk_mul_f32 v[84:85], v[22:23], v[36:37] op_sel:[0,0] op_sel_hi:[0,1] neg_hi:[1,0]
    v_pk_fma_f32 v[84:85], v[22:23], v[36:37], v[84:85] op_sel:[1,1,0] op_sel_hi:[1,0,1] neg_lo:[1,0,0] neg_hi:[1,0,0]
    v_cvt_pk_bf16_f32 v82, v84, v85
    v_pk_fma_f32 v[42:43], v[28:29], v[38:39], v[142:143] op_sel:[0,0,0] op_sel_hi:[0,1,1]
    v_pk_fma_f32 v[38:39], v[28:29], v[38:39], v[42:43] op_sel:[1,1,0] op_sel_hi:[1,0,1] neg_lo:[1,0,0]
    v_pk_mul_f32 v[86:87], v[30:31], v[38:39] op_sel:[0,0] op_sel_hi:[0,1] neg_hi:[1,0]
    v_pk_fma_f32 v[86:87], v[30:31], v[38:39], v[86:87] op_sel:[1,1,0] op_sel_hi:[1,0,1] neg_lo:[1,0,0] neg_hi:[1,0,0]
    v_cvt_pk_bf16_f32 v83, v86, v87
    buffer_store_dwordx2 v[82:83], v9, s[12:15], s35 offen sc1
    s_add_u32 s35, s35, 36864
    v_pk_fma_f32 v[40:41], v[20:21], v[36:37], v[144:145] op_sel:[0,0,0] op_sel_hi:[0,1,1]
    v_pk_fma_f32 v[36:37], v[20:21], v[36:37], v[40:41] op_sel:[1,1,0] op_sel_hi:[1,0,1] neg_lo:[1,0,0]
    v_pk_mul_f32 v[84:85], v[22:23], v[36:37] op_sel:[0,0] op_sel_hi:[0,1] neg_hi:[1,0]
    v_pk_fma_f32 v[84:85], v[22:23], v[36:37], v[84:85] op_sel:[1,1,0] op_sel_hi:[1,0,1] neg_lo:[1,0,0] neg_hi:[1,0,0]
    v_cvt_pk_bf16_f32 v76, v84, v85
    v_pk_fma_f32 v[42:43], v[28:29], v[38:39], v[146:147] op_sel:[0,0,0] op_sel_hi:[0,1,1]
    v_pk_fma_f32 v[38:39], v[28:29], v[38:39], v[42:43] op_sel:[1,1,0] op_sel_hi:[1,0,1] neg_lo:[1,0,0]
    v_pk_mul_f32 v[86:87], v[30:31], v[38:39] op_sel:[0,0] op_sel_hi:[0,1] neg_hi:[1,0]
    v_pk_fma_f32 v[86:87], v[30:31], v[38:39], v[86:87] op_sel:[1,1,0] op_sel_hi:[1,0,1] neg_lo:[1,0,0] neg_hi:[1,0,0]
    v_cvt_pk_bf16_f32 v77, v86, v87
    buffer_store_dwordx2 v[76:77], v9, s[12:15], s35 offen sc1
    s_add_u32 s35, s35, 36864
    v_pk_fma_f32 v[40:41], v[20:21], v[36:37], v[148:149] op_sel:[0,0,0] op_sel_hi:[0,1,1]
    v_pk_fma_f32 v[36:37], v[20:21], v[36:37], v[40:41] op_sel:[1,1,0] op_sel_hi:[1,0,1] neg_lo:[1,0,0]
    v_pk_mul_f32 v[84:85], v[22:23], v[36:37] op_sel:[0,0] op_sel_hi:[0,1] neg_hi:[1,0]
    v_pk_fma_f32 v[84:85], v[22:23], v[36:37], v[84:85] op_sel:[1,1,0] op_sel_hi:[1,0,1] neg_lo:[1,0,0] neg_hi:[1,0,0]
    v_cvt_pk_bf16_f32 v78, v84, v85
    v_pk_fma_f32 v[42:43], v[28:29], v[38:39], v[150:151] op_sel:[0,0,0] op_sel_hi:[0,1,1]
    v_pk_fma_f32 v[38:39], v[28:29], v[38:39], v[42:43] op_sel:[1,1,0] op_sel_hi:[1,0,1] neg_lo:[1,0,0]
    v_pk_mul_f32 v[86:87], v[30:31], v[38:39] op_sel:[0,0] op_sel_hi:[0,1] neg_hi:[1,0]
    v_pk_fma_f32 v[86:87], v[30:31], v[38:39], v[86:87] op_sel:[1,1,0] op_sel_hi:[1,0,1] neg_lo:[1,0,0] neg_hi:[1,0,0]
    v_cvt_pk_bf16_f32 v79, v86, v87
    buffer_store_dwordx2 v[78:79], v9, s[12:15], s35 offen sc1
    s_add_u32 s35, s35, 36864
    v_pk_fma_f32 v[40:41], v[20:21], v[36:37], v[152:153] op_sel:[0,0,0] op_sel_hi:[0,1,1]
    v_pk_fma_f32 v[36:37], v[20:21], v[36:37], v[40:41] op_sel:[1,1,0] op_sel_hi:[1,0,1] neg_lo:[1,0,0]
    v_pk_mul_f32 v[84:85], v[22:23], v[36:37] op_sel:[0,0] op_sel_hi:[0,1] neg_hi:[1,0]
    v_pk_fma_f32 v[84:85], v[22:23], v[36:37], v[84:85] op_sel:[1,1,0] op_sel_hi:[1,0,1] neg_lo:[1,0,0] neg_hi:[1,0,0]
    v_cvt_pk_bf16_f32 v80, v84, v85
    v_pk_fma_f32 v[42:43], v[28:29], v[38:39], v[154:155] op_sel:[0,0,0] op_sel_hi:[0,1,1]
    v_pk_fma_f32 v[38:39], v[28:29], v[38:39], v[42:43] op_sel:[1,1,0] op_sel_hi:[1,0,1] neg_lo:[1,0,0]
    v_pk_mul_f32 v[86:87], v[30:31], v[38:39] op_sel:[0,0] op_sel_hi:[0,1] neg_hi:[1,0]
    v_pk_fma_f32 v[86:87], v[30:31], v[38:39], v[86:87] op_sel:[1,1,0] op_sel_hi:[1,0,1] neg_lo:[1,0,0] neg_hi:[1,0,0]
    v_cvt_pk_bf16_f32 v81, v86, v87
    buffer_store_dwordx2 v[80:81], v9, s[12:15], s35 offen sc1
    s_add_u32 s35, s35, 36864
    v_pk_fma_f32 v[40:41], v[20:21], v[36:37], v[156:157] op_sel:[0,0,0] op_sel_hi:[0,1,1]
    v_pk_fma_f32 v[36:37], v[20:21], v[36:37], v[40:41] op_sel:[1,1,0] op_sel_hi:[1,0,1] neg_lo:[1,0,0]
    v_pk_mul_f32 v[84:85], v[22:23], v[36:37] op_sel:[0,0] op_sel_hi:[0,1] neg_hi:[1,0]
    v_pk_fma_f32 v[84:85], v[22:23], v[36:37], v[84:85] op_sel:[1,1,0] op_sel_hi:[1,0,1] neg_lo:[1,0,0] neg_hi:[1,0,0]
    v_cvt_pk_bf16_f32 v82, v84, v85
    v_pk_fma_f32 v[42:43], v[28:29], v[38:39], v[158:159] op_sel:[0,0,0] op_sel_hi:[0,1,1]
    v_pk_fma_f32 v[38:39], v[28:29], v[38:39], v[42:43] op_sel:[1,1,0] op_sel_hi:[1,0,1] neg_lo:[1,0,0]
    v_pk_mul_f32 v[86:87], v[30:31], v[38:39] op_sel:[0,0] op_sel_hi:[0,1] neg_hi:[1,0]
    v_pk_fma_f32 v[86:87], v[30:31], v[38:39], v[86:87] op_sel:[1,1,0] op_sel_hi:[1,0,1] neg_lo:[1,0,0] neg_hi:[1,0,0]
    v_cvt_pk_bf16_f32 v83, v86, v87
    buffer_store_dwordx2 v[82:83], v9, s[12:15], s35 offen sc1
    s_add_u32 s35, s35, 36864
    v_pk_fma_f32 v[40:41], v[20:21], v[36:37], v[160:161] op_sel:[0,0,0] op_sel_hi:[0,1,1]
    v_pk_fma_f32 v[36:37], v[20:21], v[36:37], v[40:41] op_sel:[1,1,0] op_sel_hi:[1,0,1] neg_lo:[1,0,0]
    v_pk_mul_f32 v[84:85], v[22:23], v[36:37] op_sel:[0,0] op_sel_hi:[0,1] neg_hi:[1,0]
    v_pk_fma_f32 v[84:85], v[22:23], v[36:37], v[84:85] op_sel:[1,1,0] op_sel_hi:[1,0,1] neg_lo:[1,0,0] neg_hi:[1,0,0]
    v_cvt_pk_bf16_f32 v76, v84, v85
    v_pk_fma_f32 v[42:43], v[28:29], v[38:39], v[162:163] op_sel:[0,0,0] op_sel_hi:[0,1,1]
    v_pk_fma_f32 v[38:39], v[28:29], v[38:39], v[42:43] op_sel:[1,1,0] op_sel_hi:[1,0,1] neg_lo:[1,0,0]
    v_pk_mul_f32 v[86:87], v[30:31], v[38:39] op_sel:[0,0] op_sel_hi:[0,1] neg_hi:[1,0]
    v_pk_fma_f32 v[86:87], v[30:31], v[38:39], v[86:87] op_sel:[1,1,0] op_sel_hi:[1,0,1] neg_lo:[1,0,0] neg_hi:[1,0,0]
    v_cvt_pk_bf16_f32 v77, v86, v87
    buffer_store_dwordx2 v[76:77], v9, s[12:15], s35 offen sc1
    s_add_u32 s35, s35, 36864
    v_pk_fma_f32 v[40:41], v[20:21], v[36:37], v[164:165] op_sel:[0,0,0] op_sel_hi:[0,1,1]
    v_pk_fma_f32 v[36:37], v[20:21], v[36:37], v[40:41] op_sel:[1,1,0] op_sel_hi:[1,0,1] neg_lo:[1,0,0]
    v_pk_mul_f32 v[84:85], v[22:23], v[36:37] op_sel:[0,0] op_sel_hi:[0,1] neg_hi:[1,0]
    v_pk_fma_f32 v[84:85], v[22:23], v[36:37], v[84:85] op_sel:[1,1,0] op_sel_hi:[1,0,1] neg_lo:[1,0,0] neg_hi:[1,0,0]
    v_cvt_pk_bf16_f32 v78, v84, v85
    v_pk_fma_f32 v[42:43], v[28:29], v[38:39], v[166:167] op_sel:[0,0,0] op_sel_hi:[0,1,1]
    v_pk_fma_f32 v[38:39], v[28:29], v[38:39], v[42:43] op_sel:[1,1,0] op_sel_hi:[1,0,1] neg_lo:[1,0,0]
    v_pk_mul_f32 v[86:87], v[30:31], v[38:39] op_sel:[0,0] op_sel_hi:[0,1] neg_hi:[1,0]
    v_pk_fma_f32 v[86:87], v[30:31], v[38:39], v[86:87] op_sel:[1,1,0] op_sel_hi:[1,0,1] neg_lo:[1,0,0] neg_hi:[1,0,0]
    v_cvt_pk_bf16_f32 v79, v86, v87
    buffer_store_dwordx2 v[78:79], v9, s[12:15], s35 offen sc1
    s_add_u32 s35, s35, 36864
    v_pk_fma_f32 v[40:41], v[20:21], v[36:37], v[168:169] op_sel:[0,0,0] op_sel_hi:[0,1,1]
    v_pk_fma_f32 v[36:37], v[20:21], v[36:37], v[40:41] op_sel:[1,1,0] op_sel_hi:[1,0,1] neg_lo:[1,0,0]
    v_pk_mul_f32 v[84:85], v[22:23], v[36:37] op_sel:[0,0] op_sel_hi:[0,1] neg_hi:[1,0]
    v_pk_fma_f32 v[84:85], v[22:23], v[36:37], v[84:85] op_sel:[1,1,0] op_sel_hi:[1,0,1] neg_lo:[1,0,0] neg_hi:[1,0,0]
    v_cvt_pk_bf16_f32 v80, v84, v85
    v_pk_fma_f32 v[42:43], v[28:29], v[38:39], v[170:171] op_sel:[0,0,0] op_sel_hi:[0,1,1]
    v_pk_fma_f32 v[38:39], v[28:29], v[38:39], v[42:43] op_sel:[1,1,0] op_sel_hi:[1,0,1] neg_lo:[1,0,0]
    v_pk_mul_f32 v[86:87], v[30:31], v[38:39] op_sel:[0,0] op_sel_hi:[0,1] neg_hi:[1,0]
    v_pk_fma_f32 v[86:87], v[30:31], v[38:39], v[86:87] op_sel:[1,1,0] op_sel_hi:[1,0,1] neg_lo:[1,0,0] neg_hi:[1,0,0]
    v_cvt_pk_bf16_f32 v81, v86, v87
    buffer_store_dwordx2 v[80:81], v9, s[12:15], s35 offen sc1
    s_add_u32 s35, s35, 36864
    v_pk_fma_f32 v[40:41], v[20:21], v[36:37], v[172:173] op_sel:[0,0,0] op_sel_hi:[0,1,1]
    v_pk_fma_f32 v[36:37], v[20:21], v[36:37], v[40:41] op_sel:[1,1,0] op_sel_hi:[1,0,1] neg_lo:[1,0,0]
    v_pk_mul_f32 v[84:85], v[22:23], v[36:37] op_sel:[0,0] op_sel_hi:[0,1] neg_hi:[1,0]
    v_pk_fma_f32 v[84:85], v[22:23], v[36:37], v[84:85] op_sel:[1,1,0] op_sel_hi:[1,0,1] neg_lo:[1,0,0] neg_hi:[1,0,0]
    v_cvt_pk_bf16_f32 v82, v84, v85
    v_pk_fma_f32 v[42:43], v[28:29], v[38:39], v[174:175] op_sel:[0,0,0] op_sel_hi:[0,1,1]
    v_pk_fma_f32 v[38:39], v[28:29], v[38:39], v[42:43] op_sel:[1,1,0] op_sel_hi:[1,0,1] neg_lo:[1,0,0]
    v_pk_mul_f32 v[86:87], v[30:31], v[38:39] op_sel:[0,0] op_sel_hi:[0,1] neg_hi:[1,0]
    v_pk_fma_f32 v[86:87], v[30:31], v[38:39], v[86:87] op_sel:[1,1,0] op_sel_hi:[1,0,1] neg_lo:[1,0,0] neg_hi:[1,0,0]
    v_cvt_pk_bf16_f32 v83, v86, v87
    buffer_store_dwordx2 v[82:83], v9, s[12:15], s35 offen sc1
    s_add_u32 s35, s35, 36864
    v_pk_fma_f32 v[40:41], v[20:21], v[36:37], v[176:177] op_sel:[0,0,0] op_sel_hi:[0,1,1]
    v_pk_fma_f32 v[36:37], v[20:21], v[36:37], v[40:41] op_sel:[1,1,0] op_sel_hi:[1,0,1] neg_lo:[1,0,0]
    v_pk_mul_f32 v[84:85], v[22:23], v[36:37] op_sel:[0,0] op_sel_hi:[0,1] neg_hi:[1,0]
    v_pk_fma_f32 v[84:85], v[22:23], v[36:37], v[84:85] op_sel:[1,1,0] op_sel_hi:[1,0,1] neg_lo:[1,0,0] neg_hi:[1,0,0]
    v_cvt_pk_bf16_f32 v76, v84, v85
    v_pk_fma_f32 v[42:43], v[28:29], v[38:39], v[178:179] op_sel:[0,0,0] op_sel_hi:[0,1,1]
    v_pk_fma_f32 v[38:39], v[28:29], v[38:39], v[42:43] op_sel:[1,1,0] op_sel_hi:[1,0,1] neg_lo:[1,0,0]
    v_pk_mul_f32 v[86:87], v[30:31], v[38:39] op_sel:[0,0] op_sel_hi:[0,1] neg_hi:[1,0]
    v_pk_fma_f32 v[86:87], v[30:31], v[38:39], v[86:87] op_sel:[1,1,0] op_sel_hi:[1,0,1] neg_lo:[1,0,0] neg_hi:[1,0,0]
    v_cvt_pk_bf16_f32 v77, v86, v87
    buffer_store_dwordx2 v[76:77], v9, s[12:15], s35 offen sc1
    s_add_u32 s35, s35, 36864
    v_pk_fma_f32 v[40:41], v[20:21], v[36:37], v[180:181] op_sel:[0,0,0] op_sel_hi:[0,1,1]
    v_pk_fma_f32 v[36:37], v[20:21], v[36:37], v[40:41] op_sel:[1,1,0] op_sel_hi:[1,0,1] neg_lo:[1,0,0]
    v_pk_mul_f32 v[84:85], v[22:23], v[36:37] op_sel:[0,0] op_sel_hi:[0,1] neg_hi:[1,0]
    v_pk_fma_f32 v[84:85], v[22:23], v[36:37], v[84:85] op_sel:[1,1,0] op_sel_hi:[1,0,1] neg_lo:[1,0,0] neg_hi:[1,0,0]
    v_cvt_pk_bf16_f32 v78, v84, v85
    v_pk_fma_f32 v[42:43], v[28:29], v[38:39], v[182:183] op_sel:[0,0,0] op_sel_hi:[0,1,1]
    v_pk_fma_f32 v[38:39], v[28:29], v[38:39], v[42:43] op_sel:[1,1,0] op_sel_hi:[1,0,1] neg_lo:[1,0,0]
    v_pk_mul_f32 v[86:87], v[30:31], v[38:39] op_sel:[0,0] op_sel_hi:[0,1] neg_hi:[1,0]
    v_pk_fma_f32 v[86:87], v[30:31], v[38:39], v[86:87] op_sel:[1,1,0] op_sel_hi:[1,0,1] neg_lo:[1,0,0] neg_hi:[1,0,0]
    v_cvt_pk_bf16_f32 v79, v86, v87
    buffer_store_dwordx2 v[78:79], v9, s[12:15], s35 offen sc1
    s_add_u32 s35, s35, 36864
    v_pk_fma_f32 v[40:41], v[20:21], v[36:37], v[184:185] op_sel:[0,0,0] op_sel_hi:[0,1,1]
    v_pk_fma_f32 v[36:37], v[20:21], v[36:37], v[40:41] op_sel:[1,1,0] op_sel_hi:[1,0,1] neg_lo:[1,0,0]
    v_pk_mul_f32 v[84:85], v[22:23], v[36:37] op_sel:[0,0] op_sel_hi:[0,1] neg_hi:[1,0]
    v_pk_fma_f32 v[84:85], v[22:23], v[36:37], v[84:85] op_sel:[1,1,0] op_sel_hi:[1,0,1] neg_lo:[1,0,0] neg_hi:[1,0,0]
    v_cvt_pk_bf16_f32 v80, v84, v85
    v_pk_fma_f32 v[42:43], v[28:29], v[38:39], v[186:187] op_sel:[0,0,0] op_sel_hi:[0,1,1]
    v_pk_fma_f32 v[38:39], v[28:29], v[38:39], v[42:43] op_sel:[1,1,0] op_sel_hi:[1,0,1] neg_lo:[1,0,0]
    v_pk_mul_f32 v[86:87], v[30:31], v[38:39] op_sel:[0,0] op_sel_hi:[0,1] neg_hi:[1,0]
    v_pk_fma_f32 v[86:87], v[30:31], v[38:39], v[86:87] op_sel:[1,1,0] op_sel_hi:[1,0,1] neg_lo:[1,0,0] neg_hi:[1,0,0]
    v_cvt_pk_bf16_f32 v81, v86, v87
    buffer_store_dwordx2 v[80:81], v9, s[12:15], s35 offen sc1
    s_add_u32 s35, s35, 36864
    v_pk_fma_f32 v[40:41], v[20:21], v[36:37], v[188:189] op_sel:[0,0,0] op_sel_hi:[0,1,1]
    v_pk_fma_f32 v[36:37], v[20:21], v[36:37], v[40:41] op_sel:[1,1,0] op_sel_hi:[1,0,1] neg_lo:[1,0,0]
    v_pk_mul_f32 v[84:85], v[22:23], v[36:37] op_sel:[0,0] op_sel_hi:[0,1] neg_hi:[1,0]
    v_pk_fma_f32 v[84:85], v[22:23], v[36:37], v[84:85] op_sel:[1,1,0] op_sel_hi:[1,0,1] neg_lo:[1,0,0] neg_hi:[1,0,0]
    v_cvt_pk_bf16_f32 v82, v84, v85
    v_pk_fma_f32 v[42:43], v[28:29], v[38:39], v[190:191] op_sel:[0,0,0] op_sel_hi:[0,1,1]
    v_pk_fma_f32 v[38:39], v[28:29], v[38:39], v[42:43] op_sel:[1,1,0] op_sel_hi:[1,0,1] neg_lo:[1,0,0]
    v_pk_mul_f32 v[86:87], v[30:31], v[38:39] op_sel:[0,0] op_sel_hi:[0,1] neg_hi:[1,0]
    v_pk_fma_f32 v[86:87], v[30:31], v[38:39], v[86:87] op_sel:[1,1,0] op_sel_hi:[1,0,1] neg_lo:[1,0,0] neg_hi:[1,0,0]
    v_cvt_pk_bf16_f32 v83, v86, v87
    buffer_store_dwordx2 v[82:83], v9, s[12:15], s35 offen sc1
    s_add_u32 s35, s35, 36864
    s_load_dwordx2 s[68:69], s[0:1], 112
    s_waitcnt vmcnt(0) lgkmcnt(0)
    s_barrier
    s_cmp_lg_u32 s32, 0
    s_cbranch_scc1 K2_END
    s_mov_b32 s24, s68
    s_mov_b32 s25, s69
    s_mov_b32 s26, 256
    s_mov_b32 s27, 0x00020000
    s_mul_i32 s70, s2, 1821
    s_lshr_b32 s70, s70, 16
    s_lshl_b32 s70, s70, 2
    v_mov_b32 v9, 0
    v_mov_b32 v10, 1
    s_mov_b64 exec, 1
    buffer_atomic_add v10, v9, s[24:27], s70 offen sc1
K2_END:
    s_endpgm
.section .rodata,"a"
.p2align 6
.amdhsa_kernel k0_kernel
  .amdhsa_next_free_vgpr 64
  .amdhsa_next_free_sgpr 96
  .amdhsa_accum_offset 64
  .amdhsa_group_segment_fixed_size 0
  .amdhsa_kernarg_size 128
  .amdhsa_user_sgpr_count 2
  .amdhsa_user_sgpr_kernarg_segment_ptr 1
  .amdhsa_system_sgpr_workgroup_id_x 1
  .amdhsa_float_denorm_mode_32 3
.end_amdhsa_kernel

.p2align 6
.amdhsa_kernel k1_kernel
  .amdhsa_next_free_vgpr 256
  .amdhsa_next_free_sgpr 102
  .amdhsa_accum_offset 256
  .amdhsa_group_segment_fixed_size 0
  .amdhsa_kernarg_size 128
  .amdhsa_user_sgpr_count 2
  .amdhsa_user_sgpr_kernarg_segment_ptr 1
  .amdhsa_system_sgpr_workgroup_id_x 1
  .amdhsa_float_denorm_mode_32 3
.end_amdhsa_kernel

.p2align 6
.amdhsa_kernel k2_kernel
  .amdhsa_next_free_vgpr 256
  .amdhsa_next_free_sgpr 102
  .amdhsa_accum_offset 256
  .amdhsa_group_segment_fixed_size 0
  .amdhsa_kernarg_size 128
  .amdhsa_user_sgpr_count 2
  .amdhsa_user_sgpr_kernarg_segment_ptr 1
  .amdhsa_system_sgpr_workgroup_id_x 1
  .amdhsa_float_denorm_mode_32 3
.end_amdhsa_kernel
```
